```python
import torch

def _softmax(x, axis=-1):
    return torch.softmax(x, dim=axis)
def _gelu(x):
    return torch.nn.functional.gelu(x, approximate="tanh")
def _silu(x):
    return torch.nn.functional.silu(x)
def _sigmoid(x):
    return torch.sigmoid(x)
def _layernorm(x, axis=-1, eps=1e-5):
    m = x.mean(dim=axis, keepdim=True)
    v = x.var(dim=axis, keepdim=True, unbiased=False)
    return (x - m) / torch.sqrt(v + eps)
def _scatter_add(tgt, idx, src, axis=0):
    return tgt.clone().index_add_(axis, idx, src)
def _segment_sum(src, seg, n):
    out = torch.zeros((n,) + src.shape[1:], dtype=src.dtype)
    return out.index_add_(0, seg, src)
def _pad(x, pw):
    flat = tuple(v for pair in reversed(pw) for v in pair)
    return torch.nn.functional.pad(x, flat)

kernel_name = 'standalone__detection_seg_fpn_lateral__vision'

def setup_inputs():

    _w = (lambda a: (lambda t: t.to(torch.bfloat16) if t.is_floating_point() else t)(torch.as_tensor(a)))
    H = W = (224 // 2) * 2
    C = 96
    k = 7
    return {
        "c_fine": _w((lambda *s: torch.randn(*s, dtype=torch.bfloat16) * 0.05)(1, H, W, C)),
        "p_coarse": _w((lambda *s: torch.randn(*s, dtype=torch.bfloat16) * 0.05)(1, H // 2, W // 2, C)),
        "w_lat": _w((lambda *s: torch.randn(*s, dtype=torch.bfloat16) * 0.05)(C, C)),
        "w_out": _w((lambda *s: torch.randn(*s, dtype=torch.bfloat16) * 0.05)(k, k, C, C)),
    }

def reference(c_fine, p_coarse, w_lat, w_out):
    B, H, W, C = c_fine.shape
    k = 7
    lat = torch.einsum("bhwc,cd->bhwd", c_fine, w_lat)
    up = (lambda x, n, axis: torch.repeat_interleave(x, n, dim=axis))((lambda x, n, axis: torch.repeat_interleave(x, n, dim=axis))(p_coarse, 2, axis=1), 2, axis=2)
    m = lat + up
    pad = k // 2
    mp = _pad(m, ((0, 0), (pad, pad), (pad, pad), (0, 0)))
    o = None
    for di in range(k):
        for dj in range(k):
            t = torch.einsum("bhwc,cd->bhwd", mp[:, di:di + H, dj:dj + W, :], w_out[di, dj])
            o = t if o is None else o + t
    return o
```

```asm
; @launch grid=(256,1,1) block=(256,1,1) lds=152064
.amdgcn_target "amdgcn-amd-amdhsa--gfx950"
.text
.globl standalone__detection_seg_fpn_lateral__vision_kernel
.p2align 8
.type standalone__detection_seg_fpn_lateral__vision_kernel,@function
standalone__detection_seg_fpn_lateral__vision_kernel:
    s_load_dwordx2 s[20:21], s[0:1], 0
    s_load_dwordx2 s[24:25], s[0:1], 8
    s_load_dwordx2 s[28:29], s[0:1], 16
    v_lshrrev_b32 v4, 6, v0
    v_and_b32 v1, 63, v0
    v_and_b32 v2, 15, v0
    v_readfirstlane_b32 s18, v4
    v_bfe_u32 v3, v0, 4, 2
    v_lshlrev_b32 v11, 4, v1
    s_getpc_b64 s[60:61]
L_PC:
    s_lshr_b32 s57, s2, 3
    s_lshl2_add_u32 s53, s57, s18
    s_mul_i32 s53, s53, 512
    v_lshl_add_u32 v4, v1, 7, s53
    v_min_u32 v4, 50664, v4
    v_mov_b32 v5, s61
    v_add_co_u32 v4, vcc, s60, v4
    s_mov_b64 exec, 0xf
    s_nop 0
    v_addc_co_u32 v5, vcc, 0, v5, vcc
    global_load_dword v255, v[4:5], off
    s_mov_b64 exec, -1
    s_and_b32 s52, s2, 7
    s_lshl_b32 s54, s52, 2
    s_lshr_b32 s54, 0x66656665, s54
    s_and_b32 s54, s54, 15
    s_cmp_lt_u32 s57, s54
    s_cbranch_scc1 L_PROD
    s_cmp_ge_u32 s57, 32
    s_cbranch_scc1 L_END
    s_cmp_eq_u32 s18, 3
    s_cbranch_scc1 L_HELP
    s_mov_b32 s54, 0x51371d03
    s_mov_b32 s55, 0x51371d03
    s_lshl_b32 s56, s52, 3
    s_lshr_b64 s[54:55], s[54:55], s56
    s_and_b32 s54, s54, 0xff
    s_add_u32 s56, s54, s57
    s_sub_u32 s56, s56, 8
    s_mul_i32 s54, s56, 9363
    s_lshr_b32 s54, s54, 16
    s_lshr_b32 s55, s52, 2
    s_sub_u32 s55, s55, s54
    s_mul_i32 s55, s55, 7
    s_add_u32 s55, s55, s56
    s_mul_i32 s49, s54, 15
    s_lshl_b32 s50, s55, 4
    s_cmp_eq_u32 s18, 2
    s_cselect_b32 s54, 12, 16
    s_cselect_b32 s55, 6, 16
    s_cselect_b32 s56, 13, -3
    v_subrev_u32 v235, 4, v2
    v_cmp_le_u32 vcc, s54, v2
    s_add_u32 s56, s56, s50
    s_and_b32 s54, s18, 1
    s_mul_i32 s54, s54, 5
    v_cndmask_b32 v234, v2, v235, vcc
    v_cmp_le_u32 vcc, s55, v234
    s_sub_u32 s57, s49, 3
    v_mov_b32 v238, s54
    v_cndmask_b32 v235, v238, 3, vcc
    v_cndmask_b32 v236, 0, 6, vcc
    v_sub_u32 v234, v234, v236
    v_add_u32 v236, s56, v234
    v_mad_u32_u24 v237, v235, 3, s57
    v_mul_i32_i24 v4, 224, v237
    v_add_u32 v4, v4, v236
    v_mul_i32_i24 v4, 192, v4
    v_cmp_gt_u32 vcc, 224, v236
    v_lshl_add_u32 v4, v3, 4, v4
    v_bfrev_b32 v238, 1
    v_cndmask_b32 v4, v238, v4, vcc
    s_mul_i32 s52, s18, 7
    s_add_u32 s52, s52, 1
    s_lshr_b32 s52, s52, 1
    s_ashr_i32 s55, s57, 1
    s_add_u32 s55, s55, s52
    s_mul_i32 s55, s55, 21504
    s_mul_i32 s54, s50, 96
    s_max_i32 s54, s54, 384
    s_add_u32 s55, s55, s54
    s_sub_u32 s55, s55, 384
    v_add_u32 v240, s55, v11
    s_mov_b32 s22, 9633792
    s_mov_b32 s23, 0x20000
    s_mov_b32 s26, 2408448
    s_mov_b32 s27, s23
    s_mov_b32 s30, 18432
    s_mov_b32 s31, s23
    s_mul_i32 s54, s18, 6144
    s_mul_i32 s56, s52, 2304
    s_add_u32 m0, s54, 101376
    s_add_u32 s55, s54, 4096
    s_waitcnt lgkmcnt(0)
    buffer_load_dwordx4 v11, s[28:31], s54 offen offset:0 lds
    buffer_load_dwordx4 v11, s[28:31], s54 offen offset:1024 lds
    buffer_load_dwordx4 v11, s[28:31], s54 offen offset:2048 lds
    buffer_load_dwordx4 v11, s[28:31], s54 offen offset:3072 lds
    s_add_u32 m0, s55, 101376
    s_mov_b32 s54, 21504
    buffer_load_dwordx4 v11, s[28:31], s55 offen offset:0 lds
    buffer_load_dwordx4 v11, s[28:31], s55 offen offset:1024 lds
    s_mov_b32 exec_hi, 0xffff
    s_add_u32 m0, s56, 50688
    s_nop 0
    buffer_load_dwordx4 v240, s[24:27], 0 offen offset:0 lds
    buffer_load_dwordx4 v240, s[24:27], 0 offen offset:768 lds
    buffer_load_dwordx4 v240, s[24:27], 0 offen offset:1536 lds
    s_add_u32 m0, s56, 52992
    v_add_u32 v240, s54, v240
    buffer_load_dwordx4 v240, s[24:27], 0 offen offset:0 lds
    buffer_load_dwordx4 v240, s[24:27], 0 offen offset:768 lds
    buffer_load_dwordx4 v240, s[24:27], 0 offen offset:1536 lds
    s_mov_b64 exec, -1
    buffer_load_dwordx4 a[72:75], v4, s[20:23], 0 offen offset:0
    buffer_load_dwordx4 a[76:79], v4, s[20:23], 0 offen offset:64
    buffer_load_dwordx4 a[80:83], v4, s[20:23], 0 offen offset:128
    v_add_u32 v4, 43008, v4
    s_mov_b32 exec_hi, 0xffff
    s_add_u32 m0, s56, 55296
    v_add_u32 v240, s54, v240
    buffer_load_dwordx4 v240, s[24:27], 0 offen offset:0 lds
    buffer_load_dwordx4 v240, s[24:27], 0 offen offset:768 lds
    buffer_load_dwordx4 v240, s[24:27], 0 offen offset:1536 lds
    s_cmp_eq_u32 s18, 1
    s_cselect_b32 s54, 86016, s54
    s_cselect_b32 s56, 16128, s56
    s_cmp_eq_u32 s18, 2
    s_cselect_b32 s54, 0x40000000, s54
    s_cselect_b32 s56, 18432, s56
    s_add_u32 m0, s56, 57600
    v_add_u32 v240, s54, v240
    buffer_load_dwordx4 v240, s[24:27], 0 offen offset:0 lds
    buffer_load_dwordx4 v240, s[24:27], 0 offen offset:768 lds
    buffer_load_dwordx4 v240, s[24:27], 0 offen offset:1536 lds
    s_mov_b64 exec, -1
    buffer_load_dwordx4 a[84:87], v4, s[20:23], 0 offen offset:0
    buffer_load_dwordx4 a[88:91], v4, s[20:23], 0 offen offset:64
    buffer_load_dwordx4 a[92:95], v4, s[20:23], 0 offen offset:128
    v_add_u32 v4, 43008, v4
    buffer_load_dwordx4 a[96:99], v4, s[20:23], 0 offen offset:0
    buffer_load_dwordx4 a[100:103], v4, s[20:23], 0 offen offset:64
    buffer_load_dwordx4 a[104:107], v4, s[20:23], 0 offen offset:128
    v_add_u32 v4, 43008, v4
    v_cndmask_b32 v252, 0, 1, vcc
    v_lshlrev_b32 v252, 16, v252
    v_sub_u32 v253, 0, v252
    s_ashr_i32 s57, s57, 1
    v_ashrrev_i32 v5, 1, v237
    v_subrev_u32 v5, s57, v5
    v_mul_u32_u24 v5, 12, v5
    s_and_b32 s54, s18, 2
    s_lshl_b32 s54, s54, 3
    v_add_u32 v234, s54, v234
    v_add_u32 v239, 1, v234
    v_lshrrev_b32 v239, 1, v239
    v_add_u32 v5, v5, v239
    v_mul_u32_u24 v5, 192, v5
    v_lshl_add_u32 v5, v3, 4, v5
    s_cmp_eq_u32 s50, 0
    s_cselect_b32 s54, 384, 0
    s_sub_u32 s54, 50688, s54
    v_add_u32 v5, s54, v5
    v_and_b32 v6, 1, v237
    v_mul_u32_u24 v6, 2304, v6
    v_add_u32 v6, v6, v5
    v_lshrrev_b32 v7, 2, v2
    v_lshl_add_u32 v7, v3, 3, v7
    v_mul_u32_u24 v7, 192, v7
    v_and_b32 v239, 3, v2
    v_lshl_add_u32 v7, v239, 4, v7
    v_add_u32 v7, 101376, v7
    s_load_dwordx2 s[36:37], s[0:1], 32
    s_load_dwordx2 s[40:41], s[0:1], 40
    s_load_dwordx2 s[44:45], s[0:1], 48
    s_mov_b32 s38, 9633792
    s_mov_b32 s39, 0x20000
    s_mov_b32 s42, 256
    s_mov_b32 s43, 0x20000
    s_mov_b32 s46, 268435456
    s_mov_b32 s47, 0x20000
    s_waitcnt lgkmcnt(0)
    s_waitcnt vmcnt(15)
    s_barrier
    ds_read_b128 v[208:211], v5 offset:0
    ds_read_b128 v[212:215], v5 offset:64
    ds_read_b128 v[216:219], v5 offset:128
    ds_read_b64_tr_b16 a[0:1], v7 offset:0
    ds_read_b64_tr_b16 a[2:3], v7 offset:768
    ds_read_b64_tr_b16 a[12:13], v7 offset:8
    ds_read_b64_tr_b16 a[14:15], v7 offset:776
    ds_read_b64_tr_b16 a[24:25], v7 offset:64
    ds_read_b64_tr_b16 a[26:27], v7 offset:832
    ds_read_b64_tr_b16 a[36:37], v7 offset:72
    ds_read_b64_tr_b16 a[38:39], v7 offset:840
    ds_read_b64_tr_b16 a[48:49], v7 offset:128
    ds_read_b64_tr_b16 a[50:51], v7 offset:896
    ds_read_b64_tr_b16 a[60:61], v7 offset:136
    ds_read_b64_tr_b16 a[62:63], v7 offset:904
    ds_read_b64_tr_b16 a[4:5], v7 offset:6144
    ds_read_b64_tr_b16 a[6:7], v7 offset:6912
    ds_read_b64_tr_b16 a[16:17], v7 offset:6152
    ds_read_b64_tr_b16 a[18:19], v7 offset:6920
    s_waitcnt lgkmcnt(15)
    v_mul_u32_u24 v16, v252, v208
    v_and_b32 v17, v253, v208
    v_mul_u32_u24 v18, v252, v209
    v_and_b32 v19, v253, v209
    v_mul_u32_u24 v20, v252, v210
    v_and_b32 v21, v253, v210
    v_mul_u32_u24 v22, v252, v211
    v_and_b32 v23, v253, v211
    v_mul_u32_u24 v24, v252, v212
    v_and_b32 v25, v253, v212
    v_mul_u32_u24 v26, v252, v213
    v_and_b32 v27, v253, v213
    v_mul_u32_u24 v28, v252, v214
    v_and_b32 v29, v253, v214
    v_mul_u32_u24 v30, v252, v215
    v_and_b32 v31, v253, v215
    v_mul_u32_u24 v32, v252, v216
    v_and_b32 v33, v253, v216
    v_mul_u32_u24 v34, v252, v217
    v_and_b32 v35, v253, v217
    v_mul_u32_u24 v36, v252, v218
    v_and_b32 v37, v253, v218
    v_mul_u32_u24 v38, v252, v219
    v_and_b32 v39, v253, v219
    s_waitcnt vmcnt(14) lgkmcnt(14)
    v_mfma_f32_16x16x32_bf16 v[16:19], a[0:3], a[72:75], v[16:19]
    s_waitcnt lgkmcnt(12)
    ds_read_b64_tr_b16 a[28:29], v7 offset:6208
    ds_read_b64_tr_b16 a[30:31], v7 offset:6976
    v_mfma_f32_16x16x32_bf16 v[20:23], a[12:15], a[72:75], v[20:23]
    s_waitcnt lgkmcnt(12)
    ds_read_b64_tr_b16 a[40:41], v7 offset:6216
    ds_read_b64_tr_b16 a[42:43], v7 offset:6984
    v_mfma_f32_16x16x32_bf16 v[24:27], a[24:27], a[72:75], v[24:27]
    s_waitcnt lgkmcnt(12)
    ds_read_b64_tr_b16 a[52:53], v7 offset:6272
    ds_read_b64_tr_b16 a[54:55], v7 offset:7040
    v_mfma_f32_16x16x32_bf16 v[28:31], a[36:39], a[72:75], v[28:31]
    s_waitcnt lgkmcnt(12)
    ds_read_b64_tr_b16 a[64:65], v7 offset:6280
    ds_read_b64_tr_b16 a[66:67], v7 offset:7048
    v_mfma_f32_16x16x32_bf16 v[32:35], a[48:51], a[72:75], v[32:35]
    s_waitcnt lgkmcnt(12)
    ds_read_b128 v[220:223], v6 offset:0
    ds_read_b128 v[224:227], v6 offset:64
    v_mfma_f32_16x16x32_bf16 v[36:39], a[60:63], a[72:75], v[36:39]
    s_waitcnt vmcnt(13) lgkmcnt(12)
    ds_read_b128 v[228:231], v6 offset:128
    ds_read_b64_tr_b16 a[8:9], v7 offset:12288
    v_mfma_f32_16x16x32_bf16 v[16:19], a[4:7], a[76:79], v[16:19]
    s_waitcnt lgkmcnt(12)
    ds_read_b64_tr_b16 a[10:11], v7 offset:13056
    ds_read_b64_tr_b16 a[20:21], v7 offset:12296
    v_mfma_f32_16x16x32_bf16 v[20:23], a[16:19], a[76:79], v[20:23]
    s_waitcnt lgkmcnt(12)
    ds_read_b64_tr_b16 a[22:23], v7 offset:13064
    ds_read_b64_tr_b16 a[32:33], v7 offset:12352
    v_mfma_f32_16x16x32_bf16 v[24:27], a[28:31], a[76:79], v[24:27]
    s_waitcnt lgkmcnt(12)
    ds_read_b64_tr_b16 a[34:35], v7 offset:13120
    ds_read_b64_tr_b16 a[44:45], v7 offset:12360
    v_mfma_f32_16x16x32_bf16 v[28:31], a[40:43], a[76:79], v[28:31]
    s_waitcnt lgkmcnt(12)
    ds_read_b64_tr_b16 a[46:47], v7 offset:13128
    ds_read_b64_tr_b16 a[56:57], v7 offset:12416
    v_mfma_f32_16x16x32_bf16 v[32:35], a[52:55], a[76:79], v[32:35]
    s_waitcnt lgkmcnt(12)
    ds_read_b64_tr_b16 a[58:59], v7 offset:13184
    ds_read_b64_tr_b16 a[68:69], v7 offset:12424
    v_mfma_f32_16x16x32_bf16 v[36:39], a[64:67], a[76:79], v[36:39]
    s_waitcnt vmcnt(12) lgkmcnt(7)
    ds_read_b64_tr_b16 a[70:71], v7 offset:13192
    v_mul_u32_u24 v40, v252, v220
    v_mfma_f32_16x16x32_bf16 v[16:19], a[8:11], a[80:83], v[16:19]
    buffer_load_dwordx4 a[108:111], v4, s[20:23], 0 offen offset:0
    v_mfma_f32_16x16x32_bf16 v[20:23], a[20:23], a[80:83], v[20:23]
    s_waitcnt lgkmcnt(6)
    v_and_b32 v41, v253, v220
    v_mul_u32_u24 v42, v252, v221
    v_mfma_f32_16x16x32_bf16 v[24:27], a[32:35], a[80:83], v[24:27]
    s_waitcnt lgkmcnt(4)
    v_and_b32 v43, v253, v221
    v_mul_u32_u24 v44, v252, v222
    v_mfma_f32_16x16x32_bf16 v[28:31], a[44:47], a[80:83], v[28:31]
    s_waitcnt lgkmcnt(2)
    v_and_b32 v45, v253, v222
    v_mul_u32_u24 v46, v252, v223
    v_mfma_f32_16x16x32_bf16 v[32:35], a[56:59], a[80:83], v[32:35]
    s_waitcnt vmcnt(7) lgkmcnt(0)
    v_and_b32 v47, v253, v223
    v_mul_u32_u24 v48, v252, v224
    v_mfma_f32_16x16x32_bf16 v[36:39], a[68:71], a[80:83], v[36:39]
    v_and_b32 v49, v253, v224
    v_mul_u32_u24 v50, v252, v225
    buffer_load_dwordx4 a[112:115], v4, s[20:23], 0 offen offset:64
    buffer_load_dwordx4 a[116:119], v4, s[20:23], 0 offen offset:128
    v_add_u32 v4, 43008, v4
    v_and_b32 v51, v253, v225
    v_mul_u32_u24 v52, v252, v226
    v_and_b32 v53, v253, v226
    v_mul_u32_u24 v54, v252, v227
    v_and_b32 v55, v253, v227
    v_mul_u32_u24 v56, v252, v228
    v_and_b32 v57, v253, v228
    v_mul_u32_u24 v58, v252, v229
    v_and_b32 v59, v253, v229
    v_mul_u32_u24 v60, v252, v230
    v_and_b32 v61, v253, v230
    v_mul_u32_u24 v62, v252, v231
    v_and_b32 v63, v253, v231
    s_barrier
    s_waitcnt vmcnt(8)
    v_mfma_f32_16x16x32_bf16 v[40:43], a[0:3], a[84:87], v[40:43]
    ds_read_b128 v[208:211], v5 offset:2304
    ds_read_b128 v[212:215], v5 offset:2368
    v_mfma_f32_16x16x32_bf16 v[44:47], a[12:15], a[84:87], v[44:47]
    ds_read_b128 v[216:219], v5 offset:2432
    ds_read_b128 v[220:223], v6 offset:2304
    v_mfma_f32_16x16x32_bf16 v[48:51], a[24:27], a[84:87], v[48:51]
    ds_read_b128 v[224:227], v6 offset:2368
    ds_read_b128 v[228:231], v6 offset:2432
    v_mfma_f32_16x16x32_bf16 v[52:55], a[36:39], a[84:87], v[52:55]
    buffer_load_dwordx4 a[120:123], v4, s[20:23], 0 offen offset:0
    v_mfma_f32_16x16x32_bf16 v[56:59], a[48:51], a[84:87], v[56:59]
    s_mov_b32 s4, -344064
    v_mfma_f32_16x16x32_bf16 v[60:63], a[60:63], a[84:87], v[60:63]
    s_waitcnt vmcnt(8) lgkmcnt(5)
    v_mul_u32_u24 v64, v252, v208
    v_and_b32 v65, v253, v208
    v_mfma_f32_16x16x32_bf16 v[40:43], a[4:7], a[88:91], v[40:43]
    s_mov_b32 s5, -215040
    v_mul_u32_u24 v66, v252, v209
    v_and_b32 v67, v253, v209
    v_mfma_f32_16x16x32_bf16 v[44:47], a[16:19], a[88:91], v[44:47]
    s_mov_b32 s6, -25344
    v_mul_u32_u24 v68, v252, v210
    v_and_b32 v69, v253, v210
    v_mfma_f32_16x16x32_bf16 v[48:51], a[28:31], a[88:91], v[48:51]
    s_mov_b32 s9, -6912
    v_mul_u32_u24 v70, v252, v211
    v_and_b32 v71, v253, v211
    v_mfma_f32_16x16x32_bf16 v[52:55], a[40:43], a[88:91], v[52:55]
    buffer_load_dwordx4 a[124:127], v4, s[20:23], 0 offen offset:64
    v_mfma_f32_16x16x32_bf16 v[56:59], a[52:55], a[88:91], v[56:59]
    s_cmp_eq_u32 s18, 1
    s_waitcnt lgkmcnt(4)
    v_mul_u32_u24 v72, v252, v212
    v_and_b32 v73, v253, v212
    v_mfma_f32_16x16x32_bf16 v[60:63], a[64:67], a[88:91], v[60:63]
    s_waitcnt vmcnt(8) lgkmcnt(3)
    v_mul_u32_u24 v74, v252, v213
    v_and_b32 v75, v253, v213
    v_mfma_f32_16x16x32_bf16 v[40:43], a[8:11], a[92:95], v[40:43]
    s_cselect_b32 s4, s4, 43008
    v_mul_u32_u24 v76, v252, v214
    v_and_b32 v77, v253, v214
    v_mfma_f32_16x16x32_bf16 v[44:47], a[20:23], a[92:95], v[44:47]
    s_cselect_b32 s5, s5, 43008
    v_mul_u32_u24 v78, v252, v215
    v_and_b32 v79, v253, v215
    v_mfma_f32_16x16x32_bf16 v[48:51], a[32:35], a[92:95], v[48:51]
    s_cselect_b32 s6, s6, 25344
    v_mul_u32_u24 v80, v252, v216
    v_and_b32 v81, v253, v216
    v_mfma_f32_16x16x32_bf16 v[52:55], a[44:47], a[92:95], v[52:55]
    buffer_load_dwordx4 a[128:131], v4, s[20:23], 0 offen offset:128
    v_mfma_f32_16x16x32_bf16 v[56:59], a[56:59], a[92:95], v[56:59]
    s_cselect_b32 s9, s9, 0
    v_add_u32 v4, 43008, v4
    v_mul_u32_u24 v82, v252, v217
    v_mfma_f32_16x16x32_bf16 v[60:63], a[68:71], a[92:95], v[60:63]
    s_waitcnt vmcnt(8)
    v_and_b32 v83, v253, v217
    v_mul_u32_u24 v84, v252, v218
    v_and_b32 v85, v253, v218
    v_mul_u32_u24 v86, v252, v219
    v_and_b32 v87, v253, v219
    v_mfma_f32_16x16x32_bf16 v[64:67], a[0:3], a[96:99], v[64:67]
    ds_read_b128 v[208:211], v5 offset:4608
    ds_read_b128 v[212:215], v5 offset:4672
    v_mfma_f32_16x16x32_bf16 v[68:71], a[12:15], a[96:99], v[68:71]
    s_waitcnt lgkmcnt(4)
    ds_read_b128 v[216:219], v5 offset:4736
    v_mul_u32_u24 v88, v252, v220
    v_mfma_f32_16x16x32_bf16 v[72:75], a[24:27], a[96:99], v[72:75]
    buffer_load_dwordx4 a[132:135], v4, s[20:23], 0 offen offset:0
    v_mfma_f32_16x16x32_bf16 v[76:79], a[36:39], a[96:99], v[76:79]
    s_cselect_b32 s55, -1, 0
    v_and_b32 v89, v253, v220
    v_mul_u32_u24 v90, v252, v221
    v_mfma_f32_16x16x32_bf16 v[80:83], a[48:51], a[96:99], v[80:83]
    s_sub_u32 s54, s49, 3
    v_and_b32 v91, v253, v221
    v_mul_u32_u24 v92, v252, v222
    v_mfma_f32_16x16x32_bf16 v[84:87], a[60:63], a[96:99], v[84:87]
    s_waitcnt vmcnt(8) lgkmcnt(4)
    v_and_b32 v93, v253, v222
    v_mul_u32_u24 v94, v252, v223
    v_mfma_f32_16x16x32_bf16 v[64:67], a[4:7], a[100:103], v[64:67]
    s_and_b32 s54, s54, 1
    v_and_b32 v95, v253, v223
    v_mul_u32_u24 v96, v252, v224
    v_mfma_f32_16x16x32_bf16 v[68:71], a[16:19], a[100:103], v[68:71]
    s_mul_i32 s54, s54, 2304
    v_and_b32 v97, v253, v224
    v_mul_u32_u24 v98, v252, v225
    v_mfma_f32_16x16x32_bf16 v[72:75], a[28:31], a[100:103], v[72:75]
    buffer_load_dwordx4 a[136:139], v4, s[20:23], 0 offen offset:64
    v_mfma_f32_16x16x32_bf16 v[76:79], a[40:43], a[100:103], v[76:79]
    s_sub_u32 s7, -9216, s54
    v_and_b32 v99, v253, v225
    v_mul_u32_u24 v100, v252, v226
    v_mfma_f32_16x16x32_bf16 v[80:83], a[52:55], a[100:103], v[80:83]
    s_add_u32 s8, s54, -11520
    v_and_b32 v101, v253, v226
    v_mul_u32_u24 v102, v252, v227
    v_mfma_f32_16x16x32_bf16 v[84:87], a[64:67], a[100:103], v[84:87]
    s_waitcnt vmcnt(8) lgkmcnt(3)
    v_and_b32 v103, v253, v227
    v_mul_u32_u24 v104, v252, v228
    v_mfma_f32_16x16x32_bf16 v[64:67], a[8:11], a[104:107], v[64:67]
    s_and_b32 s7, s7, s55
    v_and_b32 v105, v253, v228
    v_mul_u32_u24 v106, v252, v229
    v_mfma_f32_16x16x32_bf16 v[68:71], a[20:23], a[104:107], v[68:71]
    s_and_b32 s8, s8, s55
    v_and_b32 v107, v253, v229
    v_mul_u32_u24 v108, v252, v230
    v_mfma_f32_16x16x32_bf16 v[72:75], a[32:35], a[104:107], v[72:75]
    buffer_load_dwordx4 a[140:143], v4, s[20:23], 0 offen offset:128
    v_mfma_f32_16x16x32_bf16 v[76:79], a[44:47], a[104:107], v[76:79]
    s_lshr_b32 s19, s18, 1
    v_add_u32 v4, s4, v4
    v_and_b32 v109, v253, v230
    v_mfma_f32_16x16x32_bf16 v[80:83], a[56:59], a[104:107], v[80:83]
    s_and_b32 s48, s18, 1
    v_mul_u32_u24 v110, v252, v231
    v_and_b32 v111, v253, v231
    v_mfma_f32_16x16x32_bf16 v[84:87], a[68:71], a[104:107], v[84:87]
    s_waitcnt vmcnt(8)
    v_mfma_f32_16x16x32_bf16 v[88:91], a[0:3], a[108:111], v[88:91]
    ds_read_b128 v[220:223], v6 offset:4608
    ds_read_b128 v[224:227], v6 offset:4672
    v_mfma_f32_16x16x32_bf16 v[92:95], a[12:15], a[108:111], v[92:95]
    s_waitcnt lgkmcnt(4)
    ds_read_b128 v[228:231], v6 offset:4736
    v_mul_u32_u24 v112, v252, v208
    v_mfma_f32_16x16x32_bf16 v[96:99], a[24:27], a[108:111], v[96:99]
    buffer_load_dwordx4 a[144:147], v4, s[20:23], 0 offen offset:0
    v_mfma_f32_16x16x32_bf16 v[100:103], a[36:39], a[108:111], v[100:103]
    s_mov_b32 s59, 7872
    v_and_b32 v113, v253, v208
    v_mul_u32_u24 v114, v252, v209
    v_mfma_f32_16x16x32_bf16 v[104:107], a[48:51], a[108:111], v[104:107]
    s_mov_b32 s68, 0x3ec80000
    v_and_b32 v115, v253, v209
    v_mul_u32_u24 v116, v252, v210
    v_mfma_f32_16x16x32_bf16 v[108:111], a[60:63], a[108:111], v[108:111]
    s_waitcnt vmcnt(8) lgkmcnt(4)
    v_and_b32 v117, v253, v210
    v_mul_u32_u24 v118, v252, v211
    v_mfma_f32_16x16x32_bf16 v[88:91], a[4:7], a[112:115], v[88:91]
    s_mov_b32 s69, s68
    v_and_b32 v119, v253, v211
    v_mul_u32_u24 v120, v252, v212
    v_mfma_f32_16x16x32_bf16 v[92:95], a[16:19], a[112:115], v[92:95]
    s_mov_b32 s62, 0x3fc00000
    v_and_b32 v121, v253, v212
    v_mul_u32_u24 v122, v252, v213
    v_mfma_f32_16x16x32_bf16 v[96:99], a[28:31], a[112:115], v[96:99]
    buffer_load_dwordx4 a[148:151], v4, s[20:23], 0 offen offset:64
    v_mfma_f32_16x16x32_bf16 v[100:103], a[40:43], a[112:115], v[100:103]
    s_mov_b32 s63, s62
    v_and_b32 v123, v253, v213
    v_mul_u32_u24 v124, v252, v214
    v_mfma_f32_16x16x32_bf16 v[104:107], a[52:55], a[112:115], v[104:107]
    s_mov_b32 s66, 0x40100000
    v_and_b32 v125, v253, v214
    v_mul_u32_u24 v126, v252, v215
    v_mfma_f32_16x16x32_bf16 v[108:111], a[64:67], a[112:115], v[108:111]
    s_waitcnt vmcnt(8) lgkmcnt(3)
    v_and_b32 v127, v253, v215
    v_mul_u32_u24 v128, v252, v216
    v_mfma_f32_16x16x32_bf16 v[88:91], a[8:11], a[116:119], v[88:91]
    s_mov_b32 s67, s66
    v_and_b32 v129, v253, v216
    v_mul_u32_u24 v130, v252, v217
    v_mfma_f32_16x16x32_bf16 v[92:95], a[20:23], a[116:119], v[92:95]
    s_mov_b32 s64, 0x3f200000
    v_and_b32 v131, v253, v217
    v_mul_u32_u24 v132, v252, v218
    v_mfma_f32_16x16x32_bf16 v[96:99], a[32:35], a[116:119], v[96:99]
    buffer_load_dwordx4 a[152:155], v4, s[20:23], 0 offen offset:128
    v_mfma_f32_16x16x32_bf16 v[100:103], a[44:47], a[116:119], v[100:103]
    s_mov_b32 s65, s64
    v_add_u32 v4, 43008, v4
    v_and_b32 v133, v253, v218
    v_mfma_f32_16x16x32_bf16 v[104:107], a[56:59], a[116:119], v[104:107]
    s_mov_b32 s70, 0x404048d1
    v_mul_u32_u24 v134, v252, v219
    v_and_b32 v135, v253, v219
    v_mfma_f32_16x16x32_bf16 v[108:111], a[68:71], a[116:119], v[108:111]
    s_waitcnt vmcnt(8) lgkmcnt(2)
    v_mfma_f32_16x16x32_bf16 v[112:115], a[0:3], a[120:123], v[112:115]
    buffer_load_dwordx4 a[156:159], v4, s[20:23], 0 offen offset:0
    v_mfma_f32_16x16x32_bf16 v[116:119], a[12:15], a[120:123], v[116:119]
    s_mov_b32 s71, s70
    v_mul_u32_u24 v136, v252, v220
    v_and_b32 v137, v253, v220
    v_mfma_f32_16x16x32_bf16 v[120:123], a[24:27], a[120:123], v[120:123]
    s_mov_b32 s74, 0x40290000
    v_mul_u32_u24 v138, v252, v221
    v_and_b32 v139, v253, v221
    v_mfma_f32_16x16x32_bf16 v[124:127], a[36:39], a[120:123], v[124:127]
    s_mov_b32 s75, s74
    v_mul_u32_u24 v140, v252, v222
    v_and_b32 v141, v253, v222
    v_mfma_f32_16x16x32_bf16 v[128:131], a[48:51], a[120:123], v[128:131]
    s_mov_b32 s72, 0x3f91a2b4
    v_mul_u32_u24 v142, v252, v223
    v_and_b32 v143, v253, v223
    v_mfma_f32_16x16x32_bf16 v[132:135], a[60:63], a[120:123], v[132:135]
    s_waitcnt vmcnt(8) lgkmcnt(1)
    v_mul_u32_u24 v144, v252, v224
    v_and_b32 v145, v253, v224
    v_mfma_f32_16x16x32_bf16 v[112:115], a[4:7], a[124:127], v[112:115]
    buffer_load_dwordx4 a[160:163], v4, s[20:23], 0 offen offset:64
    v_mfma_f32_16x16x32_bf16 v[116:119], a[16:19], a[124:127], v[116:119]
    s_mov_b32 s73, s72
    v_mul_u32_u24 v146, v252, v225
    v_and_b32 v147, v253, v225
    v_mfma_f32_16x16x32_bf16 v[120:123], a[28:31], a[124:127], v[120:123]
    s_mov_b32 s76, 0x3f610000
    v_mul_u32_u24 v148, v252, v226
    v_and_b32 v149, v253, v226
    v_mfma_f32_16x16x32_bf16 v[124:127], a[40:43], a[124:127], v[124:127]
    s_mov_b32 s77, s76
    v_mul_u32_u24 v150, v252, v227
    v_and_b32 v151, v253, v227
    v_mfma_f32_16x16x32_bf16 v[128:131], a[52:55], a[124:127], v[128:131]
    s_mul_i32 s11, s19, 4224
    s_waitcnt lgkmcnt(0)
    v_mul_u32_u24 v152, v252, v228
    v_and_b32 v153, v253, v228
    v_mfma_f32_16x16x32_bf16 v[132:135], a[64:67], a[124:127], v[132:135]
    s_waitcnt vmcnt(8)
    v_mul_u32_u24 v154, v252, v229
    v_and_b32 v155, v253, v229
    v_mfma_f32_16x16x32_bf16 v[112:115], a[8:11], a[128:131], v[112:115]
    buffer_load_dwordx4 a[164:167], v4, s[20:23], 0 offen offset:128
    v_mfma_f32_16x16x32_bf16 v[116:119], a[20:23], a[128:131], v[116:119]
    s_mul_i32 s51, s18, 356352
    v_add_u32 v4, 43008, v4
    v_mul_u32_u24 v156, v252, v230
    v_mfma_f32_16x16x32_bf16 v[120:123], a[32:35], a[128:131], v[120:123]
    s_add_u32 s51, s51, 3072
    v_and_b32 v157, v253, v230
    v_mul_u32_u24 v158, v252, v231
    v_mfma_f32_16x16x32_bf16 v[124:127], a[44:47], a[128:131], v[124:127]
    v_and_b32 v159, v253, v231
    v_mfma_f32_16x16x32_bf16 v[128:131], a[56:59], a[128:131], v[128:131]
    v_mfma_f32_16x16x32_bf16 v[132:135], a[68:71], a[128:131], v[132:135]
    s_waitcnt vmcnt(8)
    v_mfma_f32_16x16x32_bf16 v[136:139], a[0:3], a[132:135], v[136:139]
    v_add_u32 v5, s7, v5
    v_add_u32 v6, s8, v6
    v_mfma_f32_16x16x32_bf16 v[140:143], a[12:15], a[132:135], v[140:143]
    ds_read_b128 v[208:211], v5 offset:6912
    ds_read_b128 v[212:215], v6 offset:6912
    v_mfma_f32_16x16x32_bf16 v[144:147], a[24:27], a[132:135], v[144:147]
    ds_read_b128 v[216:219], v5 offset:9216
    v_lshrrev_b32 v232, 1, v3
    v_mfma_f32_16x16x32_bf16 v[148:151], a[36:39], a[132:135], v[148:151]
    buffer_load_dwordx4 a[168:171], v4, s[20:23], 0 offen offset:0
    v_mfma_f32_16x16x32_bf16 v[152:155], a[48:51], a[132:135], v[152:155]
    v_mul_u32_u24 v232, 2112, v232
    v_and_b32 v233, 1, v3
    v_mfma_f32_16x16x32_bf16 v[156:159], a[60:63], a[132:135], v[156:159]
    s_waitcnt vmcnt(8)
    v_lshl_add_u32 v232, v233, 4, v232
    v_mul_u32_u24 v9, 96, v2
    v_mfma_f32_16x16x32_bf16 v[136:139], a[4:7], a[136:139], v[136:139]
    v_add3_u32 v9, v9, v232, s11
    v_add_u32 v10, 76032, v9
    v_mfma_f32_16x16x32_bf16 v[140:143], a[16:19], a[136:139], v[140:143]
    v_add_u32 v11, s51, v11
    v_mul_u32_u24 v8, 25344, v235
    v_mfma_f32_16x16x32_bf16 v[144:147], a[28:31], a[136:139], v[144:147]
    v_mul_u32_u24 v239, 96, v234
    v_add3_u32 v8, v8, v239, v232
    v_mfma_f32_16x16x32_bf16 v[148:151], a[40:43], a[136:139], v[148:151]
    buffer_load_dwordx4 a[172:175], v4, s[20:23], 0 offen offset:64
    v_mfma_f32_16x16x32_bf16 v[152:155], a[52:55], a[136:139], v[152:155]
    v_mfma_f32_16x16x32_bf16 v[156:159], a[64:67], a[136:139], v[156:159]
    s_waitcnt vmcnt(8)
    v_mfma_f32_16x16x32_bf16 v[136:139], a[8:11], a[140:143], v[136:139]
    v_mfma_f32_16x16x32_bf16 v[140:143], a[20:23], a[140:143], v[140:143]
    v_mfma_f32_16x16x32_bf16 v[144:147], a[32:35], a[140:143], v[144:147]
    v_mfma_f32_16x16x32_bf16 v[148:151], a[44:47], a[140:143], v[148:151]
    buffer_load_dwordx4 a[176:179], v4, s[20:23], 0 offen offset:128
    v_mfma_f32_16x16x32_bf16 v[152:155], a[56:59], a[140:143], v[152:155]
    v_add_u32 v4, s5, v4
    v_mfma_f32_16x16x32_bf16 v[156:159], a[68:71], a[140:143], v[156:159]
    s_cmp_eq_u32 s18, 1
    s_cbranch_scc1 L_REVB
.p2align 3
    v_pk_fma_f32 v[192:193], v[64:65], s[68:69], v[112:113] neg_lo:[0,1,0] neg_hi:[0,1,0]
    v_pk_fma_f32 v[194:195], v[66:67], s[68:69], v[114:115] neg_lo:[0,1,0] neg_hi:[0,1,0]
    v_pk_fma_f32 v[196:197], v[68:69], s[68:69], v[116:117] neg_lo:[0,1,0] neg_hi:[0,1,0]
    v_pk_fma_f32 v[198:199], v[70:71], s[68:69], v[118:119] neg_lo:[0,1,0] neg_hi:[0,1,0]
    v_pk_fma_f32 v[200:201], v[40:41], s[68:69], v[88:89] neg_lo:[0,1,0] neg_hi:[0,1,0]
    v_pk_fma_f32 v[202:203], v[42:43], s[68:69], v[90:91] neg_lo:[0,1,0] neg_hi:[0,1,0]
    v_pk_fma_f32 v[204:205], v[44:45], s[68:69], v[92:93] neg_lo:[0,1,0] neg_hi:[0,1,0]
    v_pk_fma_f32 v[206:207], v[46:47], s[68:69], v[94:95] neg_lo:[0,1,0] neg_hi:[0,1,0]
    v_pk_fma_f32 v[160:161], v[200:201], s[62:63], v[192:193]
    v_pk_fma_f32 v[162:163], v[202:203], s[62:63], v[194:195]
    v_pk_fma_f32 v[164:165], v[204:205], s[62:63], v[196:197]
    v_pk_fma_f32 v[166:167], v[206:207], s[62:63], v[198:199]
    v_pk_fma_f32 v[168:169], v[200:201], s[62:63], v[192:193] neg_lo:[0,1,0] neg_hi:[0,1,0]
    v_pk_fma_f32 v[170:171], v[202:203], s[62:63], v[194:195] neg_lo:[0,1,0] neg_hi:[0,1,0]
    v_pk_fma_f32 v[172:173], v[204:205], s[62:63], v[196:197] neg_lo:[0,1,0] neg_hi:[0,1,0]
    v_pk_fma_f32 v[174:175], v[206:207], s[62:63], v[198:199] neg_lo:[0,1,0] neg_hi:[0,1,0]
    v_pk_fma_f32 v[192:193], v[64:65], s[66:67], v[112:113] neg_lo:[0,1,0] neg_hi:[0,1,0]
    v_pk_fma_f32 v[194:195], v[66:67], s[66:67], v[114:115] neg_lo:[0,1,0] neg_hi:[0,1,0]
    v_pk_fma_f32 v[196:197], v[68:69], s[66:67], v[116:117] neg_lo:[0,1,0] neg_hi:[0,1,0]
    v_pk_fma_f32 v[198:199], v[70:71], s[66:67], v[118:119] neg_lo:[0,1,0] neg_hi:[0,1,0]
    v_pk_fma_f32 v[200:201], v[40:41], s[66:67], v[88:89] neg_lo:[0,1,0] neg_hi:[0,1,0]
    v_pk_fma_f32 v[202:203], v[42:43], s[66:67], v[90:91] neg_lo:[0,1,0] neg_hi:[0,1,0]
    v_pk_fma_f32 v[204:205], v[44:45], s[66:67], v[92:93] neg_lo:[0,1,0] neg_hi:[0,1,0]
    v_pk_fma_f32 v[206:207], v[46:47], s[66:67], v[94:95] neg_lo:[0,1,0] neg_hi:[0,1,0]
    buffer_load_dwordx4 a[180:183], v4, s[20:23], 0 offen offset:0
    buffer_load_dwordx4 a[184:187], v4, s[20:23], 0 offen offset:64
    buffer_load_dwordx4 a[188:191], v4, s[20:23], 0 offen offset:128
    v_add_u32 v4, 43008, v4
    v_pk_fma_f32 v[176:177], v[200:201], s[64:65], v[192:193]
    v_pk_fma_f32 v[178:179], v[202:203], s[64:65], v[194:195]
    v_pk_fma_f32 v[180:181], v[204:205], s[64:65], v[196:197]
    v_pk_fma_f32 v[182:183], v[206:207], s[64:65], v[198:199]
    v_pk_fma_f32 v[184:185], v[200:201], s[64:65], v[192:193] neg_lo:[0,1,0] neg_hi:[0,1,0]
    v_pk_fma_f32 v[186:187], v[202:203], s[64:65], v[194:195] neg_lo:[0,1,0] neg_hi:[0,1,0]
    v_pk_fma_f32 v[188:189], v[204:205], s[64:65], v[196:197] neg_lo:[0,1,0] neg_hi:[0,1,0]
    v_pk_fma_f32 v[190:191], v[206:207], s[64:65], v[198:199] neg_lo:[0,1,0] neg_hi:[0,1,0]
    v_pk_fma_f32 v[192:193], v[64:65], s[70:71], v[16:17] neg_lo:[0,1,0] neg_hi:[0,1,0]
    v_pk_fma_f32 v[194:195], v[66:67], s[70:71], v[18:19] neg_lo:[0,1,0] neg_hi:[0,1,0]
    v_pk_fma_f32 v[196:197], v[68:69], s[70:71], v[20:21] neg_lo:[0,1,0] neg_hi:[0,1,0]
    v_pk_fma_f32 v[198:199], v[70:71], s[70:71], v[22:23] neg_lo:[0,1,0] neg_hi:[0,1,0]
    v_pk_fma_f32 v[200:201], v[88:89], s[74:75], v[136:137] neg_lo:[0,1,0] neg_hi:[0,1,0]
    v_pk_fma_f32 v[202:203], v[90:91], s[74:75], v[138:139] neg_lo:[0,1,0] neg_hi:[0,1,0]
    v_pk_fma_f32 v[204:205], v[92:93], s[74:75], v[140:141] neg_lo:[0,1,0] neg_hi:[0,1,0]
    v_pk_fma_f32 v[206:207], v[94:95], s[74:75], v[142:143] neg_lo:[0,1,0] neg_hi:[0,1,0]
    v_pk_fma_f32 v[192:193], v[112:113], s[72:73], v[192:193]
    v_pk_fma_f32 v[194:195], v[114:115], s[72:73], v[194:195]
    v_pk_fma_f32 v[196:197], v[116:117], s[72:73], v[196:197]
    v_pk_fma_f32 v[198:199], v[118:119], s[72:73], v[198:199]
    v_pk_fma_f32 v[200:201], v[40:41], s[76:77], v[200:201]
    v_pk_fma_f32 v[202:203], v[42:43], s[76:77], v[202:203]
    v_pk_fma_f32 v[204:205], v[44:45], s[76:77], v[204:205]
    v_pk_fma_f32 v[206:207], v[46:47], s[76:77], v[206:207]
    s_waitcnt lgkmcnt(2)
    v_mul_u32_u24 v16, v252, v208
    v_and_b32 v17, v253, v208
    v_mul_u32_u24 v18, v252, v209
    v_and_b32 v19, v253, v209
    v_mul_u32_u24 v20, v252, v210
    v_and_b32 v21, v253, v210
    v_mul_u32_u24 v22, v252, v211
    v_and_b32 v23, v253, v211
    s_waitcnt lgkmcnt(1)
    v_mul_u32_u24 v40, v252, v212
    v_and_b32 v41, v253, v212
    v_mul_u32_u24 v42, v252, v213
    v_and_b32 v43, v253, v213
    v_mul_u32_u24 v44, v252, v214
    v_and_b32 v45, v253, v214
    v_mul_u32_u24 v46, v252, v215
    v_and_b32 v47, v253, v215
    s_waitcnt lgkmcnt(0)
    v_mul_u32_u24 v64, v252, v216
    v_and_b32 v65, v253, v216
    v_mul_u32_u24 v66, v252, v217
    v_and_b32 v67, v253, v217
    v_mul_u32_u24 v68, v252, v218
    v_and_b32 v69, v253, v218
    v_mul_u32_u24 v70, v252, v219
    v_and_b32 v71, v253, v219
    ds_read_b128 v[220:223], v5 offset:6976
    ds_read_b128 v[224:227], v6 offset:6976
    ds_read_b128 v[228:231], v5 offset:9280
    s_waitcnt vmcnt(11)
    v_mfma_f32_16x16x32_bf16 v[16:19], a[0:3], a[144:147], v[16:19]
    v_cvt_pk_bf16_f32 v192, v192, v193
    v_cvt_pk_bf16_f32 v193, v194, v195
    v_mfma_f32_16x16x32_bf16 v[20:23], a[12:15], a[144:147], v[20:23]
    s_waitcnt vmcnt(8)
    v_cvt_pk_bf16_f32 v194, v196, v197
    v_cvt_pk_bf16_f32 v195, v198, v199
    v_mfma_f32_16x16x32_bf16 v[40:43], a[0:3], a[156:159], v[40:43]
    ds_write_b128 v8, v[192:195] offset:16896
    v_mfma_f32_16x16x32_bf16 v[44:47], a[12:15], a[156:159], v[44:47]
    s_waitcnt vmcnt(5)
    v_cvt_pk_bf16_f32 v200, v200, v201
    v_cvt_pk_bf16_f32 v201, v202, v203
    v_mfma_f32_16x16x32_bf16 v[64:67], a[0:3], a[168:171], v[64:67]
    v_cvt_pk_bf16_f32 v202, v204, v205
    v_cvt_pk_bf16_f32 v203, v206, v207
    v_mfma_f32_16x16x32_bf16 v[68:71], a[12:15], a[168:171], v[68:71]
    ds_write_b128 v8, v[200:203] offset:21120
    v_mfma_f32_16x16x32_bf16 v[16:19], a[4:7], a[148:151], v[16:19]
    v_cvt_pk_bf16_f32 v160, v160, v161
    v_cvt_pk_bf16_f32 v161, v162, v163
    v_mfma_f32_16x16x32_bf16 v[20:23], a[16:19], a[148:151], v[20:23]
    v_cvt_pk_bf16_f32 v162, v164, v165
    v_cvt_pk_bf16_f32 v163, v166, v167
    v_mfma_f32_16x16x32_bf16 v[40:43], a[4:7], a[160:163], v[40:43]
    ds_write_b128 v8, v[160:163] offset:0
    v_mfma_f32_16x16x32_bf16 v[44:47], a[16:19], a[160:163], v[44:47]
    s_waitcnt vmcnt(4)
    v_cvt_pk_bf16_f32 v168, v168, v169
    v_cvt_pk_bf16_f32 v169, v170, v171
    v_mfma_f32_16x16x32_bf16 v[64:67], a[4:7], a[172:175], v[64:67]
    v_cvt_pk_bf16_f32 v170, v172, v173
    v_cvt_pk_bf16_f32 v171, v174, v175
    v_mfma_f32_16x16x32_bf16 v[68:71], a[16:19], a[172:175], v[68:71]
    ds_write_b128 v8, v[168:171] offset:4224
    v_mfma_f32_16x16x32_bf16 v[16:19], a[8:11], a[152:155], v[16:19]
    v_cvt_pk_bf16_f32 v176, v176, v177
    v_cvt_pk_bf16_f32 v177, v178, v179
    v_mfma_f32_16x16x32_bf16 v[20:23], a[20:23], a[152:155], v[20:23]
    v_cvt_pk_bf16_f32 v178, v180, v181
    v_cvt_pk_bf16_f32 v179, v182, v183
    v_mfma_f32_16x16x32_bf16 v[40:43], a[8:11], a[164:167], v[40:43]
    ds_write_b128 v8, v[176:179] offset:8448
    v_mfma_f32_16x16x32_bf16 v[44:47], a[20:23], a[164:167], v[44:47]
    s_waitcnt vmcnt(3)
    v_cvt_pk_bf16_f32 v184, v184, v185
    v_cvt_pk_bf16_f32 v185, v186, v187
    v_mfma_f32_16x16x32_bf16 v[64:67], a[8:11], a[176:179], v[64:67]
    v_cvt_pk_bf16_f32 v186, v188, v189
    v_cvt_pk_bf16_f32 v187, v190, v191
    v_mfma_f32_16x16x32_bf16 v[68:71], a[20:23], a[176:179], v[68:71]
    ds_write_b128 v8, v[184:187] offset:12672
.p2align 3
    v_pk_fma_f32 v[192:193], v[72:73], s[68:69], v[120:121] neg_lo:[0,1,0] neg_hi:[0,1,0]
    v_pk_fma_f32 v[194:195], v[74:75], s[68:69], v[122:123] neg_lo:[0,1,0] neg_hi:[0,1,0]
    v_pk_fma_f32 v[196:197], v[76:77], s[68:69], v[124:125] neg_lo:[0,1,0] neg_hi:[0,1,0]
    v_pk_fma_f32 v[198:199], v[78:79], s[68:69], v[126:127] neg_lo:[0,1,0] neg_hi:[0,1,0]
    v_pk_fma_f32 v[200:201], v[48:49], s[68:69], v[96:97] neg_lo:[0,1,0] neg_hi:[0,1,0]
    v_pk_fma_f32 v[202:203], v[50:51], s[68:69], v[98:99] neg_lo:[0,1,0] neg_hi:[0,1,0]
    v_pk_fma_f32 v[204:205], v[52:53], s[68:69], v[100:101] neg_lo:[0,1,0] neg_hi:[0,1,0]
    v_pk_fma_f32 v[206:207], v[54:55], s[68:69], v[102:103] neg_lo:[0,1,0] neg_hi:[0,1,0]
    v_pk_fma_f32 v[160:161], v[200:201], s[62:63], v[192:193]
    v_pk_fma_f32 v[162:163], v[202:203], s[62:63], v[194:195]
    v_pk_fma_f32 v[164:165], v[204:205], s[62:63], v[196:197]
    v_pk_fma_f32 v[166:167], v[206:207], s[62:63], v[198:199]
    v_pk_fma_f32 v[168:169], v[200:201], s[62:63], v[192:193] neg_lo:[0,1,0] neg_hi:[0,1,0]
    v_pk_fma_f32 v[170:171], v[202:203], s[62:63], v[194:195] neg_lo:[0,1,0] neg_hi:[0,1,0]
    v_pk_fma_f32 v[172:173], v[204:205], s[62:63], v[196:197] neg_lo:[0,1,0] neg_hi:[0,1,0]
    v_pk_fma_f32 v[174:175], v[206:207], s[62:63], v[198:199] neg_lo:[0,1,0] neg_hi:[0,1,0]
    v_pk_fma_f32 v[192:193], v[72:73], s[66:67], v[120:121] neg_lo:[0,1,0] neg_hi:[0,1,0]
    v_pk_fma_f32 v[194:195], v[74:75], s[66:67], v[122:123] neg_lo:[0,1,0] neg_hi:[0,1,0]
    v_pk_fma_f32 v[196:197], v[76:77], s[66:67], v[124:125] neg_lo:[0,1,0] neg_hi:[0,1,0]
    v_pk_fma_f32 v[198:199], v[78:79], s[66:67], v[126:127] neg_lo:[0,1,0] neg_hi:[0,1,0]
    v_pk_fma_f32 v[200:201], v[48:49], s[66:67], v[96:97] neg_lo:[0,1,0] neg_hi:[0,1,0]
    v_pk_fma_f32 v[202:203], v[50:51], s[66:67], v[98:99] neg_lo:[0,1,0] neg_hi:[0,1,0]
    v_pk_fma_f32 v[204:205], v[52:53], s[66:67], v[100:101] neg_lo:[0,1,0] neg_hi:[0,1,0]
    v_pk_fma_f32 v[206:207], v[54:55], s[66:67], v[102:103] neg_lo:[0,1,0] neg_hi:[0,1,0]
    buffer_load_dwordx4 a[192:195], v4, s[20:23], 0 offen offset:0
    buffer_load_dwordx4 a[196:199], v4, s[20:23], 0 offen offset:64
    buffer_load_dwordx4 a[200:203], v4, s[20:23], 0 offen offset:128
    v_add_u32 v4, 43008, v4
    v_pk_fma_f32 v[176:177], v[200:201], s[64:65], v[192:193]
    v_pk_fma_f32 v[178:179], v[202:203], s[64:65], v[194:195]
    v_pk_fma_f32 v[180:181], v[204:205], s[64:65], v[196:197]
    v_pk_fma_f32 v[182:183], v[206:207], s[64:65], v[198:199]
    v_pk_fma_f32 v[184:185], v[200:201], s[64:65], v[192:193] neg_lo:[0,1,0] neg_hi:[0,1,0]
    v_pk_fma_f32 v[186:187], v[202:203], s[64:65], v[194:195] neg_lo:[0,1,0] neg_hi:[0,1,0]
    v_pk_fma_f32 v[188:189], v[204:205], s[64:65], v[196:197] neg_lo:[0,1,0] neg_hi:[0,1,0]
    v_pk_fma_f32 v[190:191], v[206:207], s[64:65], v[198:199] neg_lo:[0,1,0] neg_hi:[0,1,0]
    v_pk_fma_f32 v[192:193], v[72:73], s[70:71], v[24:25] neg_lo:[0,1,0] neg_hi:[0,1,0]
    v_pk_fma_f32 v[194:195], v[74:75], s[70:71], v[26:27] neg_lo:[0,1,0] neg_hi:[0,1,0]
    v_pk_fma_f32 v[196:197], v[76:77], s[70:71], v[28:29] neg_lo:[0,1,0] neg_hi:[0,1,0]
    v_pk_fma_f32 v[198:199], v[78:79], s[70:71], v[30:31] neg_lo:[0,1,0] neg_hi:[0,1,0]
    v_pk_fma_f32 v[200:201], v[96:97], s[74:75], v[144:145] neg_lo:[0,1,0] neg_hi:[0,1,0]
    v_pk_fma_f32 v[202:203], v[98:99], s[74:75], v[146:147] neg_lo:[0,1,0] neg_hi:[0,1,0]
    v_pk_fma_f32 v[204:205], v[100:101], s[74:75], v[148:149] neg_lo:[0,1,0] neg_hi:[0,1,0]
    v_pk_fma_f32 v[206:207], v[102:103], s[74:75], v[150:151] neg_lo:[0,1,0] neg_hi:[0,1,0]
    v_pk_fma_f32 v[192:193], v[120:121], s[72:73], v[192:193]
    v_pk_fma_f32 v[194:195], v[122:123], s[72:73], v[194:195]
    v_pk_fma_f32 v[196:197], v[124:125], s[72:73], v[196:197]
    v_pk_fma_f32 v[198:199], v[126:127], s[72:73], v[198:199]
    v_pk_fma_f32 v[200:201], v[48:49], s[76:77], v[200:201]
    v_pk_fma_f32 v[202:203], v[50:51], s[76:77], v[202:203]
    v_pk_fma_f32 v[204:205], v[52:53], s[76:77], v[204:205]
    v_pk_fma_f32 v[206:207], v[54:55], s[76:77], v[206:207]
    s_waitcnt lgkmcnt(8)
    v_mul_u32_u24 v24, v252, v220
    v_and_b32 v25, v253, v220
    v_mul_u32_u24 v26, v252, v221
    v_and_b32 v27, v253, v221
    v_mul_u32_u24 v28, v252, v222
    v_and_b32 v29, v253, v222
    v_mul_u32_u24 v30, v252, v223
    v_and_b32 v31, v253, v223
    s_waitcnt lgkmcnt(7)
    v_mul_u32_u24 v48, v252, v224
    v_and_b32 v49, v253, v224
    v_mul_u32_u24 v50, v252, v225
    v_and_b32 v51, v253, v225
    v_mul_u32_u24 v52, v252, v226
    v_and_b32 v53, v253, v226
    v_mul_u32_u24 v54, v252, v227
    v_and_b32 v55, v253, v227
    s_waitcnt lgkmcnt(6)
    v_mul_u32_u24 v72, v252, v228
    v_and_b32 v73, v253, v228
    v_mul_u32_u24 v74, v252, v229
    v_and_b32 v75, v253, v229
    v_mul_u32_u24 v76, v252, v230
    v_and_b32 v77, v253, v230
    v_mul_u32_u24 v78, v252, v231
    v_and_b32 v79, v253, v231
    ds_read_b128 v[208:211], v5 offset:7040
    ds_read_b128 v[212:215], v6 offset:7040
    ds_read_b128 v[216:219], v5 offset:9344
    v_mfma_f32_16x16x32_bf16 v[24:27], a[24:27], a[144:147], v[24:27]
    v_cvt_pk_bf16_f32 v192, v192, v193
    v_cvt_pk_bf16_f32 v193, v194, v195
    v_mfma_f32_16x16x32_bf16 v[28:31], a[36:39], a[144:147], v[28:31]
    v_cvt_pk_bf16_f32 v194, v196, v197
    v_cvt_pk_bf16_f32 v195, v198, v199
    v_mfma_f32_16x16x32_bf16 v[48:51], a[24:27], a[156:159], v[48:51]
    ds_write_b128 v8, v[192:195] offset:16928
    v_mfma_f32_16x16x32_bf16 v[52:55], a[36:39], a[156:159], v[52:55]
    v_cvt_pk_bf16_f32 v200, v200, v201
    v_cvt_pk_bf16_f32 v201, v202, v203
    v_mfma_f32_16x16x32_bf16 v[72:75], a[24:27], a[168:171], v[72:75]
    v_cvt_pk_bf16_f32 v202, v204, v205
    v_cvt_pk_bf16_f32 v203, v206, v207
    v_mfma_f32_16x16x32_bf16 v[76:79], a[36:39], a[168:171], v[76:79]
    ds_write_b128 v8, v[200:203] offset:21152
    v_mfma_f32_16x16x32_bf16 v[24:27], a[28:31], a[148:151], v[24:27]
    v_cvt_pk_bf16_f32 v160, v160, v161
    v_cvt_pk_bf16_f32 v161, v162, v163
    v_mfma_f32_16x16x32_bf16 v[28:31], a[40:43], a[148:151], v[28:31]
    v_cvt_pk_bf16_f32 v162, v164, v165
    v_cvt_pk_bf16_f32 v163, v166, v167
    v_mfma_f32_16x16x32_bf16 v[48:51], a[28:31], a[160:163], v[48:51]
    ds_write_b128 v8, v[160:163] offset:32
    v_mfma_f32_16x16x32_bf16 v[52:55], a[40:43], a[160:163], v[52:55]
    v_cvt_pk_bf16_f32 v168, v168, v169
    v_cvt_pk_bf16_f32 v169, v170, v171
    v_mfma_f32_16x16x32_bf16 v[72:75], a[28:31], a[172:175], v[72:75]
    v_cvt_pk_bf16_f32 v170, v172, v173
    v_cvt_pk_bf16_f32 v171, v174, v175
    v_mfma_f32_16x16x32_bf16 v[76:79], a[40:43], a[172:175], v[76:79]
    ds_write_b128 v8, v[168:171] offset:4256
    v_mfma_f32_16x16x32_bf16 v[24:27], a[32:35], a[152:155], v[24:27]
    v_cvt_pk_bf16_f32 v176, v176, v177
    v_cvt_pk_bf16_f32 v177, v178, v179
    v_mfma_f32_16x16x32_bf16 v[28:31], a[44:47], a[152:155], v[28:31]
    v_cvt_pk_bf16_f32 v178, v180, v181
    v_cvt_pk_bf16_f32 v179, v182, v183
    v_mfma_f32_16x16x32_bf16 v[48:51], a[32:35], a[164:167], v[48:51]
    ds_write_b128 v8, v[176:179] offset:8480
    v_mfma_f32_16x16x32_bf16 v[52:55], a[44:47], a[164:167], v[52:55]
    v_cvt_pk_bf16_f32 v184, v184, v185
    v_cvt_pk_bf16_f32 v185, v186, v187
    v_mfma_f32_16x16x32_bf16 v[72:75], a[32:35], a[176:179], v[72:75]
    v_cvt_pk_bf16_f32 v186, v188, v189
    v_cvt_pk_bf16_f32 v187, v190, v191
    v_mfma_f32_16x16x32_bf16 v[76:79], a[44:47], a[176:179], v[76:79]
    ds_write_b128 v8, v[184:187] offset:12704
.p2align 3
    v_pk_fma_f32 v[192:193], v[80:81], s[68:69], v[128:129] neg_lo:[0,1,0] neg_hi:[0,1,0]
    v_pk_fma_f32 v[194:195], v[82:83], s[68:69], v[130:131] neg_lo:[0,1,0] neg_hi:[0,1,0]
    v_pk_fma_f32 v[196:197], v[84:85], s[68:69], v[132:133] neg_lo:[0,1,0] neg_hi:[0,1,0]
    v_pk_fma_f32 v[198:199], v[86:87], s[68:69], v[134:135] neg_lo:[0,1,0] neg_hi:[0,1,0]
    v_pk_fma_f32 v[200:201], v[56:57], s[68:69], v[104:105] neg_lo:[0,1,0] neg_hi:[0,1,0]
    v_pk_fma_f32 v[202:203], v[58:59], s[68:69], v[106:107] neg_lo:[0,1,0] neg_hi:[0,1,0]
    v_pk_fma_f32 v[204:205], v[60:61], s[68:69], v[108:109] neg_lo:[0,1,0] neg_hi:[0,1,0]
    v_pk_fma_f32 v[206:207], v[62:63], s[68:69], v[110:111] neg_lo:[0,1,0] neg_hi:[0,1,0]
    v_pk_fma_f32 v[160:161], v[200:201], s[62:63], v[192:193]
    v_pk_fma_f32 v[162:163], v[202:203], s[62:63], v[194:195]
    v_pk_fma_f32 v[164:165], v[204:205], s[62:63], v[196:197]
    v_pk_fma_f32 v[166:167], v[206:207], s[62:63], v[198:199]
    v_pk_fma_f32 v[168:169], v[200:201], s[62:63], v[192:193] neg_lo:[0,1,0] neg_hi:[0,1,0]
    v_pk_fma_f32 v[170:171], v[202:203], s[62:63], v[194:195] neg_lo:[0,1,0] neg_hi:[0,1,0]
    v_pk_fma_f32 v[172:173], v[204:205], s[62:63], v[196:197] neg_lo:[0,1,0] neg_hi:[0,1,0]
    v_pk_fma_f32 v[174:175], v[206:207], s[62:63], v[198:199] neg_lo:[0,1,0] neg_hi:[0,1,0]
    v_pk_fma_f32 v[192:193], v[80:81], s[66:67], v[128:129] neg_lo:[0,1,0] neg_hi:[0,1,0]
    v_pk_fma_f32 v[194:195], v[82:83], s[66:67], v[130:131] neg_lo:[0,1,0] neg_hi:[0,1,0]
    v_pk_fma_f32 v[196:197], v[84:85], s[66:67], v[132:133] neg_lo:[0,1,0] neg_hi:[0,1,0]
    v_pk_fma_f32 v[198:199], v[86:87], s[66:67], v[134:135] neg_lo:[0,1,0] neg_hi:[0,1,0]
    v_pk_fma_f32 v[200:201], v[56:57], s[66:67], v[104:105] neg_lo:[0,1,0] neg_hi:[0,1,0]
    v_pk_fma_f32 v[202:203], v[58:59], s[66:67], v[106:107] neg_lo:[0,1,0] neg_hi:[0,1,0]
    v_pk_fma_f32 v[204:205], v[60:61], s[66:67], v[108:109] neg_lo:[0,1,0] neg_hi:[0,1,0]
    v_pk_fma_f32 v[206:207], v[62:63], s[66:67], v[110:111] neg_lo:[0,1,0] neg_hi:[0,1,0]
    buffer_load_dwordx4 a[204:207], v4, s[20:23], 0 offen offset:0
    buffer_load_dwordx4 a[208:211], v4, s[20:23], 0 offen offset:64
    buffer_load_dwordx4 a[212:215], v4, s[20:23], 0 offen offset:128
    v_add_u32 v4, 43008, v4
    v_pk_fma_f32 v[176:177], v[200:201], s[64:65], v[192:193]
    v_pk_fma_f32 v[178:179], v[202:203], s[64:65], v[194:195]
    v_pk_fma_f32 v[180:181], v[204:205], s[64:65], v[196:197]
    v_pk_fma_f32 v[182:183], v[206:207], s[64:65], v[198:199]
    v_pk_fma_f32 v[184:185], v[200:201], s[64:65], v[192:193] neg_lo:[0,1,0] neg_hi:[0,1,0]
    v_pk_fma_f32 v[186:187], v[202:203], s[64:65], v[194:195] neg_lo:[0,1,0] neg_hi:[0,1,0]
    v_pk_fma_f32 v[188:189], v[204:205], s[64:65], v[196:197] neg_lo:[0,1,0] neg_hi:[0,1,0]
    v_pk_fma_f32 v[190:191], v[206:207], s[64:65], v[198:199] neg_lo:[0,1,0] neg_hi:[0,1,0]
    v_pk_fma_f32 v[192:193], v[80:81], s[70:71], v[32:33] neg_lo:[0,1,0] neg_hi:[0,1,0]
    v_pk_fma_f32 v[194:195], v[82:83], s[70:71], v[34:35] neg_lo:[0,1,0] neg_hi:[0,1,0]
    v_pk_fma_f32 v[196:197], v[84:85], s[70:71], v[36:37] neg_lo:[0,1,0] neg_hi:[0,1,0]
    v_pk_fma_f32 v[198:199], v[86:87], s[70:71], v[38:39] neg_lo:[0,1,0] neg_hi:[0,1,0]
    v_pk_fma_f32 v[200:201], v[104:105], s[74:75], v[152:153] neg_lo:[0,1,0] neg_hi:[0,1,0]
    v_pk_fma_f32 v[202:203], v[106:107], s[74:75], v[154:155] neg_lo:[0,1,0] neg_hi:[0,1,0]
    v_pk_fma_f32 v[204:205], v[108:109], s[74:75], v[156:157] neg_lo:[0,1,0] neg_hi:[0,1,0]
    v_pk_fma_f32 v[206:207], v[110:111], s[74:75], v[158:159] neg_lo:[0,1,0] neg_hi:[0,1,0]
    v_pk_fma_f32 v[192:193], v[128:129], s[72:73], v[192:193]
    v_pk_fma_f32 v[194:195], v[130:131], s[72:73], v[194:195]
    v_pk_fma_f32 v[196:197], v[132:133], s[72:73], v[196:197]
    v_pk_fma_f32 v[198:199], v[134:135], s[72:73], v[198:199]
    v_pk_fma_f32 v[200:201], v[56:57], s[76:77], v[200:201]
    v_pk_fma_f32 v[202:203], v[58:59], s[76:77], v[202:203]
    v_pk_fma_f32 v[204:205], v[60:61], s[76:77], v[204:205]
    v_pk_fma_f32 v[206:207], v[62:63], s[76:77], v[206:207]
    s_waitcnt lgkmcnt(8)
    v_mul_u32_u24 v32, v252, v208
    v_and_b32 v33, v253, v208
    v_mul_u32_u24 v34, v252, v209
    v_and_b32 v35, v253, v209
    v_mul_u32_u24 v36, v252, v210
    v_and_b32 v37, v253, v210
    v_mul_u32_u24 v38, v252, v211
    v_and_b32 v39, v253, v211
    s_waitcnt lgkmcnt(7)
    v_mul_u32_u24 v56, v252, v212
    v_and_b32 v57, v253, v212
    v_mul_u32_u24 v58, v252, v213
    v_and_b32 v59, v253, v213
    v_mul_u32_u24 v60, v252, v214
    v_and_b32 v61, v253, v214
    v_mul_u32_u24 v62, v252, v215
    v_and_b32 v63, v253, v215
    s_waitcnt lgkmcnt(6)
    v_mul_u32_u24 v80, v252, v216
    v_and_b32 v81, v253, v216
    v_mul_u32_u24 v82, v252, v217
    v_and_b32 v83, v253, v217
    v_mul_u32_u24 v84, v252, v218
    v_and_b32 v85, v253, v218
    v_mul_u32_u24 v86, v252, v219
    v_and_b32 v87, v253, v219
    v_add_u32 v5, s9, v5
    v_add_u32 v6, s9, v6
    ds_read_b128 v[220:223], v6 offset:9216
    ds_read_b128 v[224:227], v5 offset:11520
    ds_read_b128 v[228:231], v6 offset:11520
    v_mfma_f32_16x16x32_bf16 v[32:35], a[48:51], a[144:147], v[32:35]
    v_cvt_pk_bf16_f32 v192, v192, v193
    v_cvt_pk_bf16_f32 v193, v194, v195
    v_mfma_f32_16x16x32_bf16 v[36:39], a[60:63], a[144:147], v[36:39]
    v_cvt_pk_bf16_f32 v194, v196, v197
    v_cvt_pk_bf16_f32 v195, v198, v199
    v_mfma_f32_16x16x32_bf16 v[56:59], a[48:51], a[156:159], v[56:59]
    ds_write_b128 v8, v[192:195] offset:16960
    v_mfma_f32_16x16x32_bf16 v[60:63], a[60:63], a[156:159], v[60:63]
    v_cvt_pk_bf16_f32 v200, v200, v201
    v_cvt_pk_bf16_f32 v201, v202, v203
    v_mfma_f32_16x16x32_bf16 v[80:83], a[48:51], a[168:171], v[80:83]
    v_cvt_pk_bf16_f32 v202, v204, v205
    v_cvt_pk_bf16_f32 v203, v206, v207
    v_mfma_f32_16x16x32_bf16 v[84:87], a[60:63], a[168:171], v[84:87]
    ds_write_b128 v8, v[200:203] offset:21184
    v_mfma_f32_16x16x32_bf16 v[32:35], a[52:55], a[148:151], v[32:35]
    v_cvt_pk_bf16_f32 v160, v160, v161
    v_cvt_pk_bf16_f32 v161, v162, v163
    v_mfma_f32_16x16x32_bf16 v[36:39], a[64:67], a[148:151], v[36:39]
    v_cvt_pk_bf16_f32 v162, v164, v165
    v_cvt_pk_bf16_f32 v163, v166, v167
    v_mfma_f32_16x16x32_bf16 v[56:59], a[52:55], a[160:163], v[56:59]
    ds_write_b128 v8, v[160:163] offset:64
    v_mfma_f32_16x16x32_bf16 v[60:63], a[64:67], a[160:163], v[60:63]
    v_cvt_pk_bf16_f32 v168, v168, v169
    v_cvt_pk_bf16_f32 v169, v170, v171
    v_mfma_f32_16x16x32_bf16 v[80:83], a[52:55], a[172:175], v[80:83]
    v_cvt_pk_bf16_f32 v170, v172, v173
    v_cvt_pk_bf16_f32 v171, v174, v175
    v_mfma_f32_16x16x32_bf16 v[84:87], a[64:67], a[172:175], v[84:87]
    ds_write_b128 v8, v[168:171] offset:4288
    v_mfma_f32_16x16x32_bf16 v[32:35], a[56:59], a[152:155], v[32:35]
    v_cvt_pk_bf16_f32 v176, v176, v177
    v_cvt_pk_bf16_f32 v177, v178, v179
    v_mfma_f32_16x16x32_bf16 v[36:39], a[68:71], a[152:155], v[36:39]
    v_cvt_pk_bf16_f32 v178, v180, v181
    v_cvt_pk_bf16_f32 v179, v182, v183
    v_mfma_f32_16x16x32_bf16 v[56:59], a[56:59], a[164:167], v[56:59]
    ds_write_b128 v8, v[176:179] offset:8512
    v_mfma_f32_16x16x32_bf16 v[60:63], a[68:71], a[164:167], v[60:63]
    v_cvt_pk_bf16_f32 v184, v184, v185
    v_cvt_pk_bf16_f32 v185, v186, v187
    v_mfma_f32_16x16x32_bf16 v[80:83], a[56:59], a[176:179], v[80:83]
    v_cvt_pk_bf16_f32 v186, v188, v189
    v_cvt_pk_bf16_f32 v187, v190, v191
    v_mfma_f32_16x16x32_bf16 v[84:87], a[68:71], a[176:179], v[84:87]
    ds_write_b128 v8, v[184:187] offset:12736
    v_add_u32 v8, s6, v8
.p2align 3
    v_pk_fma_f32 v[192:193], v[136:137], s[68:69], v[40:41] neg_lo:[0,1,0] neg_hi:[0,1,0]
    v_pk_fma_f32 v[194:195], v[138:139], s[68:69], v[42:43] neg_lo:[0,1,0] neg_hi:[0,1,0]
    v_pk_fma_f32 v[196:197], v[140:141], s[68:69], v[44:45] neg_lo:[0,1,0] neg_hi:[0,1,0]
    v_pk_fma_f32 v[198:199], v[142:143], s[68:69], v[46:47] neg_lo:[0,1,0] neg_hi:[0,1,0]
    v_pk_fma_f32 v[200:201], v[112:113], s[68:69], v[16:17] neg_lo:[0,1,0] neg_hi:[0,1,0]
    v_pk_fma_f32 v[202:203], v[114:115], s[68:69], v[18:19] neg_lo:[0,1,0] neg_hi:[0,1,0]
    v_pk_fma_f32 v[204:205], v[116:117], s[68:69], v[20:21] neg_lo:[0,1,0] neg_hi:[0,1,0]
    v_pk_fma_f32 v[206:207], v[118:119], s[68:69], v[22:23] neg_lo:[0,1,0] neg_hi:[0,1,0]
    v_pk_fma_f32 v[160:161], v[200:201], s[62:63], v[192:193]
    v_pk_fma_f32 v[162:163], v[202:203], s[62:63], v[194:195]
    v_pk_fma_f32 v[164:165], v[204:205], s[62:63], v[196:197]
    v_pk_fma_f32 v[166:167], v[206:207], s[62:63], v[198:199]
    v_pk_fma_f32 v[168:169], v[200:201], s[62:63], v[192:193] neg_lo:[0,1,0] neg_hi:[0,1,0]
    v_pk_fma_f32 v[170:171], v[202:203], s[62:63], v[194:195] neg_lo:[0,1,0] neg_hi:[0,1,0]
    v_pk_fma_f32 v[172:173], v[204:205], s[62:63], v[196:197] neg_lo:[0,1,0] neg_hi:[0,1,0]
    v_pk_fma_f32 v[174:175], v[206:207], s[62:63], v[198:199] neg_lo:[0,1,0] neg_hi:[0,1,0]
    v_pk_fma_f32 v[192:193], v[136:137], s[66:67], v[40:41] neg_lo:[0,1,0] neg_hi:[0,1,0]
    v_pk_fma_f32 v[194:195], v[138:139], s[66:67], v[42:43] neg_lo:[0,1,0] neg_hi:[0,1,0]
    v_pk_fma_f32 v[196:197], v[140:141], s[66:67], v[44:45] neg_lo:[0,1,0] neg_hi:[0,1,0]
    v_pk_fma_f32 v[198:199], v[142:143], s[66:67], v[46:47] neg_lo:[0,1,0] neg_hi:[0,1,0]
    v_pk_fma_f32 v[200:201], v[112:113], s[66:67], v[16:17] neg_lo:[0,1,0] neg_hi:[0,1,0]
    v_pk_fma_f32 v[202:203], v[114:115], s[66:67], v[18:19] neg_lo:[0,1,0] neg_hi:[0,1,0]
    v_pk_fma_f32 v[204:205], v[116:117], s[66:67], v[20:21] neg_lo:[0,1,0] neg_hi:[0,1,0]
    v_pk_fma_f32 v[206:207], v[118:119], s[66:67], v[22:23] neg_lo:[0,1,0] neg_hi:[0,1,0]
    v_pk_fma_f32 v[176:177], v[200:201], s[64:65], v[192:193]
    v_pk_fma_f32 v[178:179], v[202:203], s[64:65], v[194:195]
    v_pk_fma_f32 v[180:181], v[204:205], s[64:65], v[196:197]
    v_pk_fma_f32 v[182:183], v[206:207], s[64:65], v[198:199]
    v_pk_fma_f32 v[184:185], v[200:201], s[64:65], v[192:193] neg_lo:[0,1,0] neg_hi:[0,1,0]
    v_pk_fma_f32 v[186:187], v[202:203], s[64:65], v[194:195] neg_lo:[0,1,0] neg_hi:[0,1,0]
    v_pk_fma_f32 v[188:189], v[204:205], s[64:65], v[196:197] neg_lo:[0,1,0] neg_hi:[0,1,0]
    v_pk_fma_f32 v[190:191], v[206:207], s[64:65], v[198:199] neg_lo:[0,1,0] neg_hi:[0,1,0]
    v_pk_fma_f32 v[192:193], v[136:137], s[70:71], v[88:89] neg_lo:[0,1,0] neg_hi:[0,1,0]
    v_pk_fma_f32 v[194:195], v[138:139], s[70:71], v[90:91] neg_lo:[0,1,0] neg_hi:[0,1,0]
    v_pk_fma_f32 v[196:197], v[140:141], s[70:71], v[92:93] neg_lo:[0,1,0] neg_hi:[0,1,0]
    v_pk_fma_f32 v[198:199], v[142:143], s[70:71], v[94:95] neg_lo:[0,1,0] neg_hi:[0,1,0]
    v_pk_fma_f32 v[200:201], v[16:17], s[74:75], v[64:65] neg_lo:[0,1,0] neg_hi:[0,1,0]
    v_pk_fma_f32 v[202:203], v[18:19], s[74:75], v[66:67] neg_lo:[0,1,0] neg_hi:[0,1,0]
    v_pk_fma_f32 v[204:205], v[20:21], s[74:75], v[68:69] neg_lo:[0,1,0] neg_hi:[0,1,0]
    v_pk_fma_f32 v[206:207], v[22:23], s[74:75], v[70:71] neg_lo:[0,1,0] neg_hi:[0,1,0]
    v_pk_fma_f32 v[192:193], v[40:41], s[72:73], v[192:193]
    v_pk_fma_f32 v[194:195], v[42:43], s[72:73], v[194:195]
    v_pk_fma_f32 v[196:197], v[44:45], s[72:73], v[196:197]
    v_pk_fma_f32 v[198:199], v[46:47], s[72:73], v[198:199]
    v_pk_fma_f32 v[200:201], v[112:113], s[76:77], v[200:201]
    v_pk_fma_f32 v[202:203], v[114:115], s[76:77], v[202:203]
    v_pk_fma_f32 v[204:205], v[116:117], s[76:77], v[204:205]
    v_pk_fma_f32 v[206:207], v[118:119], s[76:77], v[206:207]
    s_waitcnt lgkmcnt(8)
    v_mul_u32_u24 v88, v252, v220
    v_and_b32 v89, v253, v220
    v_mul_u32_u24 v90, v252, v221
    v_and_b32 v91, v253, v221
    v_mul_u32_u24 v92, v252, v222
    v_and_b32 v93, v253, v222
    v_mul_u32_u24 v94, v252, v223
    v_and_b32 v95, v253, v223
    s_waitcnt lgkmcnt(7)
    v_mul_u32_u24 v112, v252, v224
    v_and_b32 v113, v253, v224
    v_mul_u32_u24 v114, v252, v225
    v_and_b32 v115, v253, v225
    v_mul_u32_u24 v116, v252, v226
    v_and_b32 v117, v253, v226
    v_mul_u32_u24 v118, v252, v227
    v_and_b32 v119, v253, v227
    s_waitcnt lgkmcnt(6)
    v_mul_u32_u24 v136, v252, v228
    v_and_b32 v137, v253, v228
    v_mul_u32_u24 v138, v252, v229
    v_and_b32 v139, v253, v229
    v_mul_u32_u24 v140, v252, v230
    v_and_b32 v141, v253, v230
    v_mul_u32_u24 v142, v252, v231
    v_and_b32 v143, v253, v231
    ds_read_b128 v[208:211], v6 offset:9280
    ds_read_b128 v[212:215], v5 offset:11584
    ds_read_b128 v[216:219], v6 offset:11584
    s_waitcnt vmcnt(8)
    v_mfma_f32_16x16x32_bf16 v[88:91], a[0:3], a[180:183], v[88:91]
    v_cvt_pk_bf16_f32 v192, v192, v193
    v_cvt_pk_bf16_f32 v193, v194, v195
    v_mfma_f32_16x16x32_bf16 v[92:95], a[12:15], a[180:183], v[92:95]
    s_waitcnt vmcnt(5)
    v_cvt_pk_bf16_f32 v194, v196, v197
    v_cvt_pk_bf16_f32 v195, v198, v199
    v_mfma_f32_16x16x32_bf16 v[112:115], a[0:3], a[192:195], v[112:115]
    ds_write_b128 v8, v[192:195] offset:16896
    v_mfma_f32_16x16x32_bf16 v[116:119], a[12:15], a[192:195], v[116:119]
    s_waitcnt vmcnt(2)
    v_cvt_pk_bf16_f32 v200, v200, v201
    v_cvt_pk_bf16_f32 v201, v202, v203
    v_mfma_f32_16x16x32_bf16 v[136:139], a[0:3], a[204:207], v[136:139]
    v_cvt_pk_bf16_f32 v202, v204, v205
    v_cvt_pk_bf16_f32 v203, v206, v207
    v_mfma_f32_16x16x32_bf16 v[140:143], a[12:15], a[204:207], v[140:143]
    ds_write_b128 v8, v[200:203] offset:21120
    v_mfma_f32_16x16x32_bf16 v[88:91], a[4:7], a[184:187], v[88:91]
    v_cvt_pk_bf16_f32 v160, v160, v161
    v_cvt_pk_bf16_f32 v161, v162, v163
    v_mfma_f32_16x16x32_bf16 v[92:95], a[16:19], a[184:187], v[92:95]
    v_cvt_pk_bf16_f32 v162, v164, v165
    v_cvt_pk_bf16_f32 v163, v166, v167
    v_mfma_f32_16x16x32_bf16 v[112:115], a[4:7], a[196:199], v[112:115]
    ds_write_b128 v8, v[160:163] offset:0
    v_mfma_f32_16x16x32_bf16 v[116:119], a[16:19], a[196:199], v[116:119]
    s_waitcnt vmcnt(1)
    v_cvt_pk_bf16_f32 v168, v168, v169
    v_cvt_pk_bf16_f32 v169, v170, v171
    v_mfma_f32_16x16x32_bf16 v[136:139], a[4:7], a[208:211], v[136:139]
    v_cvt_pk_bf16_f32 v170, v172, v173
    v_cvt_pk_bf16_f32 v171, v174, v175
    v_mfma_f32_16x16x32_bf16 v[140:143], a[16:19], a[208:211], v[140:143]
    ds_write_b128 v8, v[168:171] offset:4224
    v_mfma_f32_16x16x32_bf16 v[88:91], a[8:11], a[188:191], v[88:91]
    v_cvt_pk_bf16_f32 v176, v176, v177
    v_cvt_pk_bf16_f32 v177, v178, v179
    v_mfma_f32_16x16x32_bf16 v[92:95], a[20:23], a[188:191], v[92:95]
    v_cvt_pk_bf16_f32 v178, v180, v181
    v_cvt_pk_bf16_f32 v179, v182, v183
    v_mfma_f32_16x16x32_bf16 v[112:115], a[8:11], a[200:203], v[112:115]
    ds_write_b128 v8, v[176:179] offset:8448
    v_mfma_f32_16x16x32_bf16 v[116:119], a[20:23], a[200:203], v[116:119]
    s_waitcnt vmcnt(0)
    v_cvt_pk_bf16_f32 v184, v184, v185
    v_cvt_pk_bf16_f32 v185, v186, v187
    v_mfma_f32_16x16x32_bf16 v[136:139], a[8:11], a[212:215], v[136:139]
    v_cvt_pk_bf16_f32 v186, v188, v189
    v_cvt_pk_bf16_f32 v187, v190, v191
    v_mfma_f32_16x16x32_bf16 v[140:143], a[20:23], a[212:215], v[140:143]
    ds_write_b128 v8, v[184:187] offset:12672
.p2align 3
    v_pk_fma_f32 v[192:193], v[144:145], s[68:69], v[48:49] neg_lo:[0,1,0] neg_hi:[0,1,0]
    v_pk_fma_f32 v[194:195], v[146:147], s[68:69], v[50:51] neg_lo:[0,1,0] neg_hi:[0,1,0]
    v_pk_fma_f32 v[196:197], v[148:149], s[68:69], v[52:53] neg_lo:[0,1,0] neg_hi:[0,1,0]
    v_pk_fma_f32 v[198:199], v[150:151], s[68:69], v[54:55] neg_lo:[0,1,0] neg_hi:[0,1,0]
    v_pk_fma_f32 v[200:201], v[120:121], s[68:69], v[24:25] neg_lo:[0,1,0] neg_hi:[0,1,0]
    v_pk_fma_f32 v[202:203], v[122:123], s[68:69], v[26:27] neg_lo:[0,1,0] neg_hi:[0,1,0]
    v_pk_fma_f32 v[204:205], v[124:125], s[68:69], v[28:29] neg_lo:[0,1,0] neg_hi:[0,1,0]
    v_pk_fma_f32 v[206:207], v[126:127], s[68:69], v[30:31] neg_lo:[0,1,0] neg_hi:[0,1,0]
    v_pk_fma_f32 v[160:161], v[200:201], s[62:63], v[192:193]
    v_pk_fma_f32 v[162:163], v[202:203], s[62:63], v[194:195]
    v_pk_fma_f32 v[164:165], v[204:205], s[62:63], v[196:197]
    v_pk_fma_f32 v[166:167], v[206:207], s[62:63], v[198:199]
    v_pk_fma_f32 v[168:169], v[200:201], s[62:63], v[192:193] neg_lo:[0,1,0] neg_hi:[0,1,0]
    v_pk_fma_f32 v[170:171], v[202:203], s[62:63], v[194:195] neg_lo:[0,1,0] neg_hi:[0,1,0]
    v_pk_fma_f32 v[172:173], v[204:205], s[62:63], v[196:197] neg_lo:[0,1,0] neg_hi:[0,1,0]
    v_pk_fma_f32 v[174:175], v[206:207], s[62:63], v[198:199] neg_lo:[0,1,0] neg_hi:[0,1,0]
    v_pk_fma_f32 v[192:193], v[144:145], s[66:67], v[48:49] neg_lo:[0,1,0] neg_hi:[0,1,0]
    v_pk_fma_f32 v[194:195], v[146:147], s[66:67], v[50:51] neg_lo:[0,1,0] neg_hi:[0,1,0]
    v_pk_fma_f32 v[196:197], v[148:149], s[66:67], v[52:53] neg_lo:[0,1,0] neg_hi:[0,1,0]
    v_pk_fma_f32 v[198:199], v[150:151], s[66:67], v[54:55] neg_lo:[0,1,0] neg_hi:[0,1,0]
    v_pk_fma_f32 v[200:201], v[120:121], s[66:67], v[24:25] neg_lo:[0,1,0] neg_hi:[0,1,0]
    v_pk_fma_f32 v[202:203], v[122:123], s[66:67], v[26:27] neg_lo:[0,1,0] neg_hi:[0,1,0]
    v_pk_fma_f32 v[204:205], v[124:125], s[66:67], v[28:29] neg_lo:[0,1,0] neg_hi:[0,1,0]
    v_pk_fma_f32 v[206:207], v[126:127], s[66:67], v[30:31] neg_lo:[0,1,0] neg_hi:[0,1,0]
    v_pk_fma_f32 v[176:177], v[200:201], s[64:65], v[192:193]
    v_pk_fma_f32 v[178:179], v[202:203], s[64:65], v[194:195]
    v_pk_fma_f32 v[180:181], v[204:205], s[64:65], v[196:197]
    v_pk_fma_f32 v[182:183], v[206:207], s[64:65], v[198:199]
    v_pk_fma_f32 v[184:185], v[200:201], s[64:65], v[192:193] neg_lo:[0,1,0] neg_hi:[0,1,0]
    v_pk_fma_f32 v[186:187], v[202:203], s[64:65], v[194:195] neg_lo:[0,1,0] neg_hi:[0,1,0]
    v_pk_fma_f32 v[188:189], v[204:205], s[64:65], v[196:197] neg_lo:[0,1,0] neg_hi:[0,1,0]
    v_pk_fma_f32 v[190:191], v[206:207], s[64:65], v[198:199] neg_lo:[0,1,0] neg_hi:[0,1,0]
    v_pk_fma_f32 v[192:193], v[144:145], s[70:71], v[96:97] neg_lo:[0,1,0] neg_hi:[0,1,0]
    v_pk_fma_f32 v[194:195], v[146:147], s[70:71], v[98:99] neg_lo:[0,1,0] neg_hi:[0,1,0]
    v_pk_fma_f32 v[196:197], v[148:149], s[70:71], v[100:101] neg_lo:[0,1,0] neg_hi:[0,1,0]
    v_pk_fma_f32 v[198:199], v[150:151], s[70:71], v[102:103] neg_lo:[0,1,0] neg_hi:[0,1,0]
    v_pk_fma_f32 v[200:201], v[24:25], s[74:75], v[72:73] neg_lo:[0,1,0] neg_hi:[0,1,0]
    v_pk_fma_f32 v[202:203], v[26:27], s[74:75], v[74:75] neg_lo:[0,1,0] neg_hi:[0,1,0]
    v_pk_fma_f32 v[204:205], v[28:29], s[74:75], v[76:77] neg_lo:[0,1,0] neg_hi:[0,1,0]
    v_pk_fma_f32 v[206:207], v[30:31], s[74:75], v[78:79] neg_lo:[0,1,0] neg_hi:[0,1,0]
    v_pk_fma_f32 v[192:193], v[48:49], s[72:73], v[192:193]
    v_pk_fma_f32 v[194:195], v[50:51], s[72:73], v[194:195]
    v_pk_fma_f32 v[196:197], v[52:53], s[72:73], v[196:197]
    v_pk_fma_f32 v[198:199], v[54:55], s[72:73], v[198:199]
    v_pk_fma_f32 v[200:201], v[120:121], s[76:77], v[200:201]
    v_pk_fma_f32 v[202:203], v[122:123], s[76:77], v[202:203]
    v_pk_fma_f32 v[204:205], v[124:125], s[76:77], v[204:205]
    v_pk_fma_f32 v[206:207], v[126:127], s[76:77], v[206:207]
    s_waitcnt lgkmcnt(8)
    v_mul_u32_u24 v96, v252, v208
    v_and_b32 v97, v253, v208
    v_mul_u32_u24 v98, v252, v209
    v_and_b32 v99, v253, v209
    v_mul_u32_u24 v100, v252, v210
    v_and_b32 v101, v253, v210
    v_mul_u32_u24 v102, v252, v211
    v_and_b32 v103, v253, v211
    s_waitcnt lgkmcnt(7)
    v_mul_u32_u24 v120, v252, v212
    v_and_b32 v121, v253, v212
    v_mul_u32_u24 v122, v252, v213
    v_and_b32 v123, v253, v213
    v_mul_u32_u24 v124, v252, v214
    v_and_b32 v125, v253, v214
    v_mul_u32_u24 v126, v252, v215
    v_and_b32 v127, v253, v215
    s_waitcnt lgkmcnt(6)
    v_mul_u32_u24 v144, v252, v216
    v_and_b32 v145, v253, v216
    v_mul_u32_u24 v146, v252, v217
    v_and_b32 v147, v253, v217
    v_mul_u32_u24 v148, v252, v218
    v_and_b32 v149, v253, v218
    v_mul_u32_u24 v150, v252, v219
    v_and_b32 v151, v253, v219
    ds_read_b128 v[220:223], v6 offset:9344
    ds_read_b128 v[224:227], v5 offset:11648
    ds_read_b128 v[228:231], v6 offset:11648
    v_mfma_f32_16x16x32_bf16 v[96:99], a[24:27], a[180:183], v[96:99]
    v_cvt_pk_bf16_f32 v192, v192, v193
    v_cvt_pk_bf16_f32 v193, v194, v195
    v_mfma_f32_16x16x32_bf16 v[100:103], a[36:39], a[180:183], v[100:103]
    v_cvt_pk_bf16_f32 v194, v196, v197
    v_cvt_pk_bf16_f32 v195, v198, v199
    v_mfma_f32_16x16x32_bf16 v[120:123], a[24:27], a[192:195], v[120:123]
    ds_write_b128 v8, v[192:195] offset:16928
    v_mfma_f32_16x16x32_bf16 v[124:127], a[36:39], a[192:195], v[124:127]
    v_cvt_pk_bf16_f32 v200, v200, v201
    v_cvt_pk_bf16_f32 v201, v202, v203
    v_mfma_f32_16x16x32_bf16 v[144:147], a[24:27], a[204:207], v[144:147]
    v_cvt_pk_bf16_f32 v202, v204, v205
    v_cvt_pk_bf16_f32 v203, v206, v207
    v_mfma_f32_16x16x32_bf16 v[148:151], a[36:39], a[204:207], v[148:151]
    ds_write_b128 v8, v[200:203] offset:21152
    v_mfma_f32_16x16x32_bf16 v[96:99], a[28:31], a[184:187], v[96:99]
    v_cvt_pk_bf16_f32 v160, v160, v161
    v_cvt_pk_bf16_f32 v161, v162, v163
    v_mfma_f32_16x16x32_bf16 v[100:103], a[40:43], a[184:187], v[100:103]
    v_cvt_pk_bf16_f32 v162, v164, v165
    v_cvt_pk_bf16_f32 v163, v166, v167
    v_mfma_f32_16x16x32_bf16 v[120:123], a[28:31], a[196:199], v[120:123]
    ds_write_b128 v8, v[160:163] offset:32
    v_mfma_f32_16x16x32_bf16 v[124:127], a[40:43], a[196:199], v[124:127]
    v_cvt_pk_bf16_f32 v168, v168, v169
    v_cvt_pk_bf16_f32 v169, v170, v171
    v_mfma_f32_16x16x32_bf16 v[144:147], a[28:31], a[208:211], v[144:147]
    v_cvt_pk_bf16_f32 v170, v172, v173
    v_cvt_pk_bf16_f32 v171, v174, v175
    v_mfma_f32_16x16x32_bf16 v[148:151], a[40:43], a[208:211], v[148:151]
    ds_write_b128 v8, v[168:171] offset:4256
    v_mfma_f32_16x16x32_bf16 v[96:99], a[32:35], a[188:191], v[96:99]
    v_cvt_pk_bf16_f32 v176, v176, v177
    v_cvt_pk_bf16_f32 v177, v178, v179
    v_mfma_f32_16x16x32_bf16 v[100:103], a[44:47], a[188:191], v[100:103]
    v_cvt_pk_bf16_f32 v178, v180, v181
    v_cvt_pk_bf16_f32 v179, v182, v183
    v_mfma_f32_16x16x32_bf16 v[120:123], a[32:35], a[200:203], v[120:123]
    ds_write_b128 v8, v[176:179] offset:8480
    v_mfma_f32_16x16x32_bf16 v[124:127], a[44:47], a[200:203], v[124:127]
    v_cvt_pk_bf16_f32 v184, v184, v185
    v_cvt_pk_bf16_f32 v185, v186, v187
    v_mfma_f32_16x16x32_bf16 v[144:147], a[32:35], a[212:215], v[144:147]
    v_cvt_pk_bf16_f32 v186, v188, v189
    v_cvt_pk_bf16_f32 v187, v190, v191
    v_mfma_f32_16x16x32_bf16 v[148:151], a[44:47], a[212:215], v[148:151]
    s_waitcnt lgkmcnt(5)
    ds_write_b128 v8, v[184:187] offset:12704
    s_barrier
.p2align 3
    v_pk_fma_f32 v[192:193], v[152:153], s[68:69], v[56:57] neg_lo:[0,1,0] neg_hi:[0,1,0]
    v_pk_fma_f32 v[194:195], v[154:155], s[68:69], v[58:59] neg_lo:[0,1,0] neg_hi:[0,1,0]
    v_pk_fma_f32 v[196:197], v[156:157], s[68:69], v[60:61] neg_lo:[0,1,0] neg_hi:[0,1,0]
    v_pk_fma_f32 v[198:199], v[158:159], s[68:69], v[62:63] neg_lo:[0,1,0] neg_hi:[0,1,0]
    v_pk_fma_f32 v[200:201], v[128:129], s[68:69], v[32:33] neg_lo:[0,1,0] neg_hi:[0,1,0]
    v_pk_fma_f32 v[202:203], v[130:131], s[68:69], v[34:35] neg_lo:[0,1,0] neg_hi:[0,1,0]
    v_pk_fma_f32 v[204:205], v[132:133], s[68:69], v[36:37] neg_lo:[0,1,0] neg_hi:[0,1,0]
    v_pk_fma_f32 v[206:207], v[134:135], s[68:69], v[38:39] neg_lo:[0,1,0] neg_hi:[0,1,0]
    v_pk_fma_f32 v[160:161], v[200:201], s[62:63], v[192:193]
    v_pk_fma_f32 v[162:163], v[202:203], s[62:63], v[194:195]
    v_pk_fma_f32 v[164:165], v[204:205], s[62:63], v[196:197]
    v_pk_fma_f32 v[166:167], v[206:207], s[62:63], v[198:199]
    v_pk_fma_f32 v[168:169], v[200:201], s[62:63], v[192:193] neg_lo:[0,1,0] neg_hi:[0,1,0]
    v_pk_fma_f32 v[170:171], v[202:203], s[62:63], v[194:195] neg_lo:[0,1,0] neg_hi:[0,1,0]
    v_pk_fma_f32 v[172:173], v[204:205], s[62:63], v[196:197] neg_lo:[0,1,0] neg_hi:[0,1,0]
    v_pk_fma_f32 v[174:175], v[206:207], s[62:63], v[198:199] neg_lo:[0,1,0] neg_hi:[0,1,0]
    v_pk_fma_f32 v[192:193], v[152:153], s[66:67], v[56:57] neg_lo:[0,1,0] neg_hi:[0,1,0]
    v_pk_fma_f32 v[194:195], v[154:155], s[66:67], v[58:59] neg_lo:[0,1,0] neg_hi:[0,1,0]
    v_pk_fma_f32 v[196:197], v[156:157], s[66:67], v[60:61] neg_lo:[0,1,0] neg_hi:[0,1,0]
    v_pk_fma_f32 v[198:199], v[158:159], s[66:67], v[62:63] neg_lo:[0,1,0] neg_hi:[0,1,0]
    v_pk_fma_f32 v[200:201], v[128:129], s[66:67], v[32:33] neg_lo:[0,1,0] neg_hi:[0,1,0]
    v_pk_fma_f32 v[202:203], v[130:131], s[66:67], v[34:35] neg_lo:[0,1,0] neg_hi:[0,1,0]
    v_pk_fma_f32 v[204:205], v[132:133], s[66:67], v[36:37] neg_lo:[0,1,0] neg_hi:[0,1,0]
    v_pk_fma_f32 v[206:207], v[134:135], s[66:67], v[38:39] neg_lo:[0,1,0] neg_hi:[0,1,0]
    global_load_dwordx4 a[72:75], v11, s[44:45] offset:-3072 sc1
    global_load_dwordx4 a[76:79], v11, s[44:45] offset:-2048 sc1
    global_load_dwordx4 a[80:83], v11, s[44:45] offset:-1024 sc1
    v_pk_fma_f32 v[176:177], v[200:201], s[64:65], v[192:193]
    v_pk_fma_f32 v[178:179], v[202:203], s[64:65], v[194:195]
    v_pk_fma_f32 v[180:181], v[204:205], s[64:65], v[196:197]
    v_pk_fma_f32 v[182:183], v[206:207], s[64:65], v[198:199]
    v_pk_fma_f32 v[184:185], v[200:201], s[64:65], v[192:193] neg_lo:[0,1,0] neg_hi:[0,1,0]
    v_pk_fma_f32 v[186:187], v[202:203], s[64:65], v[194:195] neg_lo:[0,1,0] neg_hi:[0,1,0]
    v_pk_fma_f32 v[188:189], v[204:205], s[64:65], v[196:197] neg_lo:[0,1,0] neg_hi:[0,1,0]
    v_pk_fma_f32 v[190:191], v[206:207], s[64:65], v[198:199] neg_lo:[0,1,0] neg_hi:[0,1,0]
    v_pk_fma_f32 v[192:193], v[152:153], s[70:71], v[104:105] neg_lo:[0,1,0] neg_hi:[0,1,0]
    v_pk_fma_f32 v[194:195], v[154:155], s[70:71], v[106:107] neg_lo:[0,1,0] neg_hi:[0,1,0]
    v_pk_fma_f32 v[196:197], v[156:157], s[70:71], v[108:109] neg_lo:[0,1,0] neg_hi:[0,1,0]
    v_pk_fma_f32 v[198:199], v[158:159], s[70:71], v[110:111] neg_lo:[0,1,0] neg_hi:[0,1,0]
    v_pk_fma_f32 v[200:201], v[32:33], s[74:75], v[80:81] neg_lo:[0,1,0] neg_hi:[0,1,0]
    v_pk_fma_f32 v[202:203], v[34:35], s[74:75], v[82:83] neg_lo:[0,1,0] neg_hi:[0,1,0]
    v_pk_fma_f32 v[204:205], v[36:37], s[74:75], v[84:85] neg_lo:[0,1,0] neg_hi:[0,1,0]
    v_pk_fma_f32 v[206:207], v[38:39], s[74:75], v[86:87] neg_lo:[0,1,0] neg_hi:[0,1,0]
    v_pk_fma_f32 v[192:193], v[56:57], s[72:73], v[192:193]
    v_pk_fma_f32 v[194:195], v[58:59], s[72:73], v[194:195]
    v_pk_fma_f32 v[196:197], v[60:61], s[72:73], v[196:197]
    v_pk_fma_f32 v[198:199], v[62:63], s[72:73], v[198:199]
    v_pk_fma_f32 v[200:201], v[128:129], s[76:77], v[200:201]
    v_pk_fma_f32 v[202:203], v[130:131], s[76:77], v[202:203]
    v_pk_fma_f32 v[204:205], v[132:133], s[76:77], v[204:205]
    v_pk_fma_f32 v[206:207], v[134:135], s[76:77], v[206:207]
    global_load_dwordx4 a[84:87], v11, s[44:45] offset:0 sc1
    global_load_dwordx4 a[88:91], v11, s[44:45] offset:1024 sc1
    global_load_dwordx4 a[92:95], v11, s[44:45] offset:2048 sc1
    v_add_u32 v11, 6144, v11
    v_mul_u32_u24 v104, v252, v220
    v_and_b32 v105, v253, v220
    v_mul_u32_u24 v106, v252, v221
    v_and_b32 v107, v253, v221
    v_mul_u32_u24 v108, v252, v222
    v_and_b32 v109, v253, v222
    v_mul_u32_u24 v110, v252, v223
    v_and_b32 v111, v253, v223
    v_mul_u32_u24 v128, v252, v224
    v_and_b32 v129, v253, v224
    v_mul_u32_u24 v130, v252, v225
    v_and_b32 v131, v253, v225
    v_mul_u32_u24 v132, v252, v226
    v_and_b32 v133, v253, v226
    v_mul_u32_u24 v134, v252, v227
    v_and_b32 v135, v253, v227
    v_mul_u32_u24 v152, v252, v228
    v_and_b32 v153, v253, v228
    v_mul_u32_u24 v154, v252, v229
    v_and_b32 v155, v253, v229
    v_mul_u32_u24 v156, v252, v230
    v_and_b32 v157, v253, v230
    v_mul_u32_u24 v158, v252, v231
    v_and_b32 v159, v253, v231
    ds_read_b128 a[216:219], v9 offset:0
    ds_read_b128 a[220:223], v9 offset:25344
    ds_read_b128 a[232:235], v10 offset:25344
    v_mfma_f32_16x16x32_bf16 v[104:107], a[48:51], a[180:183], v[104:107]
    v_cvt_pk_bf16_f32 v192, v192, v193
    v_cvt_pk_bf16_f32 v193, v194, v195
    v_mfma_f32_16x16x32_bf16 v[108:111], a[60:63], a[180:183], v[108:111]
    v_cvt_pk_bf16_f32 v194, v196, v197
    v_cvt_pk_bf16_f32 v195, v198, v199
    v_mfma_f32_16x16x32_bf16 v[128:131], a[48:51], a[192:195], v[128:131]
    ds_write_b128 v8, v[192:195] offset:16960
    v_mfma_f32_16x16x32_bf16 v[132:135], a[60:63], a[192:195], v[132:135]
    v_cvt_pk_bf16_f32 v200, v200, v201
    v_cvt_pk_bf16_f32 v201, v202, v203
    v_mfma_f32_16x16x32_bf16 v[152:155], a[48:51], a[204:207], v[152:155]
    v_cvt_pk_bf16_f32 v202, v204, v205
    v_cvt_pk_bf16_f32 v203, v206, v207
    v_mfma_f32_16x16x32_bf16 v[156:159], a[60:63], a[204:207], v[156:159]
    ds_write_b128 v8, v[200:203] offset:21184
    v_mfma_f32_16x16x32_bf16 v[104:107], a[52:55], a[184:187], v[104:107]
    v_cvt_pk_bf16_f32 v160, v160, v161
    v_cvt_pk_bf16_f32 v161, v162, v163
    v_mfma_f32_16x16x32_bf16 v[108:111], a[64:67], a[184:187], v[108:111]
    v_cvt_pk_bf16_f32 v162, v164, v165
    v_cvt_pk_bf16_f32 v163, v166, v167
    v_mfma_f32_16x16x32_bf16 v[128:131], a[52:55], a[196:199], v[128:131]
    ds_write_b128 v8, v[160:163] offset:64
    v_mfma_f32_16x16x32_bf16 v[132:135], a[64:67], a[196:199], v[132:135]
    v_cvt_pk_bf16_f32 v168, v168, v169
    v_cvt_pk_bf16_f32 v169, v170, v171
    v_mfma_f32_16x16x32_bf16 v[152:155], a[52:55], a[208:211], v[152:155]
    v_cvt_pk_bf16_f32 v170, v172, v173
    v_cvt_pk_bf16_f32 v171, v174, v175
    v_mfma_f32_16x16x32_bf16 v[156:159], a[64:67], a[208:211], v[156:159]
    ds_write_b128 v8, v[168:171] offset:4288
    v_mfma_f32_16x16x32_bf16 v[104:107], a[56:59], a[188:191], v[104:107]
    v_cvt_pk_bf16_f32 v176, v176, v177
    v_cvt_pk_bf16_f32 v177, v178, v179
    v_mfma_f32_16x16x32_bf16 v[108:111], a[68:71], a[188:191], v[108:111]
    v_cvt_pk_bf16_f32 v178, v180, v181
    v_cvt_pk_bf16_f32 v179, v182, v183
    v_mfma_f32_16x16x32_bf16 v[128:131], a[56:59], a[200:203], v[128:131]
    ds_write_b128 v8, v[176:179] offset:8512
    v_mfma_f32_16x16x32_bf16 v[132:135], a[68:71], a[200:203], v[132:135]
    v_cvt_pk_bf16_f32 v184, v184, v185
    v_cvt_pk_bf16_f32 v185, v186, v187
    v_mfma_f32_16x16x32_bf16 v[152:155], a[56:59], a[212:215], v[152:155]
    v_cvt_pk_bf16_f32 v186, v188, v189
    v_cvt_pk_bf16_f32 v187, v190, v191
    v_mfma_f32_16x16x32_bf16 v[156:159], a[68:71], a[212:215], v[156:159]
    ds_write_b128 v8, v[184:187] offset:12736
    v_add_u32 v8, s6, v8
L_T2:
.p2align 3
    v_pk_fma_f32 v[232:233], v[64:65], s[68:69], v[112:113] neg_lo:[0,1,0] neg_hi:[0,1,0]
    v_pk_fma_f32 v[234:235], v[66:67], s[68:69], v[114:115] neg_lo:[0,1,0] neg_hi:[0,1,0]
    v_pk_fma_f32 v[236:237], v[68:69], s[68:69], v[116:117] neg_lo:[0,1,0] neg_hi:[0,1,0]
    v_pk_fma_f32 v[238:239], v[70:71], s[68:69], v[118:119] neg_lo:[0,1,0] neg_hi:[0,1,0]
    v_pk_fma_f32 v[240:241], v[40:41], s[68:69], v[88:89] neg_lo:[0,1,0] neg_hi:[0,1,0]
    v_pk_fma_f32 v[242:243], v[42:43], s[68:69], v[90:91] neg_lo:[0,1,0] neg_hi:[0,1,0]
    v_pk_fma_f32 v[244:245], v[44:45], s[68:69], v[92:93] neg_lo:[0,1,0] neg_hi:[0,1,0]
    v_pk_fma_f32 v[246:247], v[46:47], s[68:69], v[94:95] neg_lo:[0,1,0] neg_hi:[0,1,0]
    v_pk_fma_f32 v[160:161], v[240:241], s[62:63], v[232:233]
    v_pk_fma_f32 v[162:163], v[242:243], s[62:63], v[234:235]
    v_pk_fma_f32 v[164:165], v[244:245], s[62:63], v[236:237]
    v_pk_fma_f32 v[166:167], v[246:247], s[62:63], v[238:239]
    v_pk_fma_f32 v[168:169], v[240:241], s[62:63], v[232:233] neg_lo:[0,1,0] neg_hi:[0,1,0]
    v_pk_fma_f32 v[170:171], v[242:243], s[62:63], v[234:235] neg_lo:[0,1,0] neg_hi:[0,1,0]
    v_pk_fma_f32 v[172:173], v[244:245], s[62:63], v[236:237] neg_lo:[0,1,0] neg_hi:[0,1,0]
    v_pk_fma_f32 v[174:175], v[246:247], s[62:63], v[238:239] neg_lo:[0,1,0] neg_hi:[0,1,0]
    v_cvt_pk_bf16_f32 v160, v160, v161
    v_cvt_pk_bf16_f32 v161, v162, v163
    v_cvt_pk_bf16_f32 v162, v164, v165
    v_cvt_pk_bf16_f32 v163, v166, v167
    ds_write_b128 v8, v[160:163] offset:0
    v_cvt_pk_bf16_f32 v168, v168, v169
    v_cvt_pk_bf16_f32 v169, v170, v171
    v_cvt_pk_bf16_f32 v170, v172, v173
    global_load_dwordx4 a[96:99], v11, s[44:45] offset:-3072 sc1
    global_load_dwordx4 a[100:103], v11, s[44:45] offset:-2048 sc1
    global_load_dwordx4 a[104:107], v11, s[44:45] offset:-1024 sc1
    v_cvt_pk_bf16_f32 v171, v174, v175
    ds_write_b128 v8, v[168:171] offset:4224
    v_pk_fma_f32 v[232:233], v[72:73], s[68:69], v[120:121] neg_lo:[0,1,0] neg_hi:[0,1,0]
    v_pk_fma_f32 v[234:235], v[74:75], s[68:69], v[122:123] neg_lo:[0,1,0] neg_hi:[0,1,0]
    v_pk_fma_f32 v[236:237], v[76:77], s[68:69], v[124:125] neg_lo:[0,1,0] neg_hi:[0,1,0]
    v_pk_fma_f32 v[238:239], v[78:79], s[68:69], v[126:127] neg_lo:[0,1,0] neg_hi:[0,1,0]
    v_pk_fma_f32 v[240:241], v[48:49], s[68:69], v[96:97] neg_lo:[0,1,0] neg_hi:[0,1,0]
    v_pk_fma_f32 v[242:243], v[50:51], s[68:69], v[98:99] neg_lo:[0,1,0] neg_hi:[0,1,0]
    v_pk_fma_f32 v[244:245], v[52:53], s[68:69], v[100:101] neg_lo:[0,1,0] neg_hi:[0,1,0]
    v_pk_fma_f32 v[246:247], v[54:55], s[68:69], v[102:103] neg_lo:[0,1,0] neg_hi:[0,1,0]
    v_pk_fma_f32 v[176:177], v[240:241], s[62:63], v[232:233]
    v_pk_fma_f32 v[178:179], v[242:243], s[62:63], v[234:235]
    v_pk_fma_f32 v[180:181], v[244:245], s[62:63], v[236:237]
    v_pk_fma_f32 v[182:183], v[246:247], s[62:63], v[238:239]
    v_pk_fma_f32 v[184:185], v[240:241], s[62:63], v[232:233] neg_lo:[0,1,0] neg_hi:[0,1,0]
    v_pk_fma_f32 v[186:187], v[242:243], s[62:63], v[234:235] neg_lo:[0,1,0] neg_hi:[0,1,0]
    v_pk_fma_f32 v[188:189], v[244:245], s[62:63], v[236:237] neg_lo:[0,1,0] neg_hi:[0,1,0]
    v_pk_fma_f32 v[190:191], v[246:247], s[62:63], v[238:239] neg_lo:[0,1,0] neg_hi:[0,1,0]
    v_cvt_pk_bf16_f32 v176, v176, v177
    v_cvt_pk_bf16_f32 v177, v178, v179
    v_cvt_pk_bf16_f32 v178, v180, v181
    v_cvt_pk_bf16_f32 v179, v182, v183
    ds_write_b128 v8, v[176:179] offset:32
    v_cvt_pk_bf16_f32 v184, v184, v185
    global_load_dwordx4 a[108:111], v11, s[44:45] offset:0 sc1
    global_load_dwordx4 a[112:115], v11, s[44:45] offset:1024 sc1
    global_load_dwordx4 a[116:119], v11, s[44:45] offset:2048 sc1
    v_cvt_pk_bf16_f32 v185, v186, v187
    v_cvt_pk_bf16_f32 v186, v188, v189
    v_cvt_pk_bf16_f32 v187, v190, v191
    ds_write_b128 v8, v[184:187] offset:4256
    v_pk_fma_f32 v[232:233], v[80:81], s[68:69], v[128:129] neg_lo:[0,1,0] neg_hi:[0,1,0]
    v_pk_fma_f32 v[234:235], v[82:83], s[68:69], v[130:131] neg_lo:[0,1,0] neg_hi:[0,1,0]
    v_pk_fma_f32 v[236:237], v[84:85], s[68:69], v[132:133] neg_lo:[0,1,0] neg_hi:[0,1,0]
    v_pk_fma_f32 v[238:239], v[86:87], s[68:69], v[134:135] neg_lo:[0,1,0] neg_hi:[0,1,0]
    v_pk_fma_f32 v[240:241], v[56:57], s[68:69], v[104:105] neg_lo:[0,1,0] neg_hi:[0,1,0]
    v_pk_fma_f32 v[242:243], v[58:59], s[68:69], v[106:107] neg_lo:[0,1,0] neg_hi:[0,1,0]
    v_pk_fma_f32 v[244:245], v[60:61], s[68:69], v[108:109] neg_lo:[0,1,0] neg_hi:[0,1,0]
    v_pk_fma_f32 v[246:247], v[62:63], s[68:69], v[110:111] neg_lo:[0,1,0] neg_hi:[0,1,0]
    v_pk_fma_f32 v[192:193], v[240:241], s[62:63], v[232:233]
    v_pk_fma_f32 v[194:195], v[242:243], s[62:63], v[234:235]
    v_pk_fma_f32 v[196:197], v[244:245], s[62:63], v[236:237]
    v_pk_fma_f32 v[198:199], v[246:247], s[62:63], v[238:239]
    v_pk_fma_f32 v[200:201], v[240:241], s[62:63], v[232:233] neg_lo:[0,1,0] neg_hi:[0,1,0]
    v_pk_fma_f32 v[202:203], v[242:243], s[62:63], v[234:235] neg_lo:[0,1,0] neg_hi:[0,1,0]
    v_pk_fma_f32 v[204:205], v[244:245], s[62:63], v[236:237] neg_lo:[0,1,0] neg_hi:[0,1,0]
    v_pk_fma_f32 v[206:207], v[246:247], s[62:63], v[238:239] neg_lo:[0,1,0] neg_hi:[0,1,0]
    v_cvt_pk_bf16_f32 v192, v192, v193
    v_cvt_pk_bf16_f32 v193, v194, v195
    v_cvt_pk_bf16_f32 v194, v196, v197
    v_cvt_pk_bf16_f32 v195, v198, v199
    ds_write_b128 v8, v[192:195] offset:64
    v_cvt_pk_bf16_f32 v200, v200, v201
    v_cvt_pk_bf16_f32 v201, v202, v203
    v_cvt_pk_bf16_f32 v202, v204, v205
    v_cvt_pk_bf16_f32 v203, v206, v207
    ds_write_b128 v8, v[200:203] offset:4288
    s_waitcnt lgkmcnt(0)
    s_barrier
    ds_read_b128 a[224:227], v9 offset:50688
    ds_read_b128 a[228:231], v10 offset:0
    ds_read_b128 a[236:239], v10 offset:50688
    s_waitcnt vmcnt(11)
    v_mfma_f32_16x16x32_bf16 v[160:163], a[72:75], a[216:219], 0
    s_waitcnt vmcnt(10)
    v_fma_f32 v220, -s66, v64, v112
    v_fma_f32 v221, -s66, v65, v113
    v_mfma_f32_16x16x32_bf16 v[164:167], a[76:79], a[216:219], 0
    s_waitcnt vmcnt(9)
    v_add_u32 v11, 6144, v11
    v_fma_f32 v222, -s66, v66, v114
    v_mfma_f32_16x16x32_bf16 v[168:171], a[80:83], a[216:219], 0
    global_load_dwordx4 a[120:123], v11, s[44:45] offset:-3072 sc1
    v_mfma_f32_16x16x32_bf16 v[172:175], a[72:75], a[220:223], 0
    s_mov_b32 s53, 96
    ds_read_b128 a[216:219], v9 offset:32
    v_fma_f32 v223, -s66, v67, v115
    v_mfma_f32_16x16x32_bf16 v[176:179], a[76:79], a[220:223], 0
    v_fma_f32 v224, -s66, v68, v116
    v_fma_f32 v225, -s66, v69, v117
    v_mfma_f32_16x16x32_bf16 v[180:183], a[80:83], a[220:223], 0
    s_waitcnt vmcnt(9)
    v_fma_f32 v226, -s66, v70, v118
    v_fma_f32 v227, -s66, v71, v119
    v_mfma_f32_16x16x32_bf16 v[160:163], a[84:87], a[220:223], v[160:163]
    s_waitcnt vmcnt(8)
    global_load_dwordx4 a[124:127], v11, s[44:45] offset:-2048 sc1
    v_mfma_f32_16x16x32_bf16 v[164:167], a[88:91], a[220:223], v[164:167]
    s_waitcnt vmcnt(8)
    v_fma_f32 v228, -s66, v40, v88
    v_fma_f32 v229, -s66, v41, v89
    v_mfma_f32_16x16x32_bf16 v[168:171], a[92:95], a[220:223], v[168:171]
    s_waitcnt lgkmcnt(3)
    v_fma_f32 v230, -s66, v42, v90
    v_fma_f32 v231, -s66, v43, v91
    v_mfma_f32_16x16x32_bf16 v[184:187], a[72:75], a[224:227], 0
    ds_read_b128 a[220:223], v9 offset:25376
    v_fma_f32 v232, -s66, v44, v92
    v_mfma_f32_16x16x32_bf16 v[188:191], a[76:79], a[224:227], 0
    v_fma_f32 v233, -s66, v45, v93
    v_fma_f32 v234, -s66, v46, v94
    v_mfma_f32_16x16x32_bf16 v[192:195], a[80:83], a[224:227], 0
    v_fma_f32 v235, -s66, v47, v95
    v_fma_f32 v236, s64, v228, v220
    v_mfma_f32_16x16x32_bf16 v[172:175], a[84:87], a[224:227], v[172:175]
    global_load_dwordx4 a[128:131], v11, s[44:45] offset:-1024 sc1
    v_mfma_f32_16x16x32_bf16 v[176:179], a[88:91], a[224:227], v[176:179]
    v_fma_f32 v237, s64, v229, v221
    v_fma_f32 v238, s64, v230, v222
    v_mfma_f32_16x16x32_bf16 v[180:183], a[92:95], a[224:227], v[180:183]
    s_waitcnt lgkmcnt(3)
    v_fma_f32 v239, s64, v231, v223
    v_fma_f32 v240, s64, v232, v224
    v_mfma_f32_16x16x32_bf16 v[196:199], a[72:75], a[228:231], 0
    ds_read_b128 a[224:227], v9 offset:50720
    v_fma_f32 v241, s64, v233, v225
    v_mfma_f32_16x16x32_bf16 v[200:203], a[76:79], a[228:231], 0
    v_fma_f32 v242, s64, v234, v226
    v_fma_f32 v243, s64, v235, v227
    v_mfma_f32_16x16x32_bf16 v[204:207], a[80:83], a[228:231], 0
    v_fma_f32 v244, -s64, v228, v220
    v_fma_f32 v245, -s64, v229, v221
    v_mfma_f32_16x16x32_bf16 v[184:187], a[84:87], a[228:231], v[184:187]
    global_load_dwordx4 a[132:135], v11, s[44:45] offset:0 sc1
    v_mfma_f32_16x16x32_bf16 v[188:191], a[88:91], a[228:231], v[188:191]
    v_fma_f32 v246, -s64, v230, v222
    v_fma_f32 v247, -s64, v231, v223
    v_mfma_f32_16x16x32_bf16 v[192:195], a[92:95], a[228:231], v[192:195]
    s_waitcnt lgkmcnt(3)
    v_fma_f32 v248, -s64, v232, v224
    v_fma_f32 v249, -s64, v233, v225
    v_mfma_f32_16x16x32_bf16 v[208:211], a[72:75], a[232:235], 0
    ds_read_b128 a[228:231], v10 offset:32
    v_fma_f32 v250, -s64, v234, v226
    v_mfma_f32_16x16x32_bf16 v[212:215], a[76:79], a[232:235], 0
    v_fma_f32 v251, -s64, v235, v227
    v_fma_f32 v220, -s70, v64, v16
    v_mfma_f32_16x16x32_bf16 v[216:219], a[80:83], a[232:235], 0
    v_fma_f32 v221, -s70, v65, v17
    v_fma_f32 v222, -s70, v66, v18
    v_mfma_f32_16x16x32_bf16 v[196:199], a[84:87], a[232:235], v[196:199]
    global_load_dwordx4 a[136:139], v11, s[44:45] offset:1024 sc1
    v_mfma_f32_16x16x32_bf16 v[200:203], a[88:91], a[232:235], v[200:203]
    v_fma_f32 v223, -s70, v67, v19
    v_fma_f32 v224, -s70, v68, v20
    v_mfma_f32_16x16x32_bf16 v[204:207], a[92:95], a[232:235], v[204:207]
    v_fma_f32 v225, -s70, v69, v21
    v_fma_f32 v226, -s70, v70, v22
    v_mfma_f32_16x16x32_bf16 v[208:211], a[84:87], a[236:239], v[208:211]
    ds_read_b128 a[232:235], v10 offset:25376
    v_fma_f32 v227, -s70, v71, v23
    v_mfma_f32_16x16x32_bf16 v[212:215], a[88:91], a[236:239], v[212:215]
    global_load_dwordx4 a[140:143], v11, s[44:45] offset:2048 sc1
    v_mfma_f32_16x16x32_bf16 v[216:219], a[92:95], a[236:239], v[216:219]
    s_waitcnt vmcnt(6) lgkmcnt(1)
    v_cvt_pk_bf16_f32 v236, v236, v237
    v_cvt_pk_bf16_f32 v237, v238, v239
    v_mfma_f32_16x16x32_bf16 v[160:163], a[96:99], a[216:219], v[160:163]
    ds_read_b128 a[236:239], v10 offset:50720
    v_cvt_pk_bf16_f32 v238, v240, v241
    v_mfma_f32_16x16x32_bf16 v[164:167], a[100:103], a[216:219], v[164:167]
    v_add_u32 v11, 6144, v11
    v_cvt_pk_bf16_f32 v239, v242, v243
    v_mfma_f32_16x16x32_bf16 v[168:171], a[104:107], a[216:219], v[168:171]
    global_load_dwordx4 a[72:75], v11, s[44:45] offset:-3072 sc1
    v_mfma_f32_16x16x32_bf16 v[172:175], a[96:99], a[220:223], v[172:175]
    ds_read_b128 a[216:219], v9 offset:64
    v_mfma_f32_16x16x32_bf16 v[176:179], a[100:103], a[220:223], v[176:179]
    ds_write_b64 v8, v[236:237] offset:8448
    v_mfma_f32_16x16x32_bf16 v[180:183], a[104:107], a[220:223], v[180:183]
    ds_write_b64 v8, v[238:239] offset:8456
    v_mfma_f32_16x16x32_bf16 v[160:163], a[108:111], a[220:223], v[160:163]
    global_load_dwordx4 a[76:79], v11, s[44:45] offset:-2048 sc1
    v_mfma_f32_16x16x32_bf16 v[164:167], a[112:115], a[220:223], v[164:167]
    v_fma_f32 v228, -s74, v88, v136
    v_fma_f32 v229, -s74, v89, v137
    v_mfma_f32_16x16x32_bf16 v[168:171], a[116:119], a[220:223], v[168:171]
    v_fma_f32 v230, -s74, v90, v138
    v_fma_f32 v231, -s74, v91, v139
    v_mfma_f32_16x16x32_bf16 v[184:187], a[96:99], a[224:227], v[184:187]
    ds_read_b128 a[220:223], v9 offset:25408
    v_fma_f32 v232, -s74, v92, v140
    v_mfma_f32_16x16x32_bf16 v[188:191], a[100:103], a[224:227], v[188:191]
    v_fma_f32 v233, -s74, v93, v141
    v_fma_f32 v234, -s74, v94, v142
    v_mfma_f32_16x16x32_bf16 v[192:195], a[104:107], a[224:227], v[192:195]
    v_fma_f32 v235, -s74, v95, v143
    v_cvt_pk_bf16_f32 v244, v244, v245
    v_mfma_f32_16x16x32_bf16 v[172:175], a[108:111], a[224:227], v[172:175]
    global_load_dwordx4 a[80:83], v11, s[44:45] offset:-1024 sc1
    v_mfma_f32_16x16x32_bf16 v[176:179], a[112:115], a[224:227], v[176:179]
    v_cvt_pk_bf16_f32 v245, v246, v247
    v_cvt_pk_bf16_f32 v246, v248, v249
    v_mfma_f32_16x16x32_bf16 v[180:183], a[116:119], a[224:227], v[180:183]
    v_cvt_pk_bf16_f32 v247, v250, v251
    v_mfma_f32_16x16x32_bf16 v[196:199], a[96:99], a[228:231], v[196:199]
    ds_read_b128 a[224:227], v9 offset:50752
    v_mfma_f32_16x16x32_bf16 v[200:203], a[100:103], a[228:231], v[200:203]
    ds_write_b64 v8, v[244:245] offset:12672
    v_mfma_f32_16x16x32_bf16 v[204:207], a[104:107], a[228:231], v[204:207]
    ds_write_b64 v8, v[246:247] offset:12680
    v_mfma_f32_16x16x32_bf16 v[184:187], a[108:111], a[228:231], v[184:187]
    global_load_dwordx4 a[84:87], v11, s[44:45] offset:0 sc1
    v_mfma_f32_16x16x32_bf16 v[188:191], a[112:115], a[228:231], v[188:191]
    v_fmac_f32 v220, s72, v112
    v_fmac_f32 v221, s72, v113
    v_mfma_f32_16x16x32_bf16 v[192:195], a[116:119], a[228:231], v[192:195]
    s_waitcnt lgkmcnt(7)
    v_fmac_f32 v222, s72, v114
    v_fmac_f32 v223, s72, v115
    v_mfma_f32_16x16x32_bf16 v[208:211], a[96:99], a[232:235], v[208:211]
    ds_read_b128 a[228:231], v10 offset:64
    v_fmac_f32 v224, s72, v116
    v_mfma_f32_16x16x32_bf16 v[212:215], a[100:103], a[232:235], v[212:215]
    v_fmac_f32 v225, s72, v117
    v_fmac_f32 v226, s72, v118
    v_mfma_f32_16x16x32_bf16 v[216:219], a[104:107], a[232:235], v[216:219]
    v_fmac_f32 v227, s72, v119
    v_fmac_f32 v228, s76, v40
    v_mfma_f32_16x16x32_bf16 v[196:199], a[108:111], a[232:235], v[196:199]
    global_load_dwordx4 a[88:91], v11, s[44:45] offset:1024 sc1
    v_mfma_f32_16x16x32_bf16 v[200:203], a[112:115], a[232:235], v[200:203]
    v_fmac_f32 v229, s76, v41
    v_fmac_f32 v230, s76, v42
    v_mfma_f32_16x16x32_bf16 v[204:207], a[116:119], a[232:235], v[204:207]
    v_fmac_f32 v231, s76, v43
    v_fmac_f32 v232, s76, v44
    v_mfma_f32_16x16x32_bf16 v[208:211], a[108:111], a[236:239], v[208:211]
    ds_read_b128 a[232:235], v10 offset:25408
    v_fmac_f32 v233, s76, v45
    v_mfma_f32_16x16x32_bf16 v[212:215], a[112:115], a[236:239], v[212:215]
    global_load_dwordx4 a[92:95], v11, s[44:45] offset:2048 sc1
    v_mfma_f32_16x16x32_bf16 v[216:219], a[116:119], a[236:239], v[216:219]
    s_waitcnt vmcnt(6) lgkmcnt(1)
    v_fmac_f32 v234, s76, v46
    v_fmac_f32 v235, s76, v47
    v_mfma_f32_16x16x32_bf16 v[160:163], a[120:123], a[216:219], v[160:163]
    ds_read_b128 a[236:239], v10 offset:50752
    v_cvt_pk_bf16_f32 v220, v220, v221
    v_mfma_f32_16x16x32_bf16 v[164:167], a[124:127], a[216:219], v[164:167]
    v_cvt_pk_bf16_f32 v221, v222, v223
    v_cvt_pk_bf16_f32 v222, v224, v225
    v_mfma_f32_16x16x32_bf16 v[168:171], a[128:131], a[216:219], v[168:171]
    v_add_u32 v9, 96, v9
    v_cvt_pk_bf16_f32 v223, v226, v227
    v_mfma_f32_16x16x32_bf16 v[172:175], a[120:123], a[220:223], v[172:175]
    ds_read_b128 a[216:219], v9 offset:0
    v_add_u32 v11, 6144, v11
    v_mfma_f32_16x16x32_bf16 v[176:179], a[124:127], a[220:223], v[176:179]
    global_load_dwordx4 a[96:99], v11, s[44:45] offset:-3072 sc1
    v_mfma_f32_16x16x32_bf16 v[180:183], a[128:131], a[220:223], v[180:183]
    ds_write_b64 v8, v[220:221] offset:16896
    v_mfma_f32_16x16x32_bf16 v[160:163], a[132:135], a[220:223], v[160:163]
    global_load_dwordx4 a[100:103], v11, s[44:45] offset:-2048 sc1
    v_mfma_f32_16x16x32_bf16 v[164:167], a[136:139], a[220:223], v[164:167]
    ds_write_b64 v8, v[222:223] offset:16904
    v_mfma_f32_16x16x32_bf16 v[168:171], a[140:143], a[220:223], v[168:171]
    v_cvt_pk_bf16_f32 v228, v228, v229
    v_cvt_pk_bf16_f32 v229, v230, v231
    v_mfma_f32_16x16x32_bf16 v[184:187], a[120:123], a[224:227], v[184:187]
    ds_read_b128 a[220:223], v9 offset:25344
    v_cvt_pk_bf16_f32 v230, v232, v233
    v_mfma_f32_16x16x32_bf16 v[188:191], a[124:127], a[224:227], v[188:191]
    v_cvt_pk_bf16_f32 v231, v234, v235
    v_mfma_f32_16x16x32_bf16 v[192:195], a[128:131], a[224:227], v[192:195]
    ds_write_b64 v8, v[228:229] offset:21120
    v_mfma_f32_16x16x32_bf16 v[172:175], a[132:135], a[224:227], v[172:175]
    global_load_dwordx4 a[104:107], v11, s[44:45] offset:-1024 sc1
    v_mfma_f32_16x16x32_bf16 v[176:179], a[136:139], a[224:227], v[176:179]
    ds_write_b64 v8, v[230:231] offset:21128
    v_mfma_f32_16x16x32_bf16 v[180:183], a[140:143], a[224:227], v[180:183]
    v_fma_f32 v220, -s66, v72, v120
    v_fma_f32 v221, -s66, v73, v121
    v_mfma_f32_16x16x32_bf16 v[196:199], a[120:123], a[228:231], v[196:199]
    ds_read_b128 a[224:227], v9 offset:50688
    v_fma_f32 v222, -s66, v74, v122
    v_mfma_f32_16x16x32_bf16 v[200:203], a[124:127], a[228:231], v[200:203]
    v_fma_f32 v223, -s66, v75, v123
    v_fma_f32 v224, -s66, v76, v124
    v_mfma_f32_16x16x32_bf16 v[204:207], a[128:131], a[228:231], v[204:207]
    v_fma_f32 v225, -s66, v77, v125
    v_fma_f32 v226, -s66, v78, v126
    v_mfma_f32_16x16x32_bf16 v[184:187], a[132:135], a[228:231], v[184:187]
    global_load_dwordx4 a[108:111], v11, s[44:45] offset:0 sc1
    v_mfma_f32_16x16x32_bf16 v[188:191], a[136:139], a[228:231], v[188:191]
    v_fma_f32 v227, -s66, v79, v127
    v_fma_f32 v228, -s66, v48, v96
    v_mfma_f32_16x16x32_bf16 v[192:195], a[140:143], a[228:231], v[192:195]
    s_waitcnt lgkmcnt(7)
    v_add_u32 v10, 96, v10
    v_fma_f32 v229, -s66, v49, v97
    v_mfma_f32_16x16x32_bf16 v[208:211], a[120:123], a[232:235], v[208:211]
    ds_read_b128 a[228:231], v10 offset:0
    v_fma_f32 v230, -s66, v50, v98
    v_mfma_f32_16x16x32_bf16 v[212:215], a[124:127], a[232:235], v[212:215]
    v_fma_f32 v231, -s66, v51, v99
    v_fma_f32 v232, -s66, v52, v100
    v_mfma_f32_16x16x32_bf16 v[216:219], a[128:131], a[232:235], v[216:219]
    v_fma_f32 v233, -s66, v53, v101
    v_fma_f32 v234, -s66, v54, v102
    v_mfma_f32_16x16x32_bf16 v[196:199], a[132:135], a[232:235], v[196:199]
    global_load_dwordx4 a[112:115], v11, s[44:45] offset:1024 sc1
    v_mfma_f32_16x16x32_bf16 v[200:203], a[136:139], a[232:235], v[200:203]
    v_fma_f32 v235, -s66, v55, v103
    v_fma_f32 v236, s64, v228, v220
    v_mfma_f32_16x16x32_bf16 v[204:207], a[140:143], a[232:235], v[204:207]
    v_fma_f32 v237, s64, v229, v221
    v_fma_f32 v238, s64, v230, v222
    v_mfma_f32_16x16x32_bf16 v[208:211], a[132:135], a[236:239], v[208:211]
    ds_read_b128 a[232:235], v10 offset:25344
    v_fma_f32 v239, s64, v231, v223
    v_mfma_f32_16x16x32_bf16 v[212:215], a[136:139], a[236:239], v[212:215]
    global_load_dwordx4 a[116:119], v11, s[44:45] offset:2048 sc1
    v_mfma_f32_16x16x32_bf16 v[216:219], a[140:143], a[236:239], v[216:219]
    v_fma_f32 v240, s64, v232, v224
    v_fma_f32 v241, s64, v233, v225
    s_waitcnt vmcnt(6) lgkmcnt(1)
    v_mfma_f32_16x16x32_bf16 v[160:163], a[72:75], a[216:219], v[160:163]
    ds_read_b128 a[236:239], v10 offset:50688
    v_fma_f32 v242, s64, v234, v226
    v_mfma_f32_16x16x32_bf16 v[164:167], a[76:79], a[216:219], v[164:167]
    v_add_u32 v11, 6144, v11
    v_fma_f32 v243, s64, v235, v227
    v_mfma_f32_16x16x32_bf16 v[168:171], a[80:83], a[216:219], v[168:171]
    global_load_dwordx4 a[120:123], v11, s[44:45] offset:-3072 sc1
    v_mfma_f32_16x16x32_bf16 v[172:175], a[72:75], a[220:223], v[172:175]
    s_mov_b32 s53, 96
    ds_read_b128 a[216:219], v9 offset:32
    v_fma_f32 v244, -s64, v228, v220
    v_mfma_f32_16x16x32_bf16 v[176:179], a[76:79], a[220:223], v[176:179]
    v_fma_f32 v245, -s64, v229, v221
    v_fma_f32 v246, -s64, v230, v222
    v_mfma_f32_16x16x32_bf16 v[180:183], a[80:83], a[220:223], v[180:183]
    v_fma_f32 v247, -s64, v231, v223
    v_fma_f32 v248, -s64, v232, v224
    v_mfma_f32_16x16x32_bf16 v[160:163], a[84:87], a[220:223], v[160:163]
    global_load_dwordx4 a[124:127], v11, s[44:45] offset:-2048 sc1
    v_mfma_f32_16x16x32_bf16 v[164:167], a[88:91], a[220:223], v[164:167]
    v_fma_f32 v249, -s64, v233, v225
    v_fma_f32 v250, -s64, v234, v226
    v_mfma_f32_16x16x32_bf16 v[168:171], a[92:95], a[220:223], v[168:171]
    v_fma_f32 v251, -s64, v235, v227
    v_fma_f32 v220, -s70, v72, v24
    v_mfma_f32_16x16x32_bf16 v[184:187], a[72:75], a[224:227], v[184:187]
    ds_read_b128 a[220:223], v9 offset:25376
    v_fma_f32 v221, -s70, v73, v25
    v_mfma_f32_16x16x32_bf16 v[188:191], a[76:79], a[224:227], v[188:191]
    v_fma_f32 v222, -s70, v74, v26
    v_fma_f32 v223, -s70, v75, v27
    v_mfma_f32_16x16x32_bf16 v[192:195], a[80:83], a[224:227], v[192:195]
    v_fma_f32 v224, -s70, v76, v28
    v_fma_f32 v225, -s70, v77, v29
    v_mfma_f32_16x16x32_bf16 v[172:175], a[84:87], a[224:227], v[172:175]
    global_load_dwordx4 a[128:131], v11, s[44:45] offset:-1024 sc1
    v_mfma_f32_16x16x32_bf16 v[176:179], a[88:91], a[224:227], v[176:179]
    v_fma_f32 v226, -s70, v78, v30
    v_fma_f32 v227, -s70, v79, v31
    v_mfma_f32_16x16x32_bf16 v[180:183], a[92:95], a[224:227], v[180:183]
    v_cvt_pk_bf16_f32 v236, v236, v237
    v_cvt_pk_bf16_f32 v237, v238, v239
    v_mfma_f32_16x16x32_bf16 v[196:199], a[72:75], a[228:231], v[196:199]
    ds_read_b128 a[224:227], v9 offset:50720
    v_cvt_pk_bf16_f32 v238, v240, v241
    v_mfma_f32_16x16x32_bf16 v[200:203], a[76:79], a[228:231], v[200:203]
    v_cvt_pk_bf16_f32 v239, v242, v243
    v_mfma_f32_16x16x32_bf16 v[204:207], a[80:83], a[228:231], v[204:207]
    ds_write_b64 v8, v[236:237] offset:8480
    v_mfma_f32_16x16x32_bf16 v[184:187], a[84:87], a[228:231], v[184:187]
    global_load_dwordx4 a[132:135], v11, s[44:45] offset:0 sc1
    v_mfma_f32_16x16x32_bf16 v[188:191], a[88:91], a[228:231], v[188:191]
    ds_write_b64 v8, v[238:239] offset:8488
    v_mfma_f32_16x16x32_bf16 v[192:195], a[92:95], a[228:231], v[192:195]
    s_waitcnt lgkmcnt(5)
    v_fma_f32 v228, -s74, v96, v144
    v_fma_f32 v229, -s74, v97, v145
    v_mfma_f32_16x16x32_bf16 v[208:211], a[72:75], a[232:235], v[208:211]
    ds_read_b128 a[228:231], v10 offset:32
    v_fma_f32 v230, -s74, v98, v146
    v_mfma_f32_16x16x32_bf16 v[212:215], a[76:79], a[232:235], v[212:215]
    v_fma_f32 v231, -s74, v99, v147
    v_fma_f32 v232, -s74, v100, v148
    v_mfma_f32_16x16x32_bf16 v[216:219], a[80:83], a[232:235], v[216:219]
    v_fma_f32 v233, -s74, v101, v149
    v_fma_f32 v234, -s74, v102, v150
    v_mfma_f32_16x16x32_bf16 v[196:199], a[84:87], a[232:235], v[196:199]
    global_load_dwordx4 a[136:139], v11, s[44:45] offset:1024 sc1
    v_mfma_f32_16x16x32_bf16 v[200:203], a[88:91], a[232:235], v[200:203]
    v_fma_f32 v235, -s74, v103, v151
    v_cvt_pk_bf16_f32 v244, v244, v245
    v_mfma_f32_16x16x32_bf16 v[204:207], a[92:95], a[232:235], v[204:207]
    v_cvt_pk_bf16_f32 v245, v246, v247
    v_cvt_pk_bf16_f32 v246, v248, v249
    v_mfma_f32_16x16x32_bf16 v[208:211], a[84:87], a[236:239], v[208:211]
    ds_read_b128 a[232:235], v10 offset:25376
    v_cvt_pk_bf16_f32 v247, v250, v251
    v_mfma_f32_16x16x32_bf16 v[212:215], a[88:91], a[236:239], v[212:215]
    global_load_dwordx4 a[140:143], v11, s[44:45] offset:2048 sc1
    v_mfma_f32_16x16x32_bf16 v[216:219], a[92:95], a[236:239], v[216:219]
    s_waitcnt vmcnt(6) lgkmcnt(1)
    ds_write_b64 v8, v[244:245] offset:12704
    v_mfma_f32_16x16x32_bf16 v[160:163], a[96:99], a[216:219], v[160:163]
    ds_read_b128 a[236:239], v10 offset:50720
    v_mfma_f32_16x16x32_bf16 v[164:167], a[100:103], a[216:219], v[164:167]
    v_add_u32 v11, 6144, v11
    v_mfma_f32_16x16x32_bf16 v[168:171], a[104:107], a[216:219], v[168:171]
    global_load_dwordx4 a[72:75], v11, s[44:45] offset:-3072 sc1
    v_mfma_f32_16x16x32_bf16 v[172:175], a[96:99], a[220:223], v[172:175]
    ds_read_b128 a[216:219], v9 offset:64
    v_mfma_f32_16x16x32_bf16 v[176:179], a[100:103], a[220:223], v[176:179]
    ds_write_b64 v8, v[246:247] offset:12712
    v_mfma_f32_16x16x32_bf16 v[180:183], a[104:107], a[220:223], v[180:183]
    v_fmac_f32 v220, s72, v120
    v_fmac_f32 v221, s72, v121
    v_mfma_f32_16x16x32_bf16 v[160:163], a[108:111], a[220:223], v[160:163]
    global_load_dwordx4 a[76:79], v11, s[44:45] offset:-2048 sc1
    v_mfma_f32_16x16x32_bf16 v[164:167], a[112:115], a[220:223], v[164:167]
    v_fmac_f32 v222, s72, v122
    v_fmac_f32 v223, s72, v123
    v_mfma_f32_16x16x32_bf16 v[168:171], a[116:119], a[220:223], v[168:171]
    v_fmac_f32 v224, s72, v124
    v_fmac_f32 v225, s72, v125
    v_mfma_f32_16x16x32_bf16 v[184:187], a[96:99], a[224:227], v[184:187]
    ds_read_b128 a[220:223], v9 offset:25408
    v_fmac_f32 v226, s72, v126
    v_mfma_f32_16x16x32_bf16 v[188:191], a[100:103], a[224:227], v[188:191]
    v_fmac_f32 v227, s72, v127
    v_fmac_f32 v228, s76, v48
    v_mfma_f32_16x16x32_bf16 v[192:195], a[104:107], a[224:227], v[192:195]
    v_fmac_f32 v229, s76, v49
    v_fmac_f32 v230, s76, v50
    v_mfma_f32_16x16x32_bf16 v[172:175], a[108:111], a[224:227], v[172:175]
    global_load_dwordx4 a[80:83], v11, s[44:45] offset:-1024 sc1
    v_mfma_f32_16x16x32_bf16 v[176:179], a[112:115], a[224:227], v[176:179]
    v_fmac_f32 v231, s76, v51
    v_fmac_f32 v232, s76, v52
    v_mfma_f32_16x16x32_bf16 v[180:183], a[116:119], a[224:227], v[180:183]
    v_fmac_f32 v233, s76, v53
    v_fmac_f32 v234, s76, v54
    v_mfma_f32_16x16x32_bf16 v[196:199], a[96:99], a[228:231], v[196:199]
    ds_read_b128 a[224:227], v9 offset:50752
    v_fmac_f32 v235, s76, v55
    v_mfma_f32_16x16x32_bf16 v[200:203], a[100:103], a[228:231], v[200:203]
    v_cvt_pk_bf16_f32 v220, v220, v221
    v_cvt_pk_bf16_f32 v221, v222, v223
    v_mfma_f32_16x16x32_bf16 v[204:207], a[104:107], a[228:231], v[204:207]
    v_cvt_pk_bf16_f32 v222, v224, v225
    v_cvt_pk_bf16_f32 v223, v226, v227
    v_mfma_f32_16x16x32_bf16 v[184:187], a[108:111], a[228:231], v[184:187]
    global_load_dwordx4 a[84:87], v11, s[44:45] offset:0 sc1
    v_mfma_f32_16x16x32_bf16 v[188:191], a[112:115], a[228:231], v[188:191]
    ds_write_b64 v8, v[220:221] offset:16928
    v_mfma_f32_16x16x32_bf16 v[192:195], a[116:119], a[228:231], v[192:195]
    s_waitcnt lgkmcnt(5)
    ds_write_b64 v8, v[222:223] offset:16936
    v_mfma_f32_16x16x32_bf16 v[208:211], a[96:99], a[232:235], v[208:211]
    ds_read_b128 a[228:231], v10 offset:64
    v_cvt_pk_bf16_f32 v228, v228, v229
    v_mfma_f32_16x16x32_bf16 v[212:215], a[100:103], a[232:235], v[212:215]
    v_cvt_pk_bf16_f32 v229, v230, v231
    v_cvt_pk_bf16_f32 v230, v232, v233
    v_mfma_f32_16x16x32_bf16 v[216:219], a[104:107], a[232:235], v[216:219]
    v_cvt_pk_bf16_f32 v231, v234, v235
    v_mfma_f32_16x16x32_bf16 v[196:199], a[108:111], a[232:235], v[196:199]
    global_load_dwordx4 a[88:91], v11, s[44:45] offset:1024 sc1
    v_mfma_f32_16x16x32_bf16 v[200:203], a[112:115], a[232:235], v[200:203]
    ds_write_b64 v8, v[228:229] offset:21152
    v_mfma_f32_16x16x32_bf16 v[204:207], a[116:119], a[232:235], v[204:207]
    ds_write_b64 v8, v[230:231] offset:21160
    v_mfma_f32_16x16x32_bf16 v[208:211], a[108:111], a[236:239], v[208:211]
    ds_read_b128 a[232:235], v10 offset:25408
    v_fma_f32 v220, -s66, v80, v128
    v_mfma_f32_16x16x32_bf16 v[212:215], a[112:115], a[236:239], v[212:215]
    global_load_dwordx4 a[92:95], v11, s[44:45] offset:2048 sc1
    v_mfma_f32_16x16x32_bf16 v[216:219], a[116:119], a[236:239], v[216:219]
    s_waitcnt vmcnt(6) lgkmcnt(3)
    v_fma_f32 v221, -s66, v81, v129
    v_fma_f32 v222, -s66, v82, v130
    v_mfma_f32_16x16x32_bf16 v[160:163], a[120:123], a[216:219], v[160:163]
    ds_read_b128 a[236:239], v10 offset:50752
    v_fma_f32 v223, -s66, v83, v131
    v_mfma_f32_16x16x32_bf16 v[164:167], a[124:127], a[216:219], v[164:167]
    v_fma_f32 v224, -s66, v84, v132
    v_fma_f32 v225, -s66, v85, v133
    v_mfma_f32_16x16x32_bf16 v[168:171], a[128:131], a[216:219], v[168:171]
    v_add_u32 v9, 96, v9
    v_fma_f32 v226, -s66, v86, v134
    v_mfma_f32_16x16x32_bf16 v[172:175], a[120:123], a[220:223], v[172:175]
    ds_read_b128 a[216:219], v9 offset:0
    v_add_u32 v11, 6144, v11
    v_mfma_f32_16x16x32_bf16 v[176:179], a[124:127], a[220:223], v[176:179]
    global_load_dwordx4 a[96:99], v11, s[44:45] offset:-3072 sc1
    v_mfma_f32_16x16x32_bf16 v[180:183], a[128:131], a[220:223], v[180:183]
    v_fma_f32 v227, -s66, v87, v135
    v_fma_f32 v228, -s66, v56, v104
    v_mfma_f32_16x16x32_bf16 v[160:163], a[132:135], a[220:223], v[160:163]
    global_load_dwordx4 a[100:103], v11, s[44:45] offset:-2048 sc1
    v_mfma_f32_16x16x32_bf16 v[164:167], a[136:139], a[220:223], v[164:167]
    v_fma_f32 v229, -s66, v57, v105
    v_fma_f32 v230, -s66, v58, v106
    v_mfma_f32_16x16x32_bf16 v[168:171], a[140:143], a[220:223], v[168:171]
    v_fma_f32 v231, -s66, v59, v107
    v_fma_f32 v232, -s66, v60, v108
    v_mfma_f32_16x16x32_bf16 v[184:187], a[120:123], a[224:227], v[184:187]
    ds_read_b128 a[220:223], v9 offset:25344
    v_fma_f32 v233, -s66, v61, v109
    v_mfma_f32_16x16x32_bf16 v[188:191], a[124:127], a[224:227], v[188:191]
    v_fma_f32 v234, -s66, v62, v110
    v_fma_f32 v235, -s66, v63, v111
    v_mfma_f32_16x16x32_bf16 v[192:195], a[128:131], a[224:227], v[192:195]
    v_fma_f32 v236, s64, v228, v220
    v_fma_f32 v237, s64, v229, v221
    v_mfma_f32_16x16x32_bf16 v[172:175], a[132:135], a[224:227], v[172:175]
    global_load_dwordx4 a[104:107], v11, s[44:45] offset:-1024 sc1
    v_mfma_f32_16x16x32_bf16 v[176:179], a[136:139], a[224:227], v[176:179]
    v_fma_f32 v238, s64, v230, v222
    v_fma_f32 v239, s64, v231, v223
    v_mfma_f32_16x16x32_bf16 v[180:183], a[140:143], a[224:227], v[180:183]
    v_fma_f32 v240, s64, v232, v224
    v_fma_f32 v241, s64, v233, v225
    v_mfma_f32_16x16x32_bf16 v[196:199], a[120:123], a[228:231], v[196:199]
    ds_read_b128 a[224:227], v9 offset:50688
    v_fma_f32 v242, s64, v234, v226
    v_mfma_f32_16x16x32_bf16 v[200:203], a[124:127], a[228:231], v[200:203]
    v_fma_f32 v243, s64, v235, v227
    v_fma_f32 v244, -s64, v228, v220
    v_mfma_f32_16x16x32_bf16 v[204:207], a[128:131], a[228:231], v[204:207]
    v_fma_f32 v245, -s64, v229, v221
    v_fma_f32 v246, -s64, v230, v222
    v_mfma_f32_16x16x32_bf16 v[184:187], a[132:135], a[228:231], v[184:187]
    global_load_dwordx4 a[108:111], v11, s[44:45] offset:0 sc1
    v_mfma_f32_16x16x32_bf16 v[188:191], a[136:139], a[228:231], v[188:191]
    v_fma_f32 v247, -s64, v231, v223
    v_fma_f32 v248, -s64, v232, v224
    v_mfma_f32_16x16x32_bf16 v[192:195], a[140:143], a[228:231], v[192:195]
    s_waitcnt lgkmcnt(3)
    v_add_u32 v10, 96, v10
    v_fma_f32 v249, -s64, v233, v225
    v_mfma_f32_16x16x32_bf16 v[208:211], a[120:123], a[232:235], v[208:211]
    ds_read_b128 a[228:231], v10 offset:0
    v_fma_f32 v250, -s64, v234, v226
    v_mfma_f32_16x16x32_bf16 v[212:215], a[124:127], a[232:235], v[212:215]
    v_fma_f32 v251, -s64, v235, v227
    v_fma_f32 v220, -s70, v80, v32
    v_mfma_f32_16x16x32_bf16 v[216:219], a[128:131], a[232:235], v[216:219]
    v_fma_f32 v221, -s70, v81, v33
    v_fma_f32 v222, -s70, v82, v34
    v_mfma_f32_16x16x32_bf16 v[196:199], a[132:135], a[232:235], v[196:199]
    global_load_dwordx4 a[112:115], v11, s[44:45] offset:1024 sc1
    v_mfma_f32_16x16x32_bf16 v[200:203], a[136:139], a[232:235], v[200:203]
    v_fma_f32 v223, -s70, v83, v35
    v_fma_f32 v224, -s70, v84, v36
    v_mfma_f32_16x16x32_bf16 v[204:207], a[140:143], a[232:235], v[204:207]
    v_fma_f32 v225, -s70, v85, v37
    v_fma_f32 v226, -s70, v86, v38
    v_mfma_f32_16x16x32_bf16 v[208:211], a[132:135], a[236:239], v[208:211]
    ds_read_b128 a[232:235], v10 offset:25344
    v_fma_f32 v227, -s70, v87, v39
    v_mfma_f32_16x16x32_bf16 v[212:215], a[136:139], a[236:239], v[212:215]
    global_load_dwordx4 a[116:119], v11, s[44:45] offset:2048 sc1
    v_mfma_f32_16x16x32_bf16 v[216:219], a[140:143], a[236:239], v[216:219]
    v_cvt_pk_bf16_f32 v236, v236, v237
    v_cvt_pk_bf16_f32 v237, v238, v239
    s_waitcnt vmcnt(6) lgkmcnt(1)
    v_mfma_f32_16x16x32_bf16 v[160:163], a[72:75], a[216:219], v[160:163]
    ds_read_b128 a[236:239], v10 offset:50688
    v_cvt_pk_bf16_f32 v238, v240, v241
    v_mfma_f32_16x16x32_bf16 v[164:167], a[76:79], a[216:219], v[164:167]
    v_add_u32 v11, 6144, v11
    v_cvt_pk_bf16_f32 v239, v242, v243
    v_mfma_f32_16x16x32_bf16 v[168:171], a[80:83], a[216:219], v[168:171]
    global_load_dwordx4 a[120:123], v11, s[44:45] offset:-3072 sc1
    v_mfma_f32_16x16x32_bf16 v[172:175], a[72:75], a[220:223], v[172:175]
    s_mov_b32 s53, 96
    ds_read_b128 a[216:219], v9 offset:32
    v_mfma_f32_16x16x32_bf16 v[176:179], a[76:79], a[220:223], v[176:179]
    ds_write_b64 v8, v[236:237] offset:8512
    v_mfma_f32_16x16x32_bf16 v[180:183], a[80:83], a[220:223], v[180:183]
    ds_write_b64 v8, v[238:239] offset:8520
    v_mfma_f32_16x16x32_bf16 v[160:163], a[84:87], a[220:223], v[160:163]
    s_mov_b32 s52, 4
    global_load_dwordx4 a[124:127], v11, s[44:45] offset:-2048 sc1
    v_mfma_f32_16x16x32_bf16 v[164:167], a[88:91], a[220:223], v[164:167]
    v_fma_f32 v228, -s74, v104, v152
    v_fma_f32 v229, -s74, v105, v153
    v_mfma_f32_16x16x32_bf16 v[168:171], a[92:95], a[220:223], v[168:171]
    v_fma_f32 v230, -s74, v106, v154
    v_fma_f32 v231, -s74, v107, v155
    v_mfma_f32_16x16x32_bf16 v[184:187], a[72:75], a[224:227], v[184:187]
    ds_read_b128 a[220:223], v9 offset:25376
    v_fma_f32 v232, -s74, v108, v156
    v_mfma_f32_16x16x32_bf16 v[188:191], a[76:79], a[224:227], v[188:191]
    v_fma_f32 v233, -s74, v109, v157
    v_fma_f32 v234, -s74, v110, v158
    v_mfma_f32_16x16x32_bf16 v[192:195], a[80:83], a[224:227], v[192:195]
    v_fma_f32 v235, -s74, v111, v159
    v_cvt_pk_bf16_f32 v244, v244, v245
    v_mfma_f32_16x16x32_bf16 v[172:175], a[84:87], a[224:227], v[172:175]
    global_load_dwordx4 a[128:131], v11, s[44:45] offset:-1024 sc1
    v_mfma_f32_16x16x32_bf16 v[176:179], a[88:91], a[224:227], v[176:179]
    v_cvt_pk_bf16_f32 v245, v246, v247
    v_cvt_pk_bf16_f32 v246, v248, v249
    v_mfma_f32_16x16x32_bf16 v[180:183], a[92:95], a[224:227], v[180:183]
    v_cvt_pk_bf16_f32 v247, v250, v251
    v_mfma_f32_16x16x32_bf16 v[196:199], a[72:75], a[228:231], v[196:199]
    ds_read_b128 a[224:227], v9 offset:50720
    v_mfma_f32_16x16x32_bf16 v[200:203], a[76:79], a[228:231], v[200:203]
    ds_write_b64 v8, v[244:245] offset:12736
    v_mfma_f32_16x16x32_bf16 v[204:207], a[80:83], a[228:231], v[204:207]
    ds_write_b64 v8, v[246:247] offset:12744
    v_mfma_f32_16x16x32_bf16 v[184:187], a[84:87], a[228:231], v[184:187]
    global_load_dwordx4 a[132:135], v11, s[44:45] offset:0 sc1
    v_mfma_f32_16x16x32_bf16 v[188:191], a[88:91], a[228:231], v[188:191]
    v_fmac_f32 v220, s72, v128
    v_fmac_f32 v221, s72, v129
    v_mfma_f32_16x16x32_bf16 v[192:195], a[92:95], a[228:231], v[192:195]
    s_waitcnt lgkmcnt(7)
    v_fmac_f32 v222, s72, v130
    v_fmac_f32 v223, s72, v131
    v_mfma_f32_16x16x32_bf16 v[208:211], a[72:75], a[232:235], v[208:211]
    ds_read_b128 a[228:231], v10 offset:32
    v_fmac_f32 v224, s72, v132
    v_mfma_f32_16x16x32_bf16 v[212:215], a[76:79], a[232:235], v[212:215]
    v_fmac_f32 v225, s72, v133
    v_fmac_f32 v226, s72, v134
    v_mfma_f32_16x16x32_bf16 v[216:219], a[80:83], a[232:235], v[216:219]
    v_fmac_f32 v227, s72, v135
    v_fmac_f32 v228, s76, v56
    v_mfma_f32_16x16x32_bf16 v[196:199], a[84:87], a[232:235], v[196:199]
    global_load_dwordx4 a[136:139], v11, s[44:45] offset:1024 sc1
    v_mfma_f32_16x16x32_bf16 v[200:203], a[88:91], a[232:235], v[200:203]
    v_fmac_f32 v229, s76, v57
    v_fmac_f32 v230, s76, v58
    v_mfma_f32_16x16x32_bf16 v[204:207], a[92:95], a[232:235], v[204:207]
    v_fmac_f32 v231, s76, v59
    v_fmac_f32 v232, s76, v60
    v_mfma_f32_16x16x32_bf16 v[208:211], a[84:87], a[236:239], v[208:211]
    ds_read_b128 a[232:235], v10 offset:25376
    v_fmac_f32 v233, s76, v61
    v_mfma_f32_16x16x32_bf16 v[212:215], a[88:91], a[236:239], v[212:215]
    global_load_dwordx4 a[140:143], v11, s[44:45] offset:2048 sc1
    v_mfma_f32_16x16x32_bf16 v[216:219], a[92:95], a[236:239], v[216:219]
    s_waitcnt vmcnt(6) lgkmcnt(1)
    v_fmac_f32 v234, s76, v62
    v_fmac_f32 v235, s76, v63
    v_mfma_f32_16x16x32_bf16 v[160:163], a[96:99], a[216:219], v[160:163]
    ds_read_b128 a[236:239], v10 offset:50720
    v_cvt_pk_bf16_f32 v220, v220, v221
    v_mfma_f32_16x16x32_bf16 v[164:167], a[100:103], a[216:219], v[164:167]
    v_add_u32 v11, 6144, v11
    v_cvt_pk_bf16_f32 v221, v222, v223
    v_mfma_f32_16x16x32_bf16 v[168:171], a[104:107], a[216:219], v[168:171]
    global_load_dwordx4 a[72:75], v11, s[44:45] offset:-3072 sc1
    v_mfma_f32_16x16x32_bf16 v[172:175], a[96:99], a[220:223], v[172:175]
    ds_read_b128 a[216:219], v9 offset:64
    v_cvt_pk_bf16_f32 v222, v224, v225
    v_mfma_f32_16x16x32_bf16 v[176:179], a[100:103], a[220:223], v[176:179]
    v_cvt_pk_bf16_f32 v223, v226, v227
    v_mfma_f32_16x16x32_bf16 v[180:183], a[104:107], a[220:223], v[180:183]
    ds_write_b64 v8, v[220:221] offset:16960
    v_mfma_f32_16x16x32_bf16 v[160:163], a[108:111], a[220:223], v[160:163]
    global_load_dwordx4 a[76:79], v11, s[44:45] offset:-2048 sc1
    v_mfma_f32_16x16x32_bf16 v[164:167], a[112:115], a[220:223], v[164:167]
    ds_write_b64 v8, v[222:223] offset:16968
    v_mfma_f32_16x16x32_bf16 v[168:171], a[116:119], a[220:223], v[168:171]
    v_cvt_pk_bf16_f32 v228, v228, v229
    v_cvt_pk_bf16_f32 v229, v230, v231
    v_mfma_f32_16x16x32_bf16 v[184:187], a[96:99], a[224:227], v[184:187]
    ds_read_b128 a[220:223], v9 offset:25408
    v_cvt_pk_bf16_f32 v230, v232, v233
    v_mfma_f32_16x16x32_bf16 v[188:191], a[100:103], a[224:227], v[188:191]
    v_cvt_pk_bf16_f32 v231, v234, v235
    v_mfma_f32_16x16x32_bf16 v[192:195], a[104:107], a[224:227], v[192:195]
    ds_write_b64 v8, v[228:229] offset:21184
    v_mfma_f32_16x16x32_bf16 v[172:175], a[108:111], a[224:227], v[172:175]
    global_load_dwordx4 a[80:83], v11, s[44:45] offset:-1024 sc1
    v_mfma_f32_16x16x32_bf16 v[176:179], a[112:115], a[224:227], v[176:179]
    ds_write_b64 v8, v[230:231] offset:21192
    v_mfma_f32_16x16x32_bf16 v[180:183], a[116:119], a[224:227], v[180:183]
    s_lshl_b32 s54, s19, 31
    v_mfma_f32_16x16x32_bf16 v[196:199], a[96:99], a[228:231], v[196:199]
    s_xor_b32 s78, s62, s54
    ds_read_b128 a[224:227], v9 offset:50752
    v_mfma_f32_16x16x32_bf16 v[200:203], a[100:103], a[228:231], v[200:203]
    s_xor_b32 s79, s64, s54
    v_lshlrev_b32 v14, 3, v1
    v_mfma_f32_16x16x32_bf16 v[204:207], a[104:107], a[228:231], v[204:207]
    s_mul_i32 s55, s48, 50688
    v_mfma_f32_16x16x32_bf16 v[184:187], a[108:111], a[228:231], v[184:187]
    s_add_u32 s56, s55, s11
    global_load_dwordx4 a[84:87], v11, s[44:45] offset:0 sc1
    v_mfma_f32_16x16x32_bf16 v[188:191], a[112:115], a[228:231], v[188:191]
    v_add_u32 v12, s56, v14
    v_mfma_f32_16x16x32_bf16 v[192:195], a[116:119], a[228:231], v[192:195]
    s_waitcnt lgkmcnt(7)
    v_mfma_f32_16x16x32_bf16 v[208:211], a[96:99], a[232:235], v[208:211]
    s_xor_b32 s54, s11, 4224
    ds_read_b128 a[228:231], v10 offset:64
    v_mfma_f32_16x16x32_bf16 v[212:215], a[100:103], a[232:235], v[212:215]
    s_add_u32 s56, s55, s54
    v_add_u32 v13, s56, v14
    v_mfma_f32_16x16x32_bf16 v[216:219], a[104:107], a[232:235], v[216:219]
    s_mul_i32 s54, s48, 4224
    v_mfma_f32_16x16x32_bf16 v[196:199], a[108:111], a[232:235], v[196:199]
    s_add_u32 s54, s54, 101376
    global_load_dwordx4 a[88:91], v11, s[44:45] offset:1024 sc1
    v_mfma_f32_16x16x32_bf16 v[200:203], a[112:115], a[232:235], v[200:203]
    v_add_u32 v14, s54, v14
    v_mfma_f32_16x16x32_bf16 v[204:207], a[116:119], a[232:235], v[204:207]
    s_mul_i32 s54, s49, 224
    v_mfma_f32_16x16x32_bf16 v[208:211], a[108:111], a[236:239], v[208:211]
    s_add_u32 s54, s54, s50
    ds_read_b128 a[232:235], v10 offset:25408
    v_mfma_f32_16x16x32_bf16 v[212:215], a[112:115], a[236:239], v[212:215]
    s_lshl2_add_u32 s54, s18, s54
    global_load_dwordx4 a[92:95], v11, s[44:45] offset:2048 sc1
    v_mfma_f32_16x16x32_bf16 v[216:219], a[116:119], a[236:239], v[216:219]
    s_waitcnt vmcnt(6) lgkmcnt(1)
    v_mfma_f32_16x16x32_bf16 v[160:163], a[120:123], a[216:219], v[160:163]
    s_mul_i32 s54, s54, 192
    ds_read_b128 a[236:239], v10 offset:50752
    v_add_u32 v6, 16, v1
    v_mfma_f32_16x16x32_bf16 v[164:167], a[124:127], a[216:219], v[164:167]
    v_lshrrev_b32 v6, 6, v6
    v_lshlrev_b32 v6, 31, v6
    v_mfma_f32_16x16x32_bf16 v[168:171], a[128:131], a[216:219], v[168:171]
    v_add_u32 v9, 96, v9
    v_lshl_add_u32 v15, v1, 4, v6
    v_mfma_f32_16x16x32_bf16 v[172:175], a[120:123], a[220:223], v[172:175]
    ds_read_b128 a[216:219], v9 offset:0
    v_add_u32 v11, 6144, v11
    v_mfma_f32_16x16x32_bf16 v[176:179], a[124:127], a[220:223], v[176:179]
    global_load_dwordx4 a[96:99], v11, s[44:45] offset:-3072 sc1
    v_mfma_f32_16x16x32_bf16 v[180:183], a[128:131], a[220:223], v[180:183]
    v_add_u32 v15, s54, v15
    v_mfma_f32_16x16x32_bf16 v[160:163], a[132:135], a[220:223], v[160:163]
    global_load_dwordx4 a[100:103], v11, s[44:45] offset:-2048 sc1
    v_mfma_f32_16x16x32_bf16 v[164:167], a[136:139], a[220:223], v[164:167]
    v_mfma_f32_16x16x32_bf16 v[168:171], a[140:143], a[220:223], v[168:171]
    v_mfma_f32_16x16x32_bf16 v[184:187], a[120:123], a[224:227], v[184:187]
    ds_read_b128 a[220:223], v9 offset:25344
    v_mfma_f32_16x16x32_bf16 v[188:191], a[124:127], a[224:227], v[188:191]
    v_mfma_f32_16x16x32_bf16 v[192:195], a[128:131], a[224:227], v[192:195]
    v_mfma_f32_16x16x32_bf16 v[172:175], a[132:135], a[224:227], v[172:175]
    global_load_dwordx4 a[104:107], v11, s[44:45] offset:-1024 sc1
    v_mfma_f32_16x16x32_bf16 v[176:179], a[136:139], a[224:227], v[176:179]
    v_mfma_f32_16x16x32_bf16 v[180:183], a[140:143], a[224:227], v[180:183]
    v_mfma_f32_16x16x32_bf16 v[196:199], a[120:123], a[228:231], v[196:199]
    ds_read_b128 a[224:227], v9 offset:50688
    v_mfma_f32_16x16x32_bf16 v[200:203], a[124:127], a[228:231], v[200:203]
    v_mfma_f32_16x16x32_bf16 v[204:207], a[128:131], a[228:231], v[204:207]
    v_mfma_f32_16x16x32_bf16 v[184:187], a[132:135], a[228:231], v[184:187]
    global_load_dwordx4 a[108:111], v11, s[44:45] offset:0 sc1
    v_mfma_f32_16x16x32_bf16 v[188:191], a[136:139], a[228:231], v[188:191]
    v_mfma_f32_16x16x32_bf16 v[192:195], a[140:143], a[228:231], v[192:195]
    s_waitcnt lgkmcnt(3)
    v_add_u32 v10, 96, v10
    v_mfma_f32_16x16x32_bf16 v[208:211], a[120:123], a[232:235], v[208:211]
    ds_read_b128 a[228:231], v10 offset:0
    v_mfma_f32_16x16x32_bf16 v[212:215], a[124:127], a[232:235], v[212:215]
    v_mfma_f32_16x16x32_bf16 v[216:219], a[128:131], a[232:235], v[216:219]
    v_mfma_f32_16x16x32_bf16 v[196:199], a[132:135], a[232:235], v[196:199]
    global_load_dwordx4 a[112:115], v11, s[44:45] offset:1024 sc1
    v_mfma_f32_16x16x32_bf16 v[200:203], a[136:139], a[232:235], v[200:203]
    v_mfma_f32_16x16x32_bf16 v[204:207], a[140:143], a[232:235], v[204:207]
    v_mfma_f32_16x16x32_bf16 v[208:211], a[132:135], a[236:239], v[208:211]
    s_barrier
    ds_read_b128 a[232:235], v10 offset:25344
    v_mfma_f32_16x16x32_bf16 v[212:215], a[136:139], a[236:239], v[212:215]
    global_load_dwordx4 a[116:119], v11, s[44:45] offset:2048 sc1
    v_mfma_f32_16x16x32_bf16 v[216:219], a[140:143], a[236:239], v[216:219]
.p2align 5
L_IT3:
L_LOOP1:
    s_waitcnt vmcnt(6) lgkmcnt(1)
    v_mfma_f32_16x16x32_bf16 v[160:163], a[72:75], a[216:219], v[160:163]
    ds_read_b128 a[236:239], v10 offset:50688
    v_mfma_f32_16x16x32_bf16 v[164:167], a[76:79], a[216:219], v[164:167]
    v_add_u32 v11, 6144, v11
    v_mfma_f32_16x16x32_bf16 v[168:171], a[80:83], a[216:219], v[168:171]
    global_load_dwordx4 a[120:123], v11, s[44:45] offset:-3072 sc1
    v_mfma_f32_16x16x32_bf16 v[172:175], a[72:75], a[220:223], v[172:175]
    ds_read_b128 a[216:219], v9 offset:32
    v_mfma_f32_16x16x32_bf16 v[176:179], a[76:79], a[220:223], v[176:179]
HOP2_0:
    s_cbranch_execz HOP2_1
    v_mfma_f32_16x16x32_bf16 v[180:183], a[80:83], a[220:223], v[180:183]
    v_mfma_f32_16x16x32_bf16 v[160:163], a[84:87], a[220:223], v[160:163]
    global_load_dwordx4 a[124:127], v11, s[44:45] offset:-2048 sc1
    v_mfma_f32_16x16x32_bf16 v[164:167], a[88:91], a[220:223], v[164:167]
    s_sub_u32 s52, s52, 1
    v_mfma_f32_16x16x32_bf16 v[168:171], a[92:95], a[220:223], v[168:171]
    v_mfma_f32_16x16x32_bf16 v[184:187], a[72:75], a[224:227], v[184:187]
    ds_read_b128 a[220:223], v9 offset:25376
    v_mfma_f32_16x16x32_bf16 v[188:191], a[76:79], a[224:227], v[188:191]
    v_mfma_f32_16x16x32_bf16 v[192:195], a[80:83], a[224:227], v[192:195]
    v_mfma_f32_16x16x32_bf16 v[172:175], a[84:87], a[224:227], v[172:175]
    global_load_dwordx4 a[128:131], v11, s[44:45] offset:-1024 sc1
    v_mfma_f32_16x16x32_bf16 v[176:179], a[88:91], a[224:227], v[176:179]
    s_cmp_eq_u32 s52, 0
    s_cselect_b32 s53, s59, 96
    v_mfma_f32_16x16x32_bf16 v[180:183], a[92:95], a[224:227], v[180:183]
    v_mfma_f32_16x16x32_bf16 v[196:199], a[72:75], a[228:231], v[196:199]
    ds_read_b128 a[224:227], v9 offset:50720
    v_mfma_f32_16x16x32_bf16 v[200:203], a[76:79], a[228:231], v[200:203]
    v_mfma_f32_16x16x32_bf16 v[204:207], a[80:83], a[228:231], v[204:207]
    v_mfma_f32_16x16x32_bf16 v[184:187], a[84:87], a[228:231], v[184:187]
    global_load_dwordx4 a[132:135], v11, s[44:45] offset:0 sc1
    v_mfma_f32_16x16x32_bf16 v[188:191], a[88:91], a[228:231], v[188:191]
    v_mfma_f32_16x16x32_bf16 v[192:195], a[92:95], a[228:231], v[192:195]
    s_waitcnt lgkmcnt(3)
    v_mfma_f32_16x16x32_bf16 v[208:211], a[72:75], a[232:235], v[208:211]
    ds_read_b128 a[228:231], v10 offset:32
    v_mfma_f32_16x16x32_bf16 v[212:215], a[76:79], a[232:235], v[212:215]
    v_mfma_f32_16x16x32_bf16 v[216:219], a[80:83], a[232:235], v[216:219]
    v_mfma_f32_16x16x32_bf16 v[196:199], a[84:87], a[232:235], v[196:199]
    global_load_dwordx4 a[136:139], v11, s[44:45] offset:1024 sc1
    v_mfma_f32_16x16x32_bf16 v[200:203], a[88:91], a[232:235], v[200:203]
HOP2_1:
    s_cbranch_execz HOP2_2
    v_mfma_f32_16x16x32_bf16 v[204:207], a[92:95], a[232:235], v[204:207]
    v_mfma_f32_16x16x32_bf16 v[208:211], a[84:87], a[236:239], v[208:211]
    ds_read_b128 a[232:235], v10 offset:25376
    v_mfma_f32_16x16x32_bf16 v[212:215], a[88:91], a[236:239], v[212:215]
    global_load_dwordx4 a[140:143], v11, s[44:45] offset:2048 sc1
    v_mfma_f32_16x16x32_bf16 v[216:219], a[92:95], a[236:239], v[216:219]
    s_waitcnt vmcnt(6) lgkmcnt(1)
    v_mfma_f32_16x16x32_bf16 v[160:163], a[96:99], a[216:219], v[160:163]
    ds_read_b128 a[236:239], v10 offset:50720
    v_mfma_f32_16x16x32_bf16 v[164:167], a[100:103], a[216:219], v[164:167]
    v_add_u32 v11, 6144, v11
    v_mfma_f32_16x16x32_bf16 v[168:171], a[104:107], a[216:219], v[168:171]
    global_load_dwordx4 a[72:75], v11, s[44:45] offset:-3072 sc1
    v_mfma_f32_16x16x32_bf16 v[172:175], a[96:99], a[220:223], v[172:175]
    ds_read_b128 a[216:219], v9 offset:64
    v_mfma_f32_16x16x32_bf16 v[176:179], a[100:103], a[220:223], v[176:179]
    v_mfma_f32_16x16x32_bf16 v[180:183], a[104:107], a[220:223], v[180:183]
    v_mfma_f32_16x16x32_bf16 v[160:163], a[108:111], a[220:223], v[160:163]
    global_load_dwordx4 a[76:79], v11, s[44:45] offset:-2048 sc1
    v_mfma_f32_16x16x32_bf16 v[164:167], a[112:115], a[220:223], v[164:167]
    v_mfma_f32_16x16x32_bf16 v[168:171], a[116:119], a[220:223], v[168:171]
    v_mfma_f32_16x16x32_bf16 v[184:187], a[96:99], a[224:227], v[184:187]
    ds_read_b128 a[220:223], v9 offset:25408
    v_mfma_f32_16x16x32_bf16 v[188:191], a[100:103], a[224:227], v[188:191]
    v_mfma_f32_16x16x32_bf16 v[192:195], a[104:107], a[224:227], v[192:195]
    v_mfma_f32_16x16x32_bf16 v[172:175], a[108:111], a[224:227], v[172:175]
    global_load_dwordx4 a[80:83], v11, s[44:45] offset:-1024 sc1
    v_mfma_f32_16x16x32_bf16 v[176:179], a[112:115], a[224:227], v[176:179]
    v_mfma_f32_16x16x32_bf16 v[180:183], a[116:119], a[224:227], v[180:183]
    v_mfma_f32_16x16x32_bf16 v[196:199], a[96:99], a[228:231], v[196:199]
    ds_read_b128 a[224:227], v9 offset:50752
    v_mfma_f32_16x16x32_bf16 v[200:203], a[100:103], a[228:231], v[200:203]
HOP2_2:
    s_cbranch_execz HOP2_3
    v_mfma_f32_16x16x32_bf16 v[204:207], a[104:107], a[228:231], v[204:207]
    v_mfma_f32_16x16x32_bf16 v[184:187], a[108:111], a[228:231], v[184:187]
    global_load_dwordx4 a[84:87], v11, s[44:45] offset:0 sc1
    v_mfma_f32_16x16x32_bf16 v[188:191], a[112:115], a[228:231], v[188:191]
    v_mfma_f32_16x16x32_bf16 v[192:195], a[116:119], a[228:231], v[192:195]
    s_waitcnt lgkmcnt(3)
    v_mfma_f32_16x16x32_bf16 v[208:211], a[96:99], a[232:235], v[208:211]
    ds_read_b128 a[228:231], v10 offset:64
    v_mfma_f32_16x16x32_bf16 v[212:215], a[100:103], a[232:235], v[212:215]
    v_mfma_f32_16x16x32_bf16 v[216:219], a[104:107], a[232:235], v[216:219]
    v_mfma_f32_16x16x32_bf16 v[196:199], a[108:111], a[232:235], v[196:199]
    global_load_dwordx4 a[88:91], v11, s[44:45] offset:1024 sc1
    v_mfma_f32_16x16x32_bf16 v[200:203], a[112:115], a[232:235], v[200:203]
    v_mfma_f32_16x16x32_bf16 v[204:207], a[116:119], a[232:235], v[204:207]
    v_mfma_f32_16x16x32_bf16 v[208:211], a[108:111], a[236:239], v[208:211]
    ds_read_b128 a[232:235], v10 offset:25408
    v_mfma_f32_16x16x32_bf16 v[212:215], a[112:115], a[236:239], v[212:215]
    global_load_dwordx4 a[92:95], v11, s[44:45] offset:2048 sc1
    v_mfma_f32_16x16x32_bf16 v[216:219], a[116:119], a[236:239], v[216:219]
    s_waitcnt vmcnt(6) lgkmcnt(1)
    v_mfma_f32_16x16x32_bf16 v[160:163], a[120:123], a[216:219], v[160:163]
    ds_read_b128 a[236:239], v10 offset:50752
    v_mfma_f32_16x16x32_bf16 v[164:167], a[124:127], a[216:219], v[164:167]
    v_mfma_f32_16x16x32_bf16 v[168:171], a[128:131], a[216:219], v[168:171]
    v_add_u32 v9, s53, v9
    v_mfma_f32_16x16x32_bf16 v[172:175], a[120:123], a[220:223], v[172:175]
    ds_read_b128 a[216:219], v9 offset:0
    v_add_u32 v11, 6144, v11
    v_mfma_f32_16x16x32_bf16 v[176:179], a[124:127], a[220:223], v[176:179]
    global_load_dwordx4 a[96:99], v11, s[44:45] offset:-3072 sc1
    v_mfma_f32_16x16x32_bf16 v[180:183], a[128:131], a[220:223], v[180:183]
    v_mfma_f32_16x16x32_bf16 v[160:163], a[132:135], a[220:223], v[160:163]
    global_load_dwordx4 a[100:103], v11, s[44:45] offset:-2048 sc1
    v_mfma_f32_16x16x32_bf16 v[164:167], a[136:139], a[220:223], v[164:167]
HOP2_3:
    s_cbranch_execz HOP2_4
    v_mfma_f32_16x16x32_bf16 v[168:171], a[140:143], a[220:223], v[168:171]
    v_mfma_f32_16x16x32_bf16 v[184:187], a[120:123], a[224:227], v[184:187]
    ds_read_b128 a[220:223], v9 offset:25344
    v_mfma_f32_16x16x32_bf16 v[188:191], a[124:127], a[224:227], v[188:191]
    v_mfma_f32_16x16x32_bf16 v[192:195], a[128:131], a[224:227], v[192:195]
    v_mfma_f32_16x16x32_bf16 v[172:175], a[132:135], a[224:227], v[172:175]
    global_load_dwordx4 a[104:107], v11, s[44:45] offset:-1024 sc1
    v_mfma_f32_16x16x32_bf16 v[176:179], a[136:139], a[224:227], v[176:179]
    v_mfma_f32_16x16x32_bf16 v[180:183], a[140:143], a[224:227], v[180:183]
    v_mfma_f32_16x16x32_bf16 v[196:199], a[120:123], a[228:231], v[196:199]
    ds_read_b128 a[224:227], v9 offset:50688
    v_mfma_f32_16x16x32_bf16 v[200:203], a[124:127], a[228:231], v[200:203]
    v_mfma_f32_16x16x32_bf16 v[204:207], a[128:131], a[228:231], v[204:207]
    v_mfma_f32_16x16x32_bf16 v[184:187], a[132:135], a[228:231], v[184:187]
    global_load_dwordx4 a[108:111], v11, s[44:45] offset:0 sc1
    v_mfma_f32_16x16x32_bf16 v[188:191], a[136:139], a[228:231], v[188:191]
    v_mfma_f32_16x16x32_bf16 v[192:195], a[140:143], a[228:231], v[192:195]
    s_waitcnt lgkmcnt(3)
    v_add_u32 v10, s53, v10
    v_mfma_f32_16x16x32_bf16 v[208:211], a[120:123], a[232:235], v[208:211]
    ds_read_b128 a[228:231], v10 offset:0
    v_mfma_f32_16x16x32_bf16 v[212:215], a[124:127], a[232:235], v[212:215]
    v_mfma_f32_16x16x32_bf16 v[216:219], a[128:131], a[232:235], v[216:219]
    v_mfma_f32_16x16x32_bf16 v[196:199], a[132:135], a[232:235], v[196:199]
    global_load_dwordx4 a[112:115], v11, s[44:45] offset:1024 sc1
    v_mfma_f32_16x16x32_bf16 v[200:203], a[136:139], a[232:235], v[200:203]
    v_mfma_f32_16x16x32_bf16 v[204:207], a[140:143], a[232:235], v[204:207]
    v_mfma_f32_16x16x32_bf16 v[208:211], a[132:135], a[236:239], v[208:211]
    s_cmp_lg_u32 s52, 0
    ds_read_b128 a[232:235], v10 offset:25344
    v_mfma_f32_16x16x32_bf16 v[212:215], a[136:139], a[236:239], v[212:215]
    global_load_dwordx4 a[116:119], v11, s[44:45] offset:2048 sc1
    v_mfma_f32_16x16x32_bf16 v[216:219], a[140:143], a[236:239], v[216:219]
    s_cbranch_scc1 L_LOOP1
    s_waitcnt vmcnt(6) lgkmcnt(1)
    v_mfma_f32_16x16x32_bf16 v[16:19], a[72:75], a[216:219], 0
    s_barrier
    ds_read_b128 a[236:239], v10 offset:50688
    v_mfma_f32_16x16x32_bf16 v[20:23], a[76:79], a[216:219], 0
HOP2_4:
    s_cbranch_execz HOP2_5
    v_add_u32 v11, 6144, v11
    v_mfma_f32_16x16x32_bf16 v[24:27], a[80:83], a[216:219], 0
    global_load_dwordx4 a[120:123], v11, s[44:45] offset:-3072 sc1
    v_mfma_f32_16x16x32_bf16 v[28:31], a[72:75], a[220:223], 0
    s_mov_b32 s53, 96
    ds_read_b128 a[216:219], v9 offset:32
    v_mfma_f32_16x16x32_bf16 v[32:35], a[76:79], a[220:223], 0
    ds_write_b32 v12, v162 offset:0
    v_mfma_f32_16x16x32_bf16 v[36:39], a[80:83], a[220:223], 0
    ds_write_b32 v12, v163 offset:4
    v_mfma_f32_16x16x32_bf16 v[16:19], a[84:87], a[220:223], v[16:19]
    global_load_dwordx4 a[124:127], v11, s[44:45] offset:-2048 sc1
    v_mfma_f32_16x16x32_bf16 v[20:23], a[88:91], a[220:223], v[20:23]
    ds_write_b32 v12, v166 offset:512
    v_mfma_f32_16x16x32_bf16 v[24:27], a[92:95], a[220:223], v[24:27]
    ds_write_b32 v12, v167 offset:516
    v_mfma_f32_16x16x32_bf16 v[40:43], a[72:75], a[224:227], 0
    ds_read_b128 a[220:223], v9 offset:25376
    v_mfma_f32_16x16x32_bf16 v[44:47], a[76:79], a[224:227], 0
    ds_write_b32 v12, v170 offset:1024
    v_mfma_f32_16x16x32_bf16 v[48:51], a[80:83], a[224:227], 0
    ds_write_b32 v12, v171 offset:1028
    v_mfma_f32_16x16x32_bf16 v[28:31], a[84:87], a[224:227], v[28:31]
    global_load_dwordx4 a[128:131], v11, s[44:45] offset:-1024 sc1
    v_mfma_f32_16x16x32_bf16 v[32:35], a[88:91], a[224:227], v[32:35]
    ds_write_b32 v12, v174 offset:1536
    v_mfma_f32_16x16x32_bf16 v[36:39], a[92:95], a[224:227], v[36:39]
HOP2_5:
    s_cbranch_execz HOP2_6
    ds_write_b32 v12, v175 offset:1540
    v_mfma_f32_16x16x32_bf16 v[52:55], a[72:75], a[228:231], 0
    ds_read_b128 a[224:227], v9 offset:50720
    v_mfma_f32_16x16x32_bf16 v[56:59], a[76:79], a[228:231], 0
    ds_write_b32 v12, v178 offset:2048
    v_mfma_f32_16x16x32_bf16 v[60:63], a[80:83], a[228:231], 0
    ds_write_b32 v12, v179 offset:2052
    v_mfma_f32_16x16x32_bf16 v[40:43], a[84:87], a[228:231], v[40:43]
    global_load_dwordx4 a[132:135], v11, s[44:45] offset:0 sc1
    v_mfma_f32_16x16x32_bf16 v[44:47], a[88:91], a[228:231], v[44:47]
    ds_write_b32 v12, v182 offset:2560
    v_mfma_f32_16x16x32_bf16 v[48:51], a[92:95], a[228:231], v[48:51]
    s_waitcnt lgkmcnt(14)
    ds_write_b32 v12, v183 offset:2564
    v_mfma_f32_16x16x32_bf16 v[64:67], a[72:75], a[232:235], 0
    ds_read_b128 a[228:231], v10 offset:32
    v_mfma_f32_16x16x32_bf16 v[68:71], a[76:79], a[232:235], 0
    ds_write_b32 v12, v186 offset:3072
    v_mfma_f32_16x16x32_bf16 v[72:75], a[80:83], a[232:235], 0
    ds_write_b32 v12, v187 offset:3076
    v_mfma_f32_16x16x32_bf16 v[52:55], a[84:87], a[232:235], v[52:55]
    global_load_dwordx4 a[136:139], v11, s[44:45] offset:1024 sc1
    v_mfma_f32_16x16x32_bf16 v[56:59], a[88:91], a[232:235], v[56:59]
    ds_write_b32 v12, v190 offset:3584
    v_mfma_f32_16x16x32_bf16 v[60:63], a[92:95], a[232:235], v[60:63]
    ds_write_b32 v12, v191 offset:3588
    v_mfma_f32_16x16x32_bf16 v[64:67], a[84:87], a[236:239], v[64:67]
    ds_read_b128 a[232:235], v10 offset:25376
    v_mfma_f32_16x16x32_bf16 v[68:71], a[88:91], a[236:239], v[68:71]
    global_load_dwordx4 a[140:143], v11, s[44:45] offset:2048 sc1
    v_mfma_f32_16x16x32_bf16 v[72:75], a[92:95], a[236:239], v[72:75]
    s_waitcnt vmcnt(6) lgkmcnt(5)
    ds_write_b32 v12, v194 offset:25344
    v_mfma_f32_16x16x32_bf16 v[16:19], a[96:99], a[216:219], v[16:19]
    ds_read_b128 a[236:239], v10 offset:50720
    v_mfma_f32_16x16x32_bf16 v[20:23], a[100:103], a[216:219], v[20:23]
HOP2_6:
    s_cbranch_execz HOP2_7
    v_add_u32 v11, 6144, v11
    v_mfma_f32_16x16x32_bf16 v[24:27], a[104:107], a[216:219], v[24:27]
    global_load_dwordx4 a[72:75], v11, s[44:45] offset:-3072 sc1
    v_mfma_f32_16x16x32_bf16 v[28:31], a[96:99], a[220:223], v[28:31]
    ds_read_b128 a[216:219], v9 offset:64
    v_mfma_f32_16x16x32_bf16 v[32:35], a[100:103], a[220:223], v[32:35]
    ds_write_b32 v12, v195 offset:25348
    v_mfma_f32_16x16x32_bf16 v[36:39], a[104:107], a[220:223], v[36:39]
    ds_write_b32 v12, v198 offset:25856
    v_mfma_f32_16x16x32_bf16 v[16:19], a[108:111], a[220:223], v[16:19]
    global_load_dwordx4 a[76:79], v11, s[44:45] offset:-2048 sc1
    v_mfma_f32_16x16x32_bf16 v[20:23], a[112:115], a[220:223], v[20:23]
    ds_write_b32 v12, v199 offset:25860
    v_mfma_f32_16x16x32_bf16 v[24:27], a[116:119], a[220:223], v[24:27]
    ds_write_b32 v12, v202 offset:26368
    v_mfma_f32_16x16x32_bf16 v[40:43], a[96:99], a[224:227], v[40:43]
    ds_read_b128 a[220:223], v9 offset:25408
    v_mfma_f32_16x16x32_bf16 v[44:47], a[100:103], a[224:227], v[44:47]
    ds_write_b32 v12, v203 offset:26372
    v_mfma_f32_16x16x32_bf16 v[48:51], a[104:107], a[224:227], v[48:51]
    ds_write_b32 v12, v206 offset:26880
    v_mfma_f32_16x16x32_bf16 v[28:31], a[108:111], a[224:227], v[28:31]
    global_load_dwordx4 a[80:83], v11, s[44:45] offset:-1024 sc1
    v_mfma_f32_16x16x32_bf16 v[32:35], a[112:115], a[224:227], v[32:35]
    ds_write_b32 v12, v207 offset:26884
    v_mfma_f32_16x16x32_bf16 v[36:39], a[116:119], a[224:227], v[36:39]
    ds_write_b32 v12, v210 offset:27392
    v_mfma_f32_16x16x32_bf16 v[52:55], a[96:99], a[228:231], v[52:55]
HOP2_7:
    s_cbranch_execz HOP2_8
    ds_read_b128 a[224:227], v9 offset:50752
    v_mfma_f32_16x16x32_bf16 v[56:59], a[100:103], a[228:231], v[56:59]
    ds_write_b32 v12, v211 offset:27396
    v_mfma_f32_16x16x32_bf16 v[60:63], a[104:107], a[228:231], v[60:63]
    ds_write_b32 v12, v214 offset:27904
    v_mfma_f32_16x16x32_bf16 v[40:43], a[108:111], a[228:231], v[40:43]
    global_load_dwordx4 a[84:87], v11, s[44:45] offset:0 sc1
    v_mfma_f32_16x16x32_bf16 v[44:47], a[112:115], a[228:231], v[44:47]
    ds_write_b32 v12, v215 offset:27908
    v_mfma_f32_16x16x32_bf16 v[48:51], a[116:119], a[228:231], v[48:51]
    s_waitcnt lgkmcnt(14)
    ds_write_b32 v12, v218 offset:28416
    v_mfma_f32_16x16x32_bf16 v[64:67], a[96:99], a[232:235], v[64:67]
    ds_read_b128 a[228:231], v10 offset:64
    v_mfma_f32_16x16x32_bf16 v[68:71], a[100:103], a[232:235], v[68:71]
    ds_write_b32 v12, v219 offset:28420
    v_mfma_f32_16x16x32_bf16 v[72:75], a[104:107], a[232:235], v[72:75]
    v_mfma_f32_16x16x32_bf16 v[52:55], a[108:111], a[232:235], v[52:55]
    global_load_dwordx4 a[88:91], v11, s[44:45] offset:1024 sc1
    v_mfma_f32_16x16x32_bf16 v[56:59], a[112:115], a[232:235], v[56:59]
    v_mfma_f32_16x16x32_bf16 v[60:63], a[116:119], a[232:235], v[60:63]
    v_mfma_f32_16x16x32_bf16 v[64:67], a[108:111], a[236:239], v[64:67]
    s_waitcnt lgkmcnt(0)
    ds_read_b128 a[232:235], v10 offset:25408
    v_mfma_f32_16x16x32_bf16 v[68:71], a[112:115], a[236:239], v[68:71]
    s_barrier
    global_load_dwordx4 a[92:95], v11, s[44:45] offset:2048 sc1
    v_mfma_f32_16x16x32_bf16 v[72:75], a[116:119], a[236:239], v[72:75]
    s_waitcnt vmcnt(6)
    ds_read_b64 v[226:227], v13 offset:0
    ds_read_b64 v[228:229], v13 offset:512
    v_mfma_f32_16x16x32_bf16 v[16:19], a[120:123], a[216:219], v[16:19]
HOP2_8:
    s_cbranch_execz HOP2_9
    ds_read_b128 a[236:239], v10 offset:50752
    ds_read_b64 v[230:231], v13 offset:1024
    v_mfma_f32_16x16x32_bf16 v[20:23], a[124:127], a[216:219], v[20:23]
    ds_read_b64 v[232:233], v13 offset:1536
    v_mfma_f32_16x16x32_bf16 v[24:27], a[128:131], a[216:219], v[24:27]
    v_add_u32 v9, s53, v9
    v_mfma_f32_16x16x32_bf16 v[28:31], a[120:123], a[220:223], v[28:31]
    ds_read_b128 a[216:219], v9 offset:0
    v_add_u32 v11, 6144, v11
    v_mfma_f32_16x16x32_bf16 v[32:35], a[124:127], a[220:223], v[32:35]
    global_load_dwordx4 a[96:99], v11, s[44:45] offset:-3072 sc1
    v_mfma_f32_16x16x32_bf16 v[36:39], a[128:131], a[220:223], v[36:39]
    s_waitcnt lgkmcnt(5)
    v_add_f32 v76, v160, v226
    v_sub_f32 v226, v160, v226
    v_mfma_f32_16x16x32_bf16 v[16:19], a[132:135], a[220:223], v[16:19]
    global_load_dwordx4 a[100:103], v11, s[44:45] offset:-2048 sc1
    v_mfma_f32_16x16x32_bf16 v[20:23], a[136:139], a[220:223], v[20:23]
    v_add_f32 v77, v161, v227
    v_sub_f32 v227, v161, v227
    v_mfma_f32_16x16x32_bf16 v[24:27], a[140:143], a[220:223], v[24:27]
    v_mul_f32 v136, s66, v76
    v_mul_f32 v106, s78, v226
    v_mfma_f32_16x16x32_bf16 v[40:43], a[120:123], a[224:227], v[40:43]
    ds_read_b128 a[220:223], v9 offset:25344
    v_mul_f32 v137, s66, v77
    v_mfma_f32_16x16x32_bf16 v[44:47], a[124:127], a[224:227], v[44:47]
    ds_read_b64 v[234:235], v13 offset:2048
    v_mul_f32 v107, s78, v227
    v_mfma_f32_16x16x32_bf16 v[48:51], a[128:131], a[224:227], v[48:51]
    s_waitcnt lgkmcnt(6)
    v_add_f32 v78, v164, v228
    v_sub_f32 v228, v164, v228
    v_mfma_f32_16x16x32_bf16 v[28:31], a[132:135], a[224:227], v[28:31]
    global_load_dwordx4 a[104:107], v11, s[44:45] offset:-1024 sc1
    v_mfma_f32_16x16x32_bf16 v[32:35], a[136:139], a[224:227], v[32:35]
    v_add_f32 v79, v165, v229
    v_sub_f32 v229, v165, v229
    v_mfma_f32_16x16x32_bf16 v[36:39], a[140:143], a[224:227], v[36:39]
HOP2_9:
    s_cbranch_execz HOP2_10
    v_mul_f32 v138, s66, v78
    v_mul_f32 v108, s78, v228
    v_mfma_f32_16x16x32_bf16 v[52:55], a[120:123], a[228:231], v[52:55]
    ds_read_b128 a[224:227], v9 offset:50688
    v_mul_f32 v139, s66, v79
    v_mfma_f32_16x16x32_bf16 v[56:59], a[124:127], a[228:231], v[56:59]
    ds_read_b64 v[236:237], v13 offset:2560
    v_mul_f32 v109, s78, v229
    v_mfma_f32_16x16x32_bf16 v[60:63], a[128:131], a[228:231], v[60:63]
    s_waitcnt lgkmcnt(6)
    v_add_f32 v80, v168, v230
    v_sub_f32 v230, v168, v230
    v_mfma_f32_16x16x32_bf16 v[40:43], a[132:135], a[228:231], v[40:43]
    global_load_dwordx4 a[108:111], v11, s[44:45] offset:0 sc1
    v_mfma_f32_16x16x32_bf16 v[44:47], a[136:139], a[228:231], v[44:47]
    v_add_f32 v81, v169, v231
    v_sub_f32 v231, v169, v231
    v_mfma_f32_16x16x32_bf16 v[48:51], a[140:143], a[228:231], v[48:51]
    v_add_u32 v10, s53, v10
    v_mul_f32 v140, s66, v80
    v_mfma_f32_16x16x32_bf16 v[64:67], a[120:123], a[232:235], v[64:67]
    ds_read_b128 a[228:231], v10 offset:0
    v_mul_f32 v110, s78, v230
    v_mfma_f32_16x16x32_bf16 v[68:71], a[124:127], a[232:235], v[68:71]
    v_mul_f32 v141, s66, v81
    v_mul_f32 v111, s78, v231
    v_mfma_f32_16x16x32_bf16 v[72:75], a[128:131], a[232:235], v[72:75]
    s_waitcnt lgkmcnt(6)
    ds_read_b64 v[238:239], v13 offset:3072
    v_add_f32 v82, v172, v232
    v_mfma_f32_16x16x32_bf16 v[52:55], a[132:135], a[232:235], v[52:55]
    global_load_dwordx4 a[112:115], v11, s[44:45] offset:1024 sc1
    v_mfma_f32_16x16x32_bf16 v[56:59], a[136:139], a[232:235], v[56:59]
    v_sub_f32 v232, v172, v232
    v_add_f32 v83, v173, v233
    v_mfma_f32_16x16x32_bf16 v[60:63], a[140:143], a[232:235], v[60:63]
    v_sub_f32 v233, v173, v233
    v_mul_f32 v142, s66, v82
    v_mfma_f32_16x16x32_bf16 v[64:67], a[132:135], a[236:239], v[64:67]
    ds_read_b128 a[232:235], v10 offset:25344
    v_mul_f32 v112, s78, v232
    v_mfma_f32_16x16x32_bf16 v[68:71], a[136:139], a[236:239], v[68:71]
HOP2_10:
    s_cbranch_execz HOP2_11
    global_load_dwordx4 a[116:119], v11, s[44:45] offset:2048 sc1
    v_mfma_f32_16x16x32_bf16 v[72:75], a[140:143], a[236:239], v[72:75]
    v_mul_f32 v143, s66, v83
    v_mul_f32 v113, s78, v233
    s_waitcnt vmcnt(6) lgkmcnt(2)
    v_mfma_f32_16x16x32_bf16 v[16:19], a[72:75], a[216:219], v[16:19]
    ds_read_b128 a[236:239], v10 offset:50688
    ds_read_b64 v[240:241], v13 offset:3584
    v_mfma_f32_16x16x32_bf16 v[20:23], a[76:79], a[216:219], v[20:23]
    v_add_u32 v11, 6144, v11
    v_add_f32 v84, v176, v234
    v_mfma_f32_16x16x32_bf16 v[24:27], a[80:83], a[216:219], v[24:27]
    global_load_dwordx4 a[120:123], v11, s[44:45] offset:-3072 sc1
    v_mfma_f32_16x16x32_bf16 v[28:31], a[72:75], a[220:223], v[28:31]
    s_mov_b32 s53, 96
    ds_read_b128 a[216:219], v9 offset:32
    v_sub_f32 v234, v176, v234
    v_mfma_f32_16x16x32_bf16 v[32:35], a[76:79], a[220:223], v[32:35]
    s_mov_b32 s52, 5
    v_add_f32 v85, v177, v235
    v_sub_f32 v235, v177, v235
    v_mfma_f32_16x16x32_bf16 v[36:39], a[80:83], a[220:223], v[36:39]
    v_mul_f32 v144, s66, v84
    v_mul_f32 v114, s78, v234
    v_mfma_f32_16x16x32_bf16 v[16:19], a[84:87], a[220:223], v[16:19]
    global_load_dwordx4 a[124:127], v11, s[44:45] offset:-2048 sc1
    v_mfma_f32_16x16x32_bf16 v[20:23], a[88:91], a[220:223], v[20:23]
    v_mul_f32 v145, s66, v85
    v_mul_f32 v115, s78, v235
    v_mfma_f32_16x16x32_bf16 v[24:27], a[92:95], a[220:223], v[24:27]
    ds_read_b64 v[242:243], v13 offset:25344
    v_add_f32 v86, v180, v236
    v_mfma_f32_16x16x32_bf16 v[40:43], a[72:75], a[224:227], v[40:43]
    ds_read_b128 a[220:223], v9 offset:25376
    v_sub_f32 v236, v180, v236
    v_mfma_f32_16x16x32_bf16 v[44:47], a[76:79], a[224:227], v[44:47]
    v_add_f32 v87, v181, v237
    v_sub_f32 v237, v181, v237
    v_mfma_f32_16x16x32_bf16 v[48:51], a[80:83], a[224:227], v[48:51]
    v_mul_f32 v146, s66, v86
    v_mul_f32 v116, s78, v236
    v_mfma_f32_16x16x32_bf16 v[28:31], a[84:87], a[224:227], v[28:31]
HOP2_11:
    s_cbranch_execz HOP2_12
    global_load_dwordx4 a[128:131], v11, s[44:45] offset:-1024 sc1
    v_mfma_f32_16x16x32_bf16 v[32:35], a[88:91], a[224:227], v[32:35]
    v_mul_f32 v147, s66, v87
    v_mul_f32 v117, s78, v237
    v_mfma_f32_16x16x32_bf16 v[36:39], a[92:95], a[224:227], v[36:39]
    s_waitcnt lgkmcnt(6)
    ds_read_b64 v[244:245], v13 offset:25856
    v_add_f32 v88, v184, v238
    v_mfma_f32_16x16x32_bf16 v[52:55], a[72:75], a[228:231], v[52:55]
    ds_read_b128 a[224:227], v9 offset:50720
    v_sub_f32 v238, v184, v238
    v_mfma_f32_16x16x32_bf16 v[56:59], a[76:79], a[228:231], v[56:59]
    v_add_f32 v89, v185, v239
    v_sub_f32 v239, v185, v239
    v_mfma_f32_16x16x32_bf16 v[60:63], a[80:83], a[228:231], v[60:63]
    v_mul_f32 v148, s66, v88
    v_mul_f32 v118, s78, v238
    v_mfma_f32_16x16x32_bf16 v[40:43], a[84:87], a[228:231], v[40:43]
    global_load_dwordx4 a[132:135], v11, s[44:45] offset:0 sc1
    v_mfma_f32_16x16x32_bf16 v[44:47], a[88:91], a[228:231], v[44:47]
    v_mul_f32 v149, s66, v89
    v_mul_f32 v119, s78, v239
    v_mfma_f32_16x16x32_bf16 v[48:51], a[92:95], a[228:231], v[48:51]
    s_waitcnt lgkmcnt(5)
    ds_read_b64 v[246:247], v13 offset:26368
    v_add_f32 v90, v188, v240
    v_mfma_f32_16x16x32_bf16 v[64:67], a[72:75], a[232:235], v[64:67]
    ds_read_b128 a[228:231], v10 offset:32
    v_sub_f32 v240, v188, v240
    v_mfma_f32_16x16x32_bf16 v[68:71], a[76:79], a[232:235], v[68:71]
    v_add_f32 v91, v189, v241
    v_sub_f32 v241, v189, v241
    v_mfma_f32_16x16x32_bf16 v[72:75], a[80:83], a[232:235], v[72:75]
    v_mul_f32 v150, s66, v90
    v_mul_f32 v120, s78, v240
    v_mfma_f32_16x16x32_bf16 v[52:55], a[84:87], a[232:235], v[52:55]
    global_load_dwordx4 a[136:139], v11, s[44:45] offset:1024 sc1
    v_mfma_f32_16x16x32_bf16 v[56:59], a[88:91], a[232:235], v[56:59]
    v_mul_f32 v151, s66, v91
    v_mul_f32 v121, s78, v241
    v_mfma_f32_16x16x32_bf16 v[60:63], a[92:95], a[232:235], v[60:63]
    s_waitcnt lgkmcnt(5)
    ds_read_b64 v[248:249], v13 offset:26880
    v_add_f32 v92, v192, v242
    v_mfma_f32_16x16x32_bf16 v[64:67], a[84:87], a[236:239], v[64:67]
HOP2_12:
    s_cbranch_execz HOP2_13
    ds_read_b128 a[232:235], v10 offset:25376
    v_sub_f32 v242, v192, v242
    v_mfma_f32_16x16x32_bf16 v[68:71], a[88:91], a[236:239], v[68:71]
    global_load_dwordx4 a[140:143], v11, s[44:45] offset:2048 sc1
    v_mfma_f32_16x16x32_bf16 v[72:75], a[92:95], a[236:239], v[72:75]
    s_waitcnt vmcnt(6) lgkmcnt(2)
    v_add_f32 v93, v193, v243
    v_sub_f32 v243, v193, v243
    v_mfma_f32_16x16x32_bf16 v[16:19], a[96:99], a[216:219], v[16:19]
    ds_read_b128 a[236:239], v10 offset:50720
    v_mul_f32 v152, s66, v92
    v_mfma_f32_16x16x32_bf16 v[20:23], a[100:103], a[216:219], v[20:23]
    v_add_u32 v11, 6144, v11
    v_mul_f32 v122, s78, v242
    v_mfma_f32_16x16x32_bf16 v[24:27], a[104:107], a[216:219], v[24:27]
    global_load_dwordx4 a[72:75], v11, s[44:45] offset:-3072 sc1
    v_mfma_f32_16x16x32_bf16 v[28:31], a[96:99], a[220:223], v[28:31]
    ds_read_b128 a[216:219], v9 offset:64
    v_mul_f32 v153, s66, v93
    v_mfma_f32_16x16x32_bf16 v[32:35], a[100:103], a[220:223], v[32:35]
    ds_read_b64 v[250:251], v13 offset:27392
    v_mul_f32 v123, s78, v243
    v_mfma_f32_16x16x32_bf16 v[36:39], a[104:107], a[220:223], v[36:39]
    v_add_f32 v94, v196, v244
    v_sub_f32 v244, v196, v244
    v_mfma_f32_16x16x32_bf16 v[16:19], a[108:111], a[220:223], v[16:19]
    global_load_dwordx4 a[76:79], v11, s[44:45] offset:-2048 sc1
    v_mfma_f32_16x16x32_bf16 v[20:23], a[112:115], a[220:223], v[20:23]
    v_add_f32 v95, v197, v245
    v_sub_f32 v245, v197, v245
    v_mfma_f32_16x16x32_bf16 v[24:27], a[116:119], a[220:223], v[24:27]
    v_mul_f32 v154, s66, v94
    v_mul_f32 v124, s78, v244
    v_mfma_f32_16x16x32_bf16 v[40:43], a[96:99], a[224:227], v[40:43]
    ds_read_b128 a[220:223], v9 offset:25408
    v_mul_f32 v155, s66, v95
    v_mfma_f32_16x16x32_bf16 v[44:47], a[100:103], a[224:227], v[44:47]
HOP2_13:
    s_cbranch_execz HOP2_14
    ds_read_b64 v[252:253], v13 offset:27904
    v_mul_f32 v125, s78, v245
    v_mfma_f32_16x16x32_bf16 v[48:51], a[104:107], a[224:227], v[48:51]
    v_add_f32 v96, v200, v246
    v_sub_f32 v246, v200, v246
    v_mfma_f32_16x16x32_bf16 v[28:31], a[108:111], a[224:227], v[28:31]
    global_load_dwordx4 a[80:83], v11, s[44:45] offset:-1024 sc1
    v_mfma_f32_16x16x32_bf16 v[32:35], a[112:115], a[224:227], v[32:35]
    v_add_f32 v97, v201, v247
    v_sub_f32 v247, v201, v247
    v_mfma_f32_16x16x32_bf16 v[36:39], a[116:119], a[224:227], v[36:39]
    v_mul_f32 v156, s66, v96
    v_mul_f32 v126, s78, v246
    v_mfma_f32_16x16x32_bf16 v[52:55], a[96:99], a[228:231], v[52:55]
    ds_read_b128 a[224:227], v9 offset:50752
    v_mul_f32 v157, s66, v97
    v_mfma_f32_16x16x32_bf16 v[56:59], a[100:103], a[228:231], v[56:59]
    ds_read_b64 v[254:255], v13 offset:28416
    v_mul_f32 v127, s78, v247
    v_mfma_f32_16x16x32_bf16 v[60:63], a[104:107], a[228:231], v[60:63]
    s_waitcnt lgkmcnt(8)
    v_add_f32 v98, v204, v248
    v_sub_f32 v248, v204, v248
    v_mfma_f32_16x16x32_bf16 v[40:43], a[108:111], a[228:231], v[40:43]
    global_load_dwordx4 a[84:87], v11, s[44:45] offset:0 sc1
    v_mfma_f32_16x16x32_bf16 v[44:47], a[112:115], a[228:231], v[44:47]
    v_add_f32 v99, v205, v249
    v_sub_f32 v249, v205, v249
    v_mfma_f32_16x16x32_bf16 v[48:51], a[116:119], a[228:231], v[48:51]
    s_waitcnt lgkmcnt(6)
    v_mul_f32 v158, s66, v98
    v_mul_f32 v128, s78, v248
    v_mfma_f32_16x16x32_bf16 v[64:67], a[96:99], a[232:235], v[64:67]
    ds_read_b128 a[228:231], v10 offset:64
    v_mul_f32 v159, s66, v99
    v_mfma_f32_16x16x32_bf16 v[68:71], a[100:103], a[232:235], v[68:71]
    s_waitcnt lgkmcnt(5)
    v_mul_f32 v129, s78, v249
    v_add_f32 v100, v208, v250
    v_mfma_f32_16x16x32_bf16 v[72:75], a[104:107], a[232:235], v[72:75]
HOP2_14:
    s_cbranch_execz HOP2_15
    v_sub_f32 v250, v208, v250
    v_add_f32 v101, v209, v251
    v_mfma_f32_16x16x32_bf16 v[52:55], a[108:111], a[232:235], v[52:55]
    global_load_dwordx4 a[88:91], v11, s[44:45] offset:1024 sc1
    v_mfma_f32_16x16x32_bf16 v[56:59], a[112:115], a[232:235], v[56:59]
    v_sub_f32 v251, v209, v251
    v_mul_f32 v220, s66, v100
    v_mfma_f32_16x16x32_bf16 v[60:63], a[116:119], a[232:235], v[60:63]
    v_mul_f32 v130, s78, v250
    v_mul_f32 v221, s66, v101
    v_mfma_f32_16x16x32_bf16 v[64:67], a[108:111], a[236:239], v[64:67]
    ds_read_b128 a[232:235], v10 offset:25408
    v_mul_f32 v131, s78, v251
    v_mfma_f32_16x16x32_bf16 v[68:71], a[112:115], a[236:239], v[68:71]
    global_load_dwordx4 a[92:95], v11, s[44:45] offset:2048 sc1
    v_mfma_f32_16x16x32_bf16 v[72:75], a[116:119], a[236:239], v[72:75]
    s_waitcnt vmcnt(6) lgkmcnt(1)
    v_add_f32 v102, v212, v252
    v_sub_f32 v252, v212, v252
    v_mfma_f32_16x16x32_bf16 v[16:19], a[120:123], a[216:219], v[16:19]
    ds_read_b128 a[236:239], v10 offset:50752
    v_add_f32 v103, v213, v253
    v_mfma_f32_16x16x32_bf16 v[20:23], a[124:127], a[216:219], v[20:23]
    v_sub_f32 v253, v213, v253
    v_mul_f32 v222, s66, v102
    v_mfma_f32_16x16x32_bf16 v[24:27], a[128:131], a[216:219], v[24:27]
    v_add_u32 v9, s53, v9
    v_mul_f32 v132, s78, v252
    v_mfma_f32_16x16x32_bf16 v[28:31], a[120:123], a[220:223], v[28:31]
    ds_read_b128 a[216:219], v9 offset:0
    v_add_u32 v11, 6144, v11
    v_mfma_f32_16x16x32_bf16 v[32:35], a[124:127], a[220:223], v[32:35]
    global_load_dwordx4 a[96:99], v11, s[44:45] offset:-3072 sc1
    v_mfma_f32_16x16x32_bf16 v[36:39], a[128:131], a[220:223], v[36:39]
    v_mul_f32 v223, s66, v103
    v_mul_f32 v133, s78, v253
    v_mfma_f32_16x16x32_bf16 v[16:19], a[132:135], a[220:223], v[16:19]
    global_load_dwordx4 a[100:103], v11, s[44:45] offset:-2048 sc1
    v_mfma_f32_16x16x32_bf16 v[20:23], a[136:139], a[220:223], v[20:23]
    v_add_f32 v104, v216, v254
    v_sub_f32 v254, v216, v254
    v_mfma_f32_16x16x32_bf16 v[24:27], a[140:143], a[220:223], v[24:27]
HOP2_15:
    s_cbranch_execz HOP2_16
    v_add_f32 v105, v217, v255
    v_sub_f32 v255, v217, v255
    v_mfma_f32_16x16x32_bf16 v[40:43], a[120:123], a[224:227], v[40:43]
    ds_read_b128 a[220:223], v9 offset:25344
    v_mul_f32 v224, s66, v104
    v_mfma_f32_16x16x32_bf16 v[44:47], a[124:127], a[224:227], v[44:47]
    v_mul_f32 v134, s78, v254
    v_mul_f32 v225, s66, v105
    v_mfma_f32_16x16x32_bf16 v[48:51], a[128:131], a[224:227], v[48:51]
    v_mul_f32 v135, s78, v255
    v_mfma_f32_16x16x32_bf16 v[28:31], a[132:135], a[224:227], v[28:31]
    s_mul_i32 s54, s48, 96
    global_load_dwordx4 a[104:107], v11, s[44:45] offset:-1024 sc1
    v_mfma_f32_16x16x32_bf16 v[32:35], a[136:139], a[224:227], v[32:35]
    s_mul_i32 s55, s19, 48
    v_mfma_f32_16x16x32_bf16 v[36:39], a[140:143], a[224:227], v[36:39]
    s_mul_i32 s56, s18, 832
    v_mul_u32_u24 v4, 208, v2
    v_lshl_add_u32 v4, v3, 2, v4
    v_mfma_f32_16x16x32_bf16 v[52:55], a[120:123], a[228:231], v[52:55]
    ds_read_b128 a[224:227], v9 offset:50688
    v_add_u32 v4, s54, v4
    v_mfma_f32_16x16x32_bf16 v[56:59], a[124:127], a[228:231], v[56:59]
    v_add_u32 v4, s55, v4
    v_min_u32 v6, 47, v1
    v_mfma_f32_16x16x32_bf16 v[60:63], a[128:131], a[228:231], v[60:63]
    v_mul_u32_u24 v7, 5462, v6
    v_lshrrev_b32 v7, 16, v7
    v_mfma_f32_16x16x32_bf16 v[40:43], a[132:135], a[228:231], v[40:43]
    global_load_dwordx4 a[108:111], v11, s[44:45] offset:0 sc1
    v_mfma_f32_16x16x32_bf16 v[44:47], a[136:139], a[228:231], v[44:47]
    v_lshlrev_b32 v6, 4, v6
    v_lshl_add_u32 v5, v7, 4, v6
    v_mfma_f32_16x16x32_bf16 v[48:51], a[140:143], a[228:231], v[48:51]
    s_waitcnt lgkmcnt(3)
    v_add_u32 v10, s53, v10
    v_add_u32 v5, s56, v5
    v_mfma_f32_16x16x32_bf16 v[64:67], a[120:123], a[232:235], v[64:67]
HOP2_16:
    s_cbranch_execz HOP2_17
    ds_read_b128 a[228:231], v10 offset:0
    v_mfma_f32_16x16x32_bf16 v[68:71], a[124:127], a[232:235], v[68:71]
    v_mfma_f32_16x16x32_bf16 v[72:75], a[128:131], a[232:235], v[72:75]
    v_mfma_f32_16x16x32_bf16 v[52:55], a[132:135], a[232:235], v[52:55]
    global_load_dwordx4 a[112:115], v11, s[44:45] offset:1024 sc1
    v_mfma_f32_16x16x32_bf16 v[56:59], a[136:139], a[232:235], v[56:59]
    v_mfma_f32_16x16x32_bf16 v[60:63], a[140:143], a[232:235], v[60:63]
    v_mfma_f32_16x16x32_bf16 v[64:67], a[132:135], a[236:239], v[64:67]
    ds_read_b128 a[232:235], v10 offset:25344
    v_mfma_f32_16x16x32_bf16 v[68:71], a[136:139], a[236:239], v[68:71]
    global_load_dwordx4 a[116:119], v11, s[44:45] offset:2048 sc1
    v_mfma_f32_16x16x32_bf16 v[72:75], a[140:143], a[236:239], v[72:75]
.p2align 5
L_LOOP2:
    s_waitcnt vmcnt(6) lgkmcnt(1)
    v_mfma_f32_16x16x32_bf16 v[16:19], a[72:75], a[216:219], v[16:19]
    ds_read_b128 a[236:239], v10 offset:50688
    v_mfma_f32_16x16x32_bf16 v[20:23], a[76:79], a[216:219], v[20:23]
    v_add_u32 v11, 6144, v11
    v_mfma_f32_16x16x32_bf16 v[24:27], a[80:83], a[216:219], v[24:27]
    global_load_dwordx4 a[120:123], v11, s[44:45] offset:-3072 sc1
    v_mfma_f32_16x16x32_bf16 v[28:31], a[72:75], a[220:223], v[28:31]
    ds_read_b128 a[216:219], v9 offset:32
    v_mfma_f32_16x16x32_bf16 v[32:35], a[76:79], a[220:223], v[32:35]
    v_mfma_f32_16x16x32_bf16 v[36:39], a[80:83], a[220:223], v[36:39]
    v_mfma_f32_16x16x32_bf16 v[16:19], a[84:87], a[220:223], v[16:19]
    global_load_dwordx4 a[124:127], v11, s[44:45] offset:-2048 sc1
    v_mfma_f32_16x16x32_bf16 v[20:23], a[88:91], a[220:223], v[20:23]
    s_sub_u32 s52, s52, 1
    v_mfma_f32_16x16x32_bf16 v[24:27], a[92:95], a[220:223], v[24:27]
    v_mfma_f32_16x16x32_bf16 v[40:43], a[72:75], a[224:227], v[40:43]
HOP2_17:
    s_cbranch_execz HOP2_18
    ds_read_b128 a[220:223], v9 offset:25376
    v_mfma_f32_16x16x32_bf16 v[44:47], a[76:79], a[224:227], v[44:47]
    v_mfma_f32_16x16x32_bf16 v[48:51], a[80:83], a[224:227], v[48:51]
    v_mfma_f32_16x16x32_bf16 v[28:31], a[84:87], a[224:227], v[28:31]
    global_load_dwordx4 a[128:131], v11, s[44:45] offset:-1024 sc1
    v_mfma_f32_16x16x32_bf16 v[32:35], a[88:91], a[224:227], v[32:35]
    s_cmp_eq_u32 s52, 0
    s_cselect_b32 s53, s59, 96
    v_mfma_f32_16x16x32_bf16 v[36:39], a[92:95], a[224:227], v[36:39]
    v_mfma_f32_16x16x32_bf16 v[52:55], a[72:75], a[228:231], v[52:55]
    ds_read_b128 a[224:227], v9 offset:50720
    v_mfma_f32_16x16x32_bf16 v[56:59], a[76:79], a[228:231], v[56:59]
    v_mfma_f32_16x16x32_bf16 v[60:63], a[80:83], a[228:231], v[60:63]
    v_mfma_f32_16x16x32_bf16 v[40:43], a[84:87], a[228:231], v[40:43]
    global_load_dwordx4 a[132:135], v11, s[44:45] offset:0 sc1
    v_mfma_f32_16x16x32_bf16 v[44:47], a[88:91], a[228:231], v[44:47]
    v_mfma_f32_16x16x32_bf16 v[48:51], a[92:95], a[228:231], v[48:51]
    s_waitcnt lgkmcnt(3)
    v_mfma_f32_16x16x32_bf16 v[64:67], a[72:75], a[232:235], v[64:67]
    ds_read_b128 a[228:231], v10 offset:32
    v_mfma_f32_16x16x32_bf16 v[68:71], a[76:79], a[232:235], v[68:71]
    v_mfma_f32_16x16x32_bf16 v[72:75], a[80:83], a[232:235], v[72:75]
    v_mfma_f32_16x16x32_bf16 v[52:55], a[84:87], a[232:235], v[52:55]
    global_load_dwordx4 a[136:139], v11, s[44:45] offset:1024 sc1
    v_mfma_f32_16x16x32_bf16 v[56:59], a[88:91], a[232:235], v[56:59]
    v_mfma_f32_16x16x32_bf16 v[60:63], a[92:95], a[232:235], v[60:63]
    v_mfma_f32_16x16x32_bf16 v[64:67], a[84:87], a[236:239], v[64:67]
    ds_read_b128 a[232:235], v10 offset:25376
    v_mfma_f32_16x16x32_bf16 v[68:71], a[88:91], a[236:239], v[68:71]
    global_load_dwordx4 a[140:143], v11, s[44:45] offset:2048 sc1
    v_mfma_f32_16x16x32_bf16 v[72:75], a[92:95], a[236:239], v[72:75]
    s_waitcnt vmcnt(6) lgkmcnt(1)
    v_mfma_f32_16x16x32_bf16 v[16:19], a[96:99], a[216:219], v[16:19]
HOP2_18:
    s_cbranch_execz HOP2_19
    ds_read_b128 a[236:239], v10 offset:50720
    v_mfma_f32_16x16x32_bf16 v[20:23], a[100:103], a[216:219], v[20:23]
    v_add_u32 v11, 6144, v11
    v_mfma_f32_16x16x32_bf16 v[24:27], a[104:107], a[216:219], v[24:27]
    global_load_dwordx4 a[72:75], v11, s[44:45] offset:-3072 sc1
    v_mfma_f32_16x16x32_bf16 v[28:31], a[96:99], a[220:223], v[28:31]
    ds_read_b128 a[216:219], v9 offset:64
    v_mfma_f32_16x16x32_bf16 v[32:35], a[100:103], a[220:223], v[32:35]
    v_mfma_f32_16x16x32_bf16 v[36:39], a[104:107], a[220:223], v[36:39]
    v_mfma_f32_16x16x32_bf16 v[16:19], a[108:111], a[220:223], v[16:19]
    global_load_dwordx4 a[76:79], v11, s[44:45] offset:-2048 sc1
    v_mfma_f32_16x16x32_bf16 v[20:23], a[112:115], a[220:223], v[20:23]
    v_mfma_f32_16x16x32_bf16 v[24:27], a[116:119], a[220:223], v[24:27]
    v_mfma_f32_16x16x32_bf16 v[40:43], a[96:99], a[224:227], v[40:43]
    ds_read_b128 a[220:223], v9 offset:25408
    v_mfma_f32_16x16x32_bf16 v[44:47], a[100:103], a[224:227], v[44:47]
    v_mfma_f32_16x16x32_bf16 v[48:51], a[104:107], a[224:227], v[48:51]
    v_mfma_f32_16x16x32_bf16 v[28:31], a[108:111], a[224:227], v[28:31]
    global_load_dwordx4 a[80:83], v11, s[44:45] offset:-1024 sc1
    v_mfma_f32_16x16x32_bf16 v[32:35], a[112:115], a[224:227], v[32:35]
    v_mfma_f32_16x16x32_bf16 v[36:39], a[116:119], a[224:227], v[36:39]
    v_mfma_f32_16x16x32_bf16 v[52:55], a[96:99], a[228:231], v[52:55]
    ds_read_b128 a[224:227], v9 offset:50752
    v_mfma_f32_16x16x32_bf16 v[56:59], a[100:103], a[228:231], v[56:59]
    v_mfma_f32_16x16x32_bf16 v[60:63], a[104:107], a[228:231], v[60:63]
    v_mfma_f32_16x16x32_bf16 v[40:43], a[108:111], a[228:231], v[40:43]
    global_load_dwordx4 a[84:87], v11, s[44:45] offset:0 sc1
    v_mfma_f32_16x16x32_bf16 v[44:47], a[112:115], a[228:231], v[44:47]
    v_mfma_f32_16x16x32_bf16 v[48:51], a[116:119], a[228:231], v[48:51]
    s_waitcnt lgkmcnt(3)
    v_mfma_f32_16x16x32_bf16 v[64:67], a[96:99], a[232:235], v[64:67]
    ds_read_b128 a[228:231], v10 offset:64
    v_mfma_f32_16x16x32_bf16 v[68:71], a[100:103], a[232:235], v[68:71]
HOP2_19:
    s_cbranch_execz HOP2_20
    v_mfma_f32_16x16x32_bf16 v[72:75], a[104:107], a[232:235], v[72:75]
    v_mfma_f32_16x16x32_bf16 v[52:55], a[108:111], a[232:235], v[52:55]
    global_load_dwordx4 a[88:91], v11, s[44:45] offset:1024 sc1
    v_mfma_f32_16x16x32_bf16 v[56:59], a[112:115], a[232:235], v[56:59]
    v_mfma_f32_16x16x32_bf16 v[60:63], a[116:119], a[232:235], v[60:63]
    v_mfma_f32_16x16x32_bf16 v[64:67], a[108:111], a[236:239], v[64:67]
    ds_read_b128 a[232:235], v10 offset:25408
    v_mfma_f32_16x16x32_bf16 v[68:71], a[112:115], a[236:239], v[68:71]
    global_load_dwordx4 a[92:95], v11, s[44:45] offset:2048 sc1
    v_mfma_f32_16x16x32_bf16 v[72:75], a[116:119], a[236:239], v[72:75]
    s_waitcnt vmcnt(6) lgkmcnt(1)
    v_mfma_f32_16x16x32_bf16 v[16:19], a[120:123], a[216:219], v[16:19]
    ds_read_b128 a[236:239], v10 offset:50752
    v_mfma_f32_16x16x32_bf16 v[20:23], a[124:127], a[216:219], v[20:23]
    v_mfma_f32_16x16x32_bf16 v[24:27], a[128:131], a[216:219], v[24:27]
    v_add_u32 v9, s53, v9
    v_mfma_f32_16x16x32_bf16 v[28:31], a[120:123], a[220:223], v[28:31]
    ds_read_b128 a[216:219], v9 offset:0
    v_add_u32 v11, 6144, v11
    v_mfma_f32_16x16x32_bf16 v[32:35], a[124:127], a[220:223], v[32:35]
    global_load_dwordx4 a[96:99], v11, s[44:45] offset:-3072 sc1
    v_mfma_f32_16x16x32_bf16 v[36:39], a[128:131], a[220:223], v[36:39]
    v_mfma_f32_16x16x32_bf16 v[16:19], a[132:135], a[220:223], v[16:19]
    global_load_dwordx4 a[100:103], v11, s[44:45] offset:-2048 sc1
    v_mfma_f32_16x16x32_bf16 v[20:23], a[136:139], a[220:223], v[20:23]
    v_mfma_f32_16x16x32_bf16 v[24:27], a[140:143], a[220:223], v[24:27]
    v_mfma_f32_16x16x32_bf16 v[40:43], a[120:123], a[224:227], v[40:43]
    ds_read_b128 a[220:223], v9 offset:25344
    v_mfma_f32_16x16x32_bf16 v[44:47], a[124:127], a[224:227], v[44:47]
    v_mfma_f32_16x16x32_bf16 v[48:51], a[128:131], a[224:227], v[48:51]
    v_mfma_f32_16x16x32_bf16 v[28:31], a[132:135], a[224:227], v[28:31]
    global_load_dwordx4 a[104:107], v11, s[44:45] offset:-1024 sc1
    v_mfma_f32_16x16x32_bf16 v[32:35], a[136:139], a[224:227], v[32:35]
HOP2_20:
    s_cbranch_execz HOPRET2
    v_mfma_f32_16x16x32_bf16 v[36:39], a[140:143], a[224:227], v[36:39]
    v_mfma_f32_16x16x32_bf16 v[52:55], a[120:123], a[228:231], v[52:55]
    ds_read_b128 a[224:227], v9 offset:50688
    v_mfma_f32_16x16x32_bf16 v[56:59], a[124:127], a[228:231], v[56:59]
    v_mfma_f32_16x16x32_bf16 v[60:63], a[128:131], a[228:231], v[60:63]
    v_mfma_f32_16x16x32_bf16 v[40:43], a[132:135], a[228:231], v[40:43]
    global_load_dwordx4 a[108:111], v11, s[44:45] offset:0 sc1
    v_mfma_f32_16x16x32_bf16 v[44:47], a[136:139], a[228:231], v[44:47]
    v_mfma_f32_16x16x32_bf16 v[48:51], a[140:143], a[228:231], v[48:51]
    s_waitcnt lgkmcnt(3)
    v_add_u32 v10, s53, v10
    v_mfma_f32_16x16x32_bf16 v[64:67], a[120:123], a[232:235], v[64:67]
    ds_read_b128 a[228:231], v10 offset:0
    v_mfma_f32_16x16x32_bf16 v[68:71], a[124:127], a[232:235], v[68:71]
    v_mfma_f32_16x16x32_bf16 v[72:75], a[128:131], a[232:235], v[72:75]
    v_mfma_f32_16x16x32_bf16 v[52:55], a[132:135], a[232:235], v[52:55]
    global_load_dwordx4 a[112:115], v11, s[44:45] offset:1024 sc1
    v_mfma_f32_16x16x32_bf16 v[56:59], a[136:139], a[232:235], v[56:59]
    v_mfma_f32_16x16x32_bf16 v[60:63], a[140:143], a[232:235], v[60:63]
    v_mfma_f32_16x16x32_bf16 v[64:67], a[132:135], a[236:239], v[64:67]
    s_cmp_lg_u32 s52, 0
    ds_read_b128 a[232:235], v10 offset:25344
    v_mfma_f32_16x16x32_bf16 v[68:71], a[136:139], a[236:239], v[68:71]
    global_load_dwordx4 a[116:119], v11, s[44:45] offset:2048 sc1
    v_mfma_f32_16x16x32_bf16 v[72:75], a[140:143], a[236:239], v[72:75]
    s_cbranch_scc0 L_SPLIT
    s_branch L_LOOP2
.p2align 5
L_SPLIT:
    s_cmp_eq_u32 s19, 0
    s_cbranch_scc0 L_P3B
    s_waitcnt vmcnt(9) lgkmcnt(3)
    v_mfma_f32_16x16x32_bf16 v[160:163], a[72:75], a[216:219], 0
    s_barrier
    ds_read_b128 a[236:239], v9 offset:32
    v_mfma_f32_16x16x32_bf16 v[164:167], a[76:79], a[216:219], 0
HOP1_35:
    s_cbranch_execz HOP1_36
    v_add_u32 v11, 6144, v11
    v_mfma_f32_16x16x32_bf16 v[168:171], a[80:83], a[216:219], 0
    global_load_dwordx4 a[120:123], v11, s[44:45] offset:-3072 sc1
    v_mfma_f32_16x16x32_bf16 v[172:175], a[72:75], a[220:223], 0
    ds_read_b128 a[216:219], v9 offset:25376
    v_mfma_f32_16x16x32_bf16 v[176:179], a[76:79], a[220:223], 0
    ds_write_b32 v12, v18 offset:8448
    v_mfma_f32_16x16x32_bf16 v[180:183], a[80:83], a[220:223], 0
    s_waitcnt lgkmcnt(4)
    ds_write_b32 v12, v19 offset:8452
    v_mfma_f32_16x16x32_bf16 v[184:187], a[72:75], a[224:227], 0
    ds_read_b128 a[220:223], v9 offset:50720
    v_mfma_f32_16x16x32_bf16 v[188:191], a[76:79], a[224:227], 0
    ds_write_b32 v12, v22 offset:8960
    v_mfma_f32_16x16x32_bf16 v[192:195], a[80:83], a[224:227], 0
    global_load_dwordx4 a[124:127], v11, s[44:45] offset:-2048 sc1
    v_mfma_f32_16x16x32_bf16 v[196:199], a[72:75], a[228:231], 0
    ds_read_b128 a[224:227], v10 offset:32
    v_mfma_f32_16x16x32_bf16 v[200:203], a[76:79], a[228:231], 0
    ds_write_b32 v12, v23 offset:8964
    v_mfma_f32_16x16x32_bf16 v[204:207], a[80:83], a[228:231], 0
    s_waitcnt lgkmcnt(8)
    global_load_dwordx4 a[128:131], v11, s[44:45] offset:-1024 sc1
    v_mfma_f32_16x16x32_bf16 v[208:211], a[72:75], a[232:235], 0
    ds_read_b128 a[228:231], v10 offset:25376
    v_mfma_f32_16x16x32_bf16 v[212:215], a[76:79], a[232:235], 0
    ds_write_b32 v12, v26 offset:9472
    v_mfma_f32_16x16x32_bf16 v[216:219], a[80:83], a[232:235], 0
    s_waitcnt vmcnt(9) lgkmcnt(8)
    ds_write_b32 v12, v27 offset:9476
    v_mfma_f32_16x16x32_bf16 v[160:163], a[84:87], a[236:239], v[160:163]
    ds_read_b128 a[232:235], v9 offset:64
    v_mfma_f32_16x16x32_bf16 v[164:167], a[88:91], a[236:239], v[164:167]
HOP1_36:
    s_cbranch_execz HOP1_37
    ds_write_b32 v12, v30 offset:9984
    v_mfma_f32_16x16x32_bf16 v[168:171], a[92:95], a[236:239], v[168:171]
    global_load_dwordx4 a[132:135], v11, s[44:45] offset:0 sc1
    v_mfma_f32_16x16x32_bf16 v[172:175], a[84:87], a[216:219], v[172:175]
    ds_read_b128 a[236:239], v9 offset:25408
    v_mfma_f32_16x16x32_bf16 v[176:179], a[88:91], a[216:219], v[176:179]
    ds_write_b32 v12, v31 offset:9988
    v_mfma_f32_16x16x32_bf16 v[180:183], a[92:95], a[216:219], v[180:183]
    s_waitcnt lgkmcnt(8)
    ds_write_b32 v12, v34 offset:10496
    v_mfma_f32_16x16x32_bf16 v[184:187], a[84:87], a[220:223], v[184:187]
    ds_read_b128 a[216:219], v9 offset:50752
    v_mfma_f32_16x16x32_bf16 v[188:191], a[88:91], a[220:223], v[188:191]
    ds_write_b32 v12, v35 offset:10500
    v_mfma_f32_16x16x32_bf16 v[192:195], a[92:95], a[220:223], v[192:195]
    global_load_dwordx4 a[136:139], v11, s[44:45] offset:1024 sc1
    v_mfma_f32_16x16x32_bf16 v[196:199], a[84:87], a[224:227], v[196:199]
    ds_read_b128 a[220:223], v10 offset:64
    v_mfma_f32_16x16x32_bf16 v[200:203], a[88:91], a[224:227], v[200:203]
    ds_write_b32 v12, v38 offset:11008
    v_mfma_f32_16x16x32_bf16 v[204:207], a[92:95], a[224:227], v[204:207]
    s_waitcnt lgkmcnt(11)
    global_load_dwordx4 a[140:143], v11, s[44:45] offset:2048 sc1
    v_mfma_f32_16x16x32_bf16 v[208:211], a[84:87], a[228:231], v[208:211]
    ds_read_b128 a[224:227], v10 offset:25408
    v_mfma_f32_16x16x32_bf16 v[212:215], a[88:91], a[228:231], v[212:215]
    ds_write_b32 v12, v39 offset:11012
    v_mfma_f32_16x16x32_bf16 v[216:219], a[92:95], a[228:231], v[216:219]
    s_waitcnt vmcnt(9) lgkmcnt(8)
    v_add_u32 v9, 96, v9
    v_mfma_f32_16x16x32_bf16 v[160:163], a[96:99], a[232:235], v[160:163]
    ds_read_b128 a[228:231], v9 offset:0
    v_mfma_f32_16x16x32_bf16 v[164:167], a[100:103], a[232:235], v[164:167]
HOP1_37:
    s_cbranch_execz HOP1_38
    v_add_u32 v11, 6144, v11
    v_mfma_f32_16x16x32_bf16 v[168:171], a[104:107], a[232:235], v[168:171]
    global_load_dwordx4 a[72:75], v11, s[44:45] offset:-3072 sc1
    v_mfma_f32_16x16x32_bf16 v[172:175], a[96:99], a[236:239], v[172:175]
    ds_read_b128 a[232:235], v9 offset:25344
    v_mfma_f32_16x16x32_bf16 v[176:179], a[100:103], a[236:239], v[176:179]
    ds_write_b32 v12, v42 offset:11520
    v_mfma_f32_16x16x32_bf16 v[180:183], a[104:107], a[236:239], v[180:183]
    s_waitcnt lgkmcnt(6)
    ds_write_b32 v12, v43 offset:11524
    v_mfma_f32_16x16x32_bf16 v[184:187], a[96:99], a[216:219], v[184:187]
    ds_read_b128 a[236:239], v9 offset:50688
    v_mfma_f32_16x16x32_bf16 v[188:191], a[100:103], a[216:219], v[188:191]
    ds_write_b32 v12, v46 offset:12032
    v_mfma_f32_16x16x32_bf16 v[192:195], a[104:107], a[216:219], v[192:195]
    v_add_u32 v10, 96, v10
    v_mfma_f32_16x16x32_bf16 v[196:199], a[96:99], a[220:223], v[196:199]
    ds_read_b128 a[216:219], v10 offset:0
    v_mfma_f32_16x16x32_bf16 v[200:203], a[100:103], a[220:223], v[200:203]
    global_load_dwordx4 a[76:79], v11, s[44:45] offset:-2048 sc1
    v_mfma_f32_16x16x32_bf16 v[204:207], a[104:107], a[220:223], v[204:207]
    s_waitcnt lgkmcnt(8)
    global_load_dwordx4 a[80:83], v11, s[44:45] offset:-1024 sc1
    v_mfma_f32_16x16x32_bf16 v[208:211], a[96:99], a[224:227], v[208:211]
    ds_read_b128 a[220:223], v10 offset:25344
    v_mfma_f32_16x16x32_bf16 v[212:215], a[100:103], a[224:227], v[212:215]
    ds_write_b32 v12, v47 offset:12036
    v_mfma_f32_16x16x32_bf16 v[216:219], a[104:107], a[224:227], v[216:219]
    s_waitcnt vmcnt(9) lgkmcnt(7)
    ds_write_b32 v12, v50 offset:33792
    v_mfma_f32_16x16x32_bf16 v[160:163], a[108:111], a[228:231], v[160:163]
    ds_read_b128 a[224:227], v9 offset:32
    v_mfma_f32_16x16x32_bf16 v[164:167], a[112:115], a[228:231], v[164:167]
HOP1_38:
    s_cbranch_execz HOP1_39
    ds_write_b32 v12, v51 offset:33796
    v_mfma_f32_16x16x32_bf16 v[168:171], a[116:119], a[228:231], v[168:171]
    global_load_dwordx4 a[84:87], v11, s[44:45] offset:0 sc1
    v_mfma_f32_16x16x32_bf16 v[172:175], a[108:111], a[232:235], v[172:175]
    ds_read_b128 a[228:231], v9 offset:25376
    v_mfma_f32_16x16x32_bf16 v[176:179], a[112:115], a[232:235], v[176:179]
    ds_write_b32 v12, v54 offset:34304
    v_mfma_f32_16x16x32_bf16 v[180:183], a[116:119], a[232:235], v[180:183]
    s_waitcnt lgkmcnt(7)
    ds_write_b32 v12, v55 offset:34308
    v_mfma_f32_16x16x32_bf16 v[184:187], a[108:111], a[236:239], v[184:187]
    ds_read_b128 a[232:235], v9 offset:50720
    v_mfma_f32_16x16x32_bf16 v[188:191], a[112:115], a[236:239], v[188:191]
    ds_write_b32 v12, v58 offset:34816
    v_mfma_f32_16x16x32_bf16 v[192:195], a[116:119], a[236:239], v[192:195]
    global_load_dwordx4 a[88:91], v11, s[44:45] offset:1024 sc1
    v_mfma_f32_16x16x32_bf16 v[196:199], a[108:111], a[216:219], v[196:199]
    ds_read_b128 a[236:239], v10 offset:32
    v_mfma_f32_16x16x32_bf16 v[200:203], a[112:115], a[216:219], v[200:203]
    ds_write_b32 v12, v59 offset:34820
    v_mfma_f32_16x16x32_bf16 v[204:207], a[116:119], a[216:219], v[204:207]
    s_waitcnt lgkmcnt(11)
    global_load_dwordx4 a[92:95], v11, s[44:45] offset:2048 sc1
    v_mfma_f32_16x16x32_bf16 v[208:211], a[108:111], a[220:223], v[208:211]
    ds_read_b128 a[216:219], v10 offset:25376
    v_mfma_f32_16x16x32_bf16 v[212:215], a[112:115], a[220:223], v[212:215]
    ds_write_b32 v12, v62 offset:35328
    v_mfma_f32_16x16x32_bf16 v[216:219], a[116:119], a[220:223], v[216:219]
    s_waitcnt vmcnt(9) lgkmcnt(8)
    ds_write_b32 v12, v63 offset:35332
    v_mfma_f32_16x16x32_bf16 v[160:163], a[120:123], a[224:227], v[160:163]
    ds_read_b128 a[220:223], v9 offset:64
    v_mfma_f32_16x16x32_bf16 v[164:167], a[124:127], a[224:227], v[164:167]
HOP1_39:
    s_cbranch_execz HOP1_40
    v_add_u32 v11, 6144, v11
    v_mfma_f32_16x16x32_bf16 v[168:171], a[128:131], a[224:227], v[168:171]
    global_load_dwordx4 a[96:99], v11, s[44:45] offset:-3072 sc1
    v_mfma_f32_16x16x32_bf16 v[172:175], a[120:123], a[228:231], v[172:175]
    ds_read_b128 a[224:227], v9 offset:25408
    v_mfma_f32_16x16x32_bf16 v[176:179], a[124:127], a[228:231], v[176:179]
    ds_write_b32 v12, v66 offset:35840
    v_mfma_f32_16x16x32_bf16 v[180:183], a[128:131], a[228:231], v[180:183]
    s_waitcnt lgkmcnt(7)
    ds_write_b32 v12, v67 offset:35844
    v_mfma_f32_16x16x32_bf16 v[184:187], a[120:123], a[232:235], v[184:187]
    ds_read_b128 a[228:231], v9 offset:50752
    v_mfma_f32_16x16x32_bf16 v[188:191], a[124:127], a[232:235], v[188:191]
    ds_write_b32 v12, v70 offset:36352
    v_mfma_f32_16x16x32_bf16 v[192:195], a[128:131], a[232:235], v[192:195]
    global_load_dwordx4 a[100:103], v11, s[44:45] offset:-2048 sc1
    v_mfma_f32_16x16x32_bf16 v[196:199], a[120:123], a[236:239], v[196:199]
    ds_read_b128 a[232:235], v10 offset:64
    v_mfma_f32_16x16x32_bf16 v[200:203], a[124:127], a[236:239], v[200:203]
    ds_write_b32 v12, v71 offset:36356
    v_mfma_f32_16x16x32_bf16 v[204:207], a[128:131], a[236:239], v[204:207]
    s_waitcnt lgkmcnt(10)
    global_load_dwordx4 a[104:107], v11, s[44:45] offset:-1024 sc1
    v_mfma_f32_16x16x32_bf16 v[208:211], a[120:123], a[216:219], v[208:211]
    ds_read_b128 a[236:239], v10 offset:25408
    v_mfma_f32_16x16x32_bf16 v[212:215], a[124:127], a[216:219], v[212:215]
    ds_write_b32 v12, v74 offset:36864
    v_mfma_f32_16x16x32_bf16 v[216:219], a[128:131], a[216:219], v[216:219]
    s_waitcnt vmcnt(9) lgkmcnt(8)
    v_add_u32 v9, 96, v9
    v_mfma_f32_16x16x32_bf16 v[160:163], a[132:135], a[220:223], v[160:163]
    ds_read_b128 a[216:219], v9 offset:0
    v_mfma_f32_16x16x32_bf16 v[164:167], a[136:139], a[220:223], v[164:167]
HOP1_40:
    s_cbranch_execz HOP1_41
    ds_write_b32 v12, v75 offset:36868
    v_mfma_f32_16x16x32_bf16 v[168:171], a[140:143], a[220:223], v[168:171]
    s_waitcnt lgkmcnt(0)
    s_barrier
    global_load_dwordx4 a[108:111], v11, s[44:45] offset:0 sc1
    v_mfma_f32_16x16x32_bf16 v[172:175], a[132:135], a[224:227], v[172:175]
    ds_read_b128 a[220:223], v9 offset:25344
    ds_read_b64 v[226:227], v13 offset:8448
    v_mfma_f32_16x16x32_bf16 v[176:179], a[136:139], a[224:227], v[176:179]
    ds_read_b64 v[228:229], v13 offset:8960
    ds_read_b64 v[230:231], v13 offset:9472
    v_mfma_f32_16x16x32_bf16 v[180:183], a[140:143], a[224:227], v[180:183]
    ds_read_b64 v[232:233], v13 offset:9984
    v_mfma_f32_16x16x32_bf16 v[184:187], a[132:135], a[228:231], v[184:187]
    ds_read_b128 a[224:227], v9 offset:50688
    v_mfma_f32_16x16x32_bf16 v[188:191], a[136:139], a[228:231], v[188:191]
    v_mfma_f32_16x16x32_bf16 v[192:195], a[140:143], a[228:231], v[192:195]
    v_add_u32 v10, 96, v10
    v_mfma_f32_16x16x32_bf16 v[196:199], a[132:135], a[232:235], v[196:199]
    s_waitcnt lgkmcnt(4)
    ds_read_b128 a[228:231], v10 offset:0
    v_sub_f32 v18, v16, v226
    v_mfma_f32_16x16x32_bf16 v[200:203], a[136:139], a[232:235], v[200:203]
    global_load_dwordx4 a[112:115], v11, s[44:45] offset:1024 sc1
    v_mfma_f32_16x16x32_bf16 v[204:207], a[140:143], a[232:235], v[204:207]
    global_load_dwordx4 a[116:119], v11, s[44:45] offset:2048 sc1
    v_mfma_f32_16x16x32_bf16 v[208:211], a[132:135], a[236:239], v[208:211]
    ds_read_b128 a[232:235], v10 offset:25344
    v_add_f32 v226, v16, v226
    v_mfma_f32_16x16x32_bf16 v[212:215], a[136:139], a[236:239], v[212:215]
    v_sub_f32 v19, v17, v227
    v_add_f32 v227, v17, v227
    v_mfma_f32_16x16x32_bf16 v[216:219], a[140:143], a[236:239], v[216:219]
    s_waitcnt vmcnt(9)
    v_fmac_f32 v106, s79, v18
    v_add_f32 v76, v76, v226
    v_mfma_f32_16x16x32_bf16 v[160:163], a[72:75], a[216:219], v[160:163]
HOP1_41:
    s_cbranch_execz HOP1_42
    ds_read_b128 a[236:239], v9 offset:32
    v_fmac_f32 v136, s68, v226
    v_mfma_f32_16x16x32_bf16 v[164:167], a[76:79], a[216:219], v[164:167]
    v_add_u32 v11, 6144, v11
    v_fmac_f32 v107, s79, v19
    v_mfma_f32_16x16x32_bf16 v[168:171], a[80:83], a[216:219], v[168:171]
    global_load_dwordx4 a[120:123], v11, s[44:45] offset:-3072 sc1
    v_mfma_f32_16x16x32_bf16 v[172:175], a[72:75], a[220:223], v[172:175]
    ds_read_b128 a[216:219], v9 offset:25376
    v_add_f32 v77, v77, v227
    v_mfma_f32_16x16x32_bf16 v[176:179], a[76:79], a[220:223], v[176:179]
    ds_read_b64 v[234:235], v13 offset:10496
    v_fmac_f32 v137, s68, v227
    v_mfma_f32_16x16x32_bf16 v[180:183], a[80:83], a[220:223], v[180:183]
    s_waitcnt lgkmcnt(4)
    v_sub_f32 v22, v20, v228
    v_add_f32 v228, v20, v228
    v_mfma_f32_16x16x32_bf16 v[184:187], a[72:75], a[224:227], v[184:187]
    ds_read_b128 a[220:223], v9 offset:50720
    v_sub_f32 v23, v21, v229
    v_mfma_f32_16x16x32_bf16 v[188:191], a[76:79], a[224:227], v[188:191]
    v_add_f32 v229, v21, v229
    v_fmac_f32 v108, s79, v22
    v_mfma_f32_16x16x32_bf16 v[192:195], a[80:83], a[224:227], v[192:195]
    global_load_dwordx4 a[124:127], v11, s[44:45] offset:-2048 sc1
    v_mfma_f32_16x16x32_bf16 v[196:199], a[72:75], a[228:231], v[196:199]
    ds_read_b128 a[224:227], v10 offset:32
    v_add_f32 v78, v78, v228
    v_mfma_f32_16x16x32_bf16 v[200:203], a[76:79], a[228:231], v[200:203]
    v_fmac_f32 v138, s68, v228
    v_fmac_f32 v109, s79, v23
    v_mfma_f32_16x16x32_bf16 v[204:207], a[80:83], a[228:231], v[204:207]
    s_waitcnt lgkmcnt(5)
    global_load_dwordx4 a[128:131], v11, s[44:45] offset:-1024 sc1
    v_mfma_f32_16x16x32_bf16 v[208:211], a[72:75], a[232:235], v[208:211]
    ds_read_b128 a[228:231], v10 offset:25376
    v_add_f32 v79, v79, v229
    v_mfma_f32_16x16x32_bf16 v[212:215], a[76:79], a[232:235], v[212:215]
HOP1_42:
    s_cbranch_execz HOP1_43
    ds_read_b64 v[236:237], v13 offset:11008
    v_fmac_f32 v139, s68, v229
    v_mfma_f32_16x16x32_bf16 v[216:219], a[80:83], a[232:235], v[216:219]
    s_waitcnt vmcnt(9) lgkmcnt(5)
    v_sub_f32 v26, v24, v230
    v_add_f32 v230, v24, v230
    v_mfma_f32_16x16x32_bf16 v[160:163], a[84:87], a[236:239], v[160:163]
    ds_read_b128 a[232:235], v9 offset:64
    v_sub_f32 v27, v25, v231
    v_mfma_f32_16x16x32_bf16 v[164:167], a[88:91], a[236:239], v[164:167]
    v_add_f32 v231, v25, v231
    v_fmac_f32 v110, s79, v26
    v_mfma_f32_16x16x32_bf16 v[168:171], a[92:95], a[236:239], v[168:171]
    global_load_dwordx4 a[132:135], v11, s[44:45] offset:0 sc1
    v_mfma_f32_16x16x32_bf16 v[172:175], a[84:87], a[216:219], v[172:175]
    ds_read_b128 a[236:239], v9 offset:25408
    v_add_f32 v80, v80, v230
    v_mfma_f32_16x16x32_bf16 v[176:179], a[88:91], a[216:219], v[176:179]
    v_fmac_f32 v140, s68, v230
    v_fmac_f32 v111, s79, v27
    v_mfma_f32_16x16x32_bf16 v[180:183], a[92:95], a[216:219], v[180:183]
    s_waitcnt lgkmcnt(4)
    v_add_f32 v81, v81, v231
    v_fmac_f32 v141, s68, v231
    v_mfma_f32_16x16x32_bf16 v[184:187], a[84:87], a[220:223], v[184:187]
    ds_read_b128 a[216:219], v9 offset:50752
    ds_read_b64 v[238:239], v13 offset:11520
    v_mfma_f32_16x16x32_bf16 v[188:191], a[88:91], a[220:223], v[188:191]
    v_sub_f32 v30, v28, v232
    v_add_f32 v232, v28, v232
    v_mfma_f32_16x16x32_bf16 v[192:195], a[92:95], a[220:223], v[192:195]
    global_load_dwordx4 a[136:139], v11, s[44:45] offset:1024 sc1
    v_mfma_f32_16x16x32_bf16 v[196:199], a[84:87], a[224:227], v[196:199]
    ds_read_b128 a[220:223], v10 offset:64
    v_sub_f32 v31, v29, v233
    v_mfma_f32_16x16x32_bf16 v[200:203], a[88:91], a[224:227], v[200:203]
    v_add_f32 v233, v29, v233
    v_fmac_f32 v112, s79, v30
    v_mfma_f32_16x16x32_bf16 v[204:207], a[92:95], a[224:227], v[204:207]
    s_waitcnt lgkmcnt(6)
    global_load_dwordx4 a[140:143], v11, s[44:45] offset:2048 sc1
    v_mfma_f32_16x16x32_bf16 v[208:211], a[84:87], a[228:231], v[208:211]
HOP1_43:
    s_cbranch_execz HOP1_44
    ds_read_b128 a[224:227], v10 offset:25408
    v_add_f32 v82, v82, v232
    v_mfma_f32_16x16x32_bf16 v[212:215], a[88:91], a[228:231], v[212:215]
    v_fmac_f32 v142, s68, v232
    v_fmac_f32 v113, s79, v31
    v_mfma_f32_16x16x32_bf16 v[216:219], a[92:95], a[228:231], v[216:219]
    s_waitcnt vmcnt(9) lgkmcnt(4)
    v_add_u32 v9, 96, v9
    v_add_f32 v83, v83, v233
    v_mfma_f32_16x16x32_bf16 v[160:163], a[96:99], a[232:235], v[160:163]
    ds_read_b128 a[228:231], v9 offset:0
    v_fmac_f32 v143, s68, v233
    v_mfma_f32_16x16x32_bf16 v[164:167], a[100:103], a[232:235], v[164:167]
    ds_read_b64 v[240:241], v13 offset:12032
    v_add_u32 v11, 6144, v11
    v_mfma_f32_16x16x32_bf16 v[168:171], a[104:107], a[232:235], v[168:171]
    global_load_dwordx4 a[72:75], v11, s[44:45] offset:-3072 sc1
    v_mfma_f32_16x16x32_bf16 v[172:175], a[96:99], a[236:239], v[172:175]
    ds_read_b128 a[232:235], v9 offset:25344
    v_sub_f32 v34, v32, v234
    v_mfma_f32_16x16x32_bf16 v[176:179], a[100:103], a[236:239], v[176:179]
    v_add_f32 v234, v32, v234
    v_sub_f32 v35, v33, v235
    v_mfma_f32_16x16x32_bf16 v[180:183], a[104:107], a[236:239], v[180:183]
    s_waitcnt lgkmcnt(4)
    v_add_f32 v235, v33, v235
    v_fmac_f32 v114, s79, v34
    v_mfma_f32_16x16x32_bf16 v[184:187], a[96:99], a[216:219], v[184:187]
    ds_read_b128 a[236:239], v9 offset:50688
    v_add_f32 v84, v84, v234
    v_mfma_f32_16x16x32_bf16 v[188:191], a[100:103], a[216:219], v[188:191]
    v_fmac_f32 v144, s68, v234
    v_fmac_f32 v115, s79, v35
    v_mfma_f32_16x16x32_bf16 v[192:195], a[104:107], a[216:219], v[192:195]
    v_add_u32 v10, 96, v10
    v_add_f32 v85, v85, v235
    v_mfma_f32_16x16x32_bf16 v[196:199], a[96:99], a[220:223], v[196:199]
    ds_read_b128 a[216:219], v10 offset:0
    v_fmac_f32 v145, s68, v235
    v_mfma_f32_16x16x32_bf16 v[200:203], a[100:103], a[220:223], v[200:203]
HOP1_44:
    s_cbranch_execz HOP1_45
    global_load_dwordx4 a[76:79], v11, s[44:45] offset:-2048 sc1
    v_mfma_f32_16x16x32_bf16 v[204:207], a[104:107], a[220:223], v[204:207]
    s_waitcnt lgkmcnt(5)
    global_load_dwordx4 a[80:83], v11, s[44:45] offset:-1024 sc1
    v_mfma_f32_16x16x32_bf16 v[208:211], a[96:99], a[224:227], v[208:211]
    ds_read_b128 a[220:223], v10 offset:25344
    ds_read_b64 v[242:243], v13 offset:33792
    v_mfma_f32_16x16x32_bf16 v[212:215], a[100:103], a[224:227], v[212:215]
    v_sub_f32 v38, v36, v236
    v_add_f32 v236, v36, v236
    v_mfma_f32_16x16x32_bf16 v[216:219], a[104:107], a[224:227], v[216:219]
    s_waitcnt vmcnt(9) lgkmcnt(4)
    v_sub_f32 v39, v37, v237
    v_add_f32 v237, v37, v237
    v_mfma_f32_16x16x32_bf16 v[160:163], a[108:111], a[228:231], v[160:163]
    ds_read_b128 a[224:227], v9 offset:32
    v_fmac_f32 v116, s79, v38
    v_mfma_f32_16x16x32_bf16 v[164:167], a[112:115], a[228:231], v[164:167]
    v_add_f32 v86, v86, v236
    v_fmac_f32 v146, s68, v236
    v_mfma_f32_16x16x32_bf16 v[168:171], a[116:119], a[228:231], v[168:171]
    global_load_dwordx4 a[84:87], v11, s[44:45] offset:0 sc1
    v_mfma_f32_16x16x32_bf16 v[172:175], a[108:111], a[232:235], v[172:175]
    ds_read_b128 a[228:231], v9 offset:25376
    v_fmac_f32 v117, s79, v39
    v_mfma_f32_16x16x32_bf16 v[176:179], a[112:115], a[232:235], v[176:179]
    v_add_f32 v87, v87, v237
    v_fmac_f32 v147, s68, v237
    v_mfma_f32_16x16x32_bf16 v[180:183], a[116:119], a[232:235], v[180:183]
    s_waitcnt lgkmcnt(4)
    ds_read_b64 v[244:245], v13 offset:34304
    v_sub_f32 v42, v40, v238
    v_mfma_f32_16x16x32_bf16 v[184:187], a[108:111], a[236:239], v[184:187]
    ds_read_b128 a[232:235], v9 offset:50720
    v_add_f32 v238, v40, v238
    v_mfma_f32_16x16x32_bf16 v[188:191], a[112:115], a[236:239], v[188:191]
    v_sub_f32 v43, v41, v239
    v_add_f32 v239, v41, v239
    v_mfma_f32_16x16x32_bf16 v[192:195], a[116:119], a[236:239], v[192:195]
HOP1_45:
    s_cbranch_execz HOP1_46
    global_load_dwordx4 a[88:91], v11, s[44:45] offset:1024 sc1
    v_mfma_f32_16x16x32_bf16 v[196:199], a[108:111], a[216:219], v[196:199]
    ds_read_b128 a[236:239], v10 offset:32
    v_fmac_f32 v118, s79, v42
    v_mfma_f32_16x16x32_bf16 v[200:203], a[112:115], a[216:219], v[200:203]
    v_add_f32 v88, v88, v238
    v_fmac_f32 v148, s68, v238
    v_mfma_f32_16x16x32_bf16 v[204:207], a[116:119], a[216:219], v[204:207]
    s_waitcnt lgkmcnt(6)
    global_load_dwordx4 a[92:95], v11, s[44:45] offset:2048 sc1
    v_mfma_f32_16x16x32_bf16 v[208:211], a[108:111], a[220:223], v[208:211]
    ds_read_b128 a[216:219], v10 offset:25376
    v_fmac_f32 v119, s79, v43
    v_mfma_f32_16x16x32_bf16 v[212:215], a[112:115], a[220:223], v[212:215]
    v_add_f32 v89, v89, v239
    v_fmac_f32 v149, s68, v239
    v_mfma_f32_16x16x32_bf16 v[216:219], a[116:119], a[220:223], v[216:219]
    s_waitcnt vmcnt(9) lgkmcnt(4)
    ds_read_b64 v[246:247], v13 offset:34816
    v_sub_f32 v46, v44, v240
    v_mfma_f32_16x16x32_bf16 v[160:163], a[120:123], a[224:227], v[160:163]
    ds_read_b128 a[220:223], v9 offset:64
    v_add_f32 v240, v44, v240
    v_mfma_f32_16x16x32_bf16 v[164:167], a[124:127], a[224:227], v[164:167]
    v_add_u32 v11, 6144, v11
    v_sub_f32 v47, v45, v241
    v_mfma_f32_16x16x32_bf16 v[168:171], a[128:131], a[224:227], v[168:171]
    global_load_dwordx4 a[96:99], v11, s[44:45] offset:-3072 sc1
    v_mfma_f32_16x16x32_bf16 v[172:175], a[120:123], a[228:231], v[172:175]
    ds_read_b128 a[224:227], v9 offset:25408
    v_add_f32 v241, v45, v241
    v_mfma_f32_16x16x32_bf16 v[176:179], a[124:127], a[228:231], v[176:179]
    v_fmac_f32 v120, s79, v46
    v_add_f32 v90, v90, v240
    v_mfma_f32_16x16x32_bf16 v[180:183], a[128:131], a[228:231], v[180:183]
    s_waitcnt lgkmcnt(4)
    v_fmac_f32 v150, s68, v240
    v_fmac_f32 v121, s79, v47
    v_mfma_f32_16x16x32_bf16 v[184:187], a[120:123], a[232:235], v[184:187]
    ds_read_b128 a[228:231], v9 offset:50752
    v_add_f32 v91, v91, v241
    v_mfma_f32_16x16x32_bf16 v[188:191], a[124:127], a[232:235], v[188:191]
HOP1_46:
    s_cbranch_execz HOP1_47
    ds_read_b64 v[248:249], v13 offset:35328
    v_fmac_f32 v151, s68, v241
    v_mfma_f32_16x16x32_bf16 v[192:195], a[128:131], a[232:235], v[192:195]
    global_load_dwordx4 a[100:103], v11, s[44:45] offset:-2048 sc1
    v_mfma_f32_16x16x32_bf16 v[196:199], a[120:123], a[236:239], v[196:199]
    ds_read_b128 a[232:235], v10 offset:64
    v_sub_f32 v50, v48, v242
    v_mfma_f32_16x16x32_bf16 v[200:203], a[124:127], a[236:239], v[200:203]
    v_add_f32 v242, v48, v242
    v_sub_f32 v51, v49, v243
    v_mfma_f32_16x16x32_bf16 v[204:207], a[128:131], a[236:239], v[204:207]
    s_waitcnt lgkmcnt(6)
    global_load_dwordx4 a[104:107], v11, s[44:45] offset:-1024 sc1
    v_mfma_f32_16x16x32_bf16 v[208:211], a[120:123], a[216:219], v[208:211]
    ds_read_b128 a[236:239], v10 offset:25408
    v_add_f32 v243, v49, v243
    v_mfma_f32_16x16x32_bf16 v[212:215], a[124:127], a[216:219], v[212:215]
    v_fmac_f32 v122, s79, v50
    v_add_f32 v92, v92, v242
    v_mfma_f32_16x16x32_bf16 v[216:219], a[128:131], a[216:219], v[216:219]
    s_waitcnt vmcnt(9) lgkmcnt(4)
    v_add_u32 v9, 96, v9
    v_fmac_f32 v152, s68, v242
    v_mfma_f32_16x16x32_bf16 v[160:163], a[132:135], a[220:223], v[160:163]
    ds_read_b128 a[216:219], v9 offset:0
    v_fmac_f32 v123, s79, v51
    v_mfma_f32_16x16x32_bf16 v[164:167], a[136:139], a[220:223], v[164:167]
    v_add_f32 v93, v93, v243
    v_fmac_f32 v153, s68, v243
    v_mfma_f32_16x16x32_bf16 v[168:171], a[140:143], a[220:223], v[168:171]
    global_load_dwordx4 a[108:111], v11, s[44:45] offset:0 sc1
    v_mfma_f32_16x16x32_bf16 v[172:175], a[132:135], a[224:227], v[172:175]
    ds_read_b128 a[220:223], v9 offset:25344
    ds_read_b64 v[250:251], v13 offset:35840
    v_mfma_f32_16x16x32_bf16 v[176:179], a[136:139], a[224:227], v[176:179]
    v_sub_f32 v54, v52, v244
    v_add_f32 v244, v52, v244
    v_mfma_f32_16x16x32_bf16 v[180:183], a[140:143], a[224:227], v[180:183]
    s_waitcnt lgkmcnt(4)
    v_sub_f32 v55, v53, v245
    v_add_f32 v245, v53, v245
    v_mfma_f32_16x16x32_bf16 v[184:187], a[132:135], a[228:231], v[184:187]
    ds_read_b128 a[224:227], v9 offset:50688
    v_fmac_f32 v124, s79, v54
    v_mfma_f32_16x16x32_bf16 v[188:191], a[136:139], a[228:231], v[188:191]
HOP1_47:
    s_cbranch_execz HOP1_48
    v_add_f32 v94, v94, v244
    v_fmac_f32 v154, s68, v244
    v_mfma_f32_16x16x32_bf16 v[192:195], a[140:143], a[228:231], v[192:195]
    v_add_u32 v10, 96, v10
    v_fmac_f32 v125, s79, v55
    v_mfma_f32_16x16x32_bf16 v[196:199], a[132:135], a[232:235], v[196:199]
    ds_read_b128 a[228:231], v10 offset:0
    v_add_f32 v95, v95, v245
    v_mfma_f32_16x16x32_bf16 v[200:203], a[136:139], a[232:235], v[200:203]
    global_load_dwordx4 a[112:115], v11, s[44:45] offset:1024 sc1
    v_mfma_f32_16x16x32_bf16 v[204:207], a[140:143], a[232:235], v[204:207]
    s_waitcnt lgkmcnt(5)
    global_load_dwordx4 a[116:119], v11, s[44:45] offset:2048 sc1
    v_mfma_f32_16x16x32_bf16 v[208:211], a[132:135], a[236:239], v[208:211]
    ds_read_b128 a[232:235], v10 offset:25344
    v_fmac_f32 v155, s68, v245
    v_mfma_f32_16x16x32_bf16 v[212:215], a[136:139], a[236:239], v[212:215]
    ds_read_b64 v[252:253], v13 offset:36352
    v_sub_f32 v58, v56, v246
    v_mfma_f32_16x16x32_bf16 v[216:219], a[140:143], a[236:239], v[216:219]
    s_waitcnt vmcnt(9) lgkmcnt(5)
    v_add_f32 v246, v56, v246
    v_sub_f32 v59, v57, v247
    v_mfma_f32_16x16x32_bf16 v[160:163], a[72:75], a[216:219], v[160:163]
    ds_read_b128 a[236:239], v9 offset:32
    v_add_f32 v247, v57, v247
    v_mfma_f32_16x16x32_bf16 v[164:167], a[76:79], a[216:219], v[164:167]
    v_add_u32 v11, 6144, v11
    v_fmac_f32 v126, s79, v58
    v_mfma_f32_16x16x32_bf16 v[168:171], a[80:83], a[216:219], v[168:171]
    global_load_dwordx4 a[120:123], v11, s[44:45] offset:-3072 sc1
    v_mfma_f32_16x16x32_bf16 v[172:175], a[72:75], a[220:223], v[172:175]
HOP1_48:
    s_cbranch_execz HOP1_49
    ds_read_b128 a[216:219], v9 offset:25376
    v_add_f32 v96, v96, v246
    v_mfma_f32_16x16x32_bf16 v[176:179], a[76:79], a[220:223], v[176:179]
    v_fmac_f32 v156, s68, v246
    v_fmac_f32 v127, s79, v59
    v_mfma_f32_16x16x32_bf16 v[180:183], a[80:83], a[220:223], v[180:183]
    s_waitcnt lgkmcnt(4)
    v_add_f32 v97, v97, v247
    v_fmac_f32 v157, s68, v247
    v_mfma_f32_16x16x32_bf16 v[184:187], a[72:75], a[224:227], v[184:187]
    ds_read_b128 a[220:223], v9 offset:50720
    ds_read_b64 v[254:255], v13 offset:36864
    v_mfma_f32_16x16x32_bf16 v[188:191], a[76:79], a[224:227], v[188:191]
    v_sub_f32 v62, v60, v248
    v_add_f32 v248, v60, v248
    v_mfma_f32_16x16x32_bf16 v[192:195], a[80:83], a[224:227], v[192:195]
    global_load_dwordx4 a[124:127], v11, s[44:45] offset:-2048 sc1
    v_mfma_f32_16x16x32_bf16 v[196:199], a[72:75], a[228:231], v[196:199]
    ds_read_b128 a[224:227], v10 offset:32
    v_sub_f32 v63, v61, v249
    v_mfma_f32_16x16x32_bf16 v[200:203], a[76:79], a[228:231], v[200:203]
    v_add_f32 v249, v61, v249
    v_fmac_f32 v128, s79, v62
    v_mfma_f32_16x16x32_bf16 v[204:207], a[80:83], a[228:231], v[204:207]
    s_waitcnt lgkmcnt(6)
    global_load_dwordx4 a[128:131], v11, s[44:45] offset:-1024 sc1
    v_mfma_f32_16x16x32_bf16 v[208:211], a[72:75], a[232:235], v[208:211]
    ds_read_b128 a[228:231], v10 offset:25376
    v_add_f32 v98, v98, v248
    v_mfma_f32_16x16x32_bf16 v[212:215], a[76:79], a[232:235], v[212:215]
    v_fmac_f32 v158, s68, v248
    v_fmac_f32 v129, s79, v63
    v_mfma_f32_16x16x32_bf16 v[216:219], a[80:83], a[232:235], v[216:219]
    s_waitcnt vmcnt(9) lgkmcnt(4)
    v_add_f32 v99, v99, v249
    v_fmac_f32 v159, s68, v249
    v_mfma_f32_16x16x32_bf16 v[160:163], a[84:87], a[236:239], v[160:163]
    ds_read_b128 a[232:235], v9 offset:64
    v_sub_f32 v66, v64, v250
    v_mfma_f32_16x16x32_bf16 v[164:167], a[88:91], a[236:239], v[164:167]
    v_add_f32 v250, v64, v250
    v_sub_f32 v67, v65, v251
    v_mfma_f32_16x16x32_bf16 v[168:171], a[92:95], a[236:239], v[168:171]
HOP1_49:
    s_cbranch_execz HOP1_50
    global_load_dwordx4 a[132:135], v11, s[44:45] offset:0 sc1
    v_mfma_f32_16x16x32_bf16 v[172:175], a[84:87], a[216:219], v[172:175]
    ds_read_b128 a[236:239], v9 offset:25408
    v_add_f32 v251, v65, v251
    v_mfma_f32_16x16x32_bf16 v[176:179], a[88:91], a[216:219], v[176:179]
    v_fmac_f32 v130, s79, v66
    v_add_f32 v100, v100, v250
    v_mfma_f32_16x16x32_bf16 v[180:183], a[92:95], a[216:219], v[180:183]
    s_waitcnt lgkmcnt(3)
    v_fmac_f32 v220, s68, v250
    v_fmac_f32 v131, s79, v67
    v_mfma_f32_16x16x32_bf16 v[184:187], a[84:87], a[220:223], v[184:187]
    ds_read_b128 a[216:219], v9 offset:50752
    v_add_f32 v101, v101, v251
    v_mfma_f32_16x16x32_bf16 v[188:191], a[88:91], a[220:223], v[188:191]
    v_fmac_f32 v221, s68, v251
    v_sub_f32 v70, v68, v252
    v_mfma_f32_16x16x32_bf16 v[192:195], a[92:95], a[220:223], v[192:195]
    global_load_dwordx4 a[136:139], v11, s[44:45] offset:1024 sc1
    v_mfma_f32_16x16x32_bf16 v[196:199], a[84:87], a[224:227], v[196:199]
    ds_read_b128 a[220:223], v10 offset:64
    v_add_f32 v252, v68, v252
    v_mfma_f32_16x16x32_bf16 v[200:203], a[88:91], a[224:227], v[200:203]
    v_sub_f32 v71, v69, v253
    v_add_f32 v253, v69, v253
    v_mfma_f32_16x16x32_bf16 v[204:207], a[92:95], a[224:227], v[204:207]
    s_waitcnt lgkmcnt(4)
    global_load_dwordx4 a[140:143], v11, s[44:45] offset:2048 sc1
    v_mfma_f32_16x16x32_bf16 v[208:211], a[84:87], a[228:231], v[208:211]
    ds_read_b128 a[224:227], v10 offset:25408
    v_fmac_f32 v132, s79, v70
    v_mfma_f32_16x16x32_bf16 v[212:215], a[88:91], a[228:231], v[212:215]
    v_add_f32 v102, v102, v252
    v_fmac_f32 v222, s68, v252
    v_mfma_f32_16x16x32_bf16 v[216:219], a[92:95], a[228:231], v[216:219]
    s_waitcnt vmcnt(9) lgkmcnt(3)
    v_add_u32 v9, 96, v9
    v_fmac_f32 v133, s79, v71
    v_mfma_f32_16x16x32_bf16 v[160:163], a[96:99], a[232:235], v[160:163]
HOP1_50:
    s_cbranch_execz HOP1_51
    ds_read_b128 a[228:231], v9 offset:0
    v_add_f32 v103, v103, v253
    v_mfma_f32_16x16x32_bf16 v[164:167], a[100:103], a[232:235], v[164:167]
    v_add_u32 v11, 6144, v11
    v_fmac_f32 v223, s68, v253
    v_mfma_f32_16x16x32_bf16 v[168:171], a[104:107], a[232:235], v[168:171]
    global_load_dwordx4 a[72:75], v11, s[44:45] offset:-3072 sc1
    v_mfma_f32_16x16x32_bf16 v[172:175], a[96:99], a[236:239], v[172:175]
    ds_read_b128 a[232:235], v9 offset:25344
    v_sub_f32 v74, v72, v254
    v_mfma_f32_16x16x32_bf16 v[176:179], a[100:103], a[236:239], v[176:179]
    v_add_f32 v254, v72, v254
    v_sub_f32 v75, v73, v255
    v_mfma_f32_16x16x32_bf16 v[180:183], a[104:107], a[236:239], v[180:183]
    s_waitcnt lgkmcnt(3)
    v_add_f32 v255, v73, v255
    v_fmac_f32 v134, s79, v74
    v_mfma_f32_16x16x32_bf16 v[184:187], a[96:99], a[216:219], v[184:187]
    ds_read_b128 a[236:239], v9 offset:50688
    v_add_f32 v104, v104, v254
    v_mfma_f32_16x16x32_bf16 v[188:191], a[100:103], a[216:219], v[188:191]
    v_fmac_f32 v224, s68, v254
    v_fmac_f32 v135, s79, v75
    v_mfma_f32_16x16x32_bf16 v[192:195], a[104:107], a[216:219], v[192:195]
    v_add_u32 v10, 96, v10
    v_add_f32 v105, v105, v255
    v_mfma_f32_16x16x32_bf16 v[196:199], a[96:99], a[220:223], v[196:199]
    ds_read_b128 a[216:219], v10 offset:0
    v_fmac_f32 v225, s68, v255
    v_mfma_f32_16x16x32_bf16 v[200:203], a[100:103], a[220:223], v[200:203]
    global_load_dwordx4 a[76:79], v11, s[44:45] offset:-2048 sc1
    v_mfma_f32_16x16x32_bf16 v[204:207], a[104:107], a[220:223], v[204:207]
    s_waitcnt lgkmcnt(4)
    global_load_dwordx4 a[80:83], v11, s[44:45] offset:-1024 sc1
    v_mfma_f32_16x16x32_bf16 v[208:211], a[96:99], a[224:227], v[208:211]
    ds_read_b128 a[220:223], v10 offset:25344
    v_cvt_pk_bf16_f32 v106, v106, v107
    v_mfma_f32_16x16x32_bf16 v[212:215], a[100:103], a[224:227], v[212:215]
    ds_write_b32 v4, v106 offset:0
    v_mfma_f32_16x16x32_bf16 v[216:219], a[104:107], a[224:227], v[216:219]
    s_waitcnt vmcnt(9) lgkmcnt(4)
    v_cvt_pk_bf16_f32 v108, v108, v109
    v_mfma_f32_16x16x32_bf16 v[160:163], a[108:111], a[228:231], v[160:163]
HOP1_51:
    s_cbranch_execz HOP1_52
    ds_read_b128 a[224:227], v9 offset:32
    v_mfma_f32_16x16x32_bf16 v[164:167], a[112:115], a[228:231], v[164:167]
    ds_write_b32 v4, v108 offset:16
    v_mfma_f32_16x16x32_bf16 v[168:171], a[116:119], a[228:231], v[168:171]
    global_load_dwordx4 a[84:87], v11, s[44:45] offset:0 sc1
    v_mfma_f32_16x16x32_bf16 v[172:175], a[108:111], a[232:235], v[172:175]
    ds_read_b128 a[228:231], v9 offset:25376
    v_cvt_pk_bf16_f32 v110, v110, v111
    v_mfma_f32_16x16x32_bf16 v[176:179], a[112:115], a[232:235], v[176:179]
    ds_write_b32 v4, v110 offset:32
    v_mfma_f32_16x16x32_bf16 v[180:183], a[116:119], a[232:235], v[180:183]
    s_waitcnt lgkmcnt(6)
    v_cvt_pk_bf16_f32 v112, v112, v113
    v_mfma_f32_16x16x32_bf16 v[184:187], a[108:111], a[236:239], v[184:187]
    ds_read_b128 a[232:235], v9 offset:50720
    v_mfma_f32_16x16x32_bf16 v[188:191], a[112:115], a[236:239], v[188:191]
    ds_write_b32 v4, v112 offset:25344
    v_mfma_f32_16x16x32_bf16 v[192:195], a[116:119], a[236:239], v[192:195]
    global_load_dwordx4 a[88:91], v11, s[44:45] offset:1024 sc1
    v_mfma_f32_16x16x32_bf16 v[196:199], a[108:111], a[216:219], v[196:199]
    ds_read_b128 a[236:239], v10 offset:32
    v_cvt_pk_bf16_f32 v114, v114, v115
    v_mfma_f32_16x16x32_bf16 v[200:203], a[112:115], a[216:219], v[200:203]
    ds_write_b32 v4, v114 offset:25360
    v_mfma_f32_16x16x32_bf16 v[204:207], a[116:119], a[216:219], v[204:207]
    s_waitcnt lgkmcnt(9)
    global_load_dwordx4 a[92:95], v11, s[44:45] offset:2048 sc1
    v_mfma_f32_16x16x32_bf16 v[208:211], a[108:111], a[220:223], v[208:211]
    ds_read_b128 a[216:219], v10 offset:25376
    v_cvt_pk_bf16_f32 v116, v116, v117
    v_mfma_f32_16x16x32_bf16 v[212:215], a[112:115], a[220:223], v[212:215]
    ds_write_b32 v4, v116 offset:25376
    v_mfma_f32_16x16x32_bf16 v[216:219], a[116:119], a[220:223], v[216:219]
HOP1_52:
    s_cbranch_execz HOP1_53
    s_waitcnt vmcnt(9) lgkmcnt(7)
    v_cvt_pk_bf16_f32 v118, v118, v119
    v_mfma_f32_16x16x32_bf16 v[160:163], a[120:123], a[224:227], v[160:163]
    ds_read_b128 a[220:223], v9 offset:64
    v_mfma_f32_16x16x32_bf16 v[164:167], a[124:127], a[224:227], v[164:167]
    v_add_u32 v11, 6144, v11
    v_mfma_f32_16x16x32_bf16 v[168:171], a[128:131], a[224:227], v[168:171]
    global_load_dwordx4 a[96:99], v11, s[44:45] offset:-3072 sc1
    v_mfma_f32_16x16x32_bf16 v[172:175], a[120:123], a[228:231], v[172:175]
    ds_read_b128 a[224:227], v9 offset:25408
    v_mfma_f32_16x16x32_bf16 v[176:179], a[124:127], a[228:231], v[176:179]
    ds_write_b32 v4, v118 offset:50688
    v_mfma_f32_16x16x32_bf16 v[180:183], a[128:131], a[228:231], v[180:183]
    s_waitcnt lgkmcnt(6)
    v_cvt_pk_bf16_f32 v120, v120, v121
    v_mfma_f32_16x16x32_bf16 v[184:187], a[120:123], a[232:235], v[184:187]
    ds_read_b128 a[228:231], v9 offset:50752
    v_mfma_f32_16x16x32_bf16 v[188:191], a[124:127], a[232:235], v[188:191]
    ds_write_b32 v4, v120 offset:50704
    v_mfma_f32_16x16x32_bf16 v[192:195], a[128:131], a[232:235], v[192:195]
    global_load_dwordx4 a[100:103], v11, s[44:45] offset:-2048 sc1
    v_mfma_f32_16x16x32_bf16 v[196:199], a[120:123], a[236:239], v[196:199]
    ds_read_b128 a[232:235], v10 offset:64
    v_cvt_pk_bf16_f32 v122, v122, v123
    v_mfma_f32_16x16x32_bf16 v[200:203], a[124:127], a[236:239], v[200:203]
    ds_write_b32 v4, v122 offset:50720
    v_mfma_f32_16x16x32_bf16 v[204:207], a[128:131], a[236:239], v[204:207]
    s_waitcnt lgkmcnt(8)
    global_load_dwordx4 a[104:107], v11, s[44:45] offset:-1024 sc1
    v_mfma_f32_16x16x32_bf16 v[208:211], a[120:123], a[216:219], v[208:211]
HOP1_53:
    s_cbranch_execz HOP1_54
    ds_read_b128 a[236:239], v10 offset:25408
    v_cvt_pk_bf16_f32 v124, v124, v125
    v_mfma_f32_16x16x32_bf16 v[212:215], a[124:127], a[216:219], v[212:215]
    ds_write_b32 v4, v124 offset:4224
    v_mfma_f32_16x16x32_bf16 v[216:219], a[128:131], a[216:219], v[216:219]
    s_waitcnt vmcnt(9) lgkmcnt(7)
    v_add_u32 v9, 96, v9
    v_cvt_pk_bf16_f32 v126, v126, v127
    v_mfma_f32_16x16x32_bf16 v[160:163], a[132:135], a[220:223], v[160:163]
    ds_read_b128 a[216:219], v9 offset:0
    v_mfma_f32_16x16x32_bf16 v[164:167], a[136:139], a[220:223], v[164:167]
    ds_write_b32 v4, v126 offset:4240
    v_mfma_f32_16x16x32_bf16 v[168:171], a[140:143], a[220:223], v[168:171]
    global_load_dwordx4 a[108:111], v11, s[44:45] offset:0 sc1
    v_mfma_f32_16x16x32_bf16 v[172:175], a[132:135], a[224:227], v[172:175]
    ds_read_b128 a[220:223], v9 offset:25344
    v_cvt_pk_bf16_f32 v128, v128, v129
    v_mfma_f32_16x16x32_bf16 v[176:179], a[136:139], a[224:227], v[176:179]
    ds_write_b32 v4, v128 offset:4256
    v_mfma_f32_16x16x32_bf16 v[180:183], a[140:143], a[224:227], v[180:183]
    s_waitcnt lgkmcnt(7)
    v_cvt_pk_bf16_f32 v130, v130, v131
    v_mfma_f32_16x16x32_bf16 v[184:187], a[132:135], a[228:231], v[184:187]
    ds_read_b128 a[224:227], v9 offset:50688
    v_mfma_f32_16x16x32_bf16 v[188:191], a[136:139], a[228:231], v[188:191]
    ds_write_b32 v4, v130 offset:29568
    v_mfma_f32_16x16x32_bf16 v[192:195], a[140:143], a[228:231], v[192:195]
    v_add_u32 v10, 96, v10
    v_cvt_pk_bf16_f32 v132, v132, v133
    v_mfma_f32_16x16x32_bf16 v[196:199], a[132:135], a[232:235], v[196:199]
    ds_read_b128 a[228:231], v10 offset:0
    v_mfma_f32_16x16x32_bf16 v[200:203], a[136:139], a[232:235], v[200:203]
HOP1_54:
    s_cbranch_execz HOP1_55
    global_load_dwordx4 a[112:115], v11, s[44:45] offset:1024 sc1
    v_mfma_f32_16x16x32_bf16 v[204:207], a[140:143], a[232:235], v[204:207]
    s_waitcnt lgkmcnt(8)
    global_load_dwordx4 a[116:119], v11, s[44:45] offset:2048 sc1
    v_mfma_f32_16x16x32_bf16 v[208:211], a[132:135], a[236:239], v[208:211]
    ds_read_b128 a[232:235], v10 offset:25344
    v_mfma_f32_16x16x32_bf16 v[212:215], a[136:139], a[236:239], v[212:215]
    ds_write_b32 v4, v132 offset:29584
    v_mfma_f32_16x16x32_bf16 v[216:219], a[140:143], a[236:239], v[216:219]
    s_waitcnt vmcnt(9) lgkmcnt(6)
    v_cvt_pk_bf16_f32 v134, v134, v135
    v_mfma_f32_16x16x32_bf16 v[160:163], a[72:75], a[216:219], v[160:163]
    ds_read_b128 a[236:239], v9 offset:32
    v_mfma_f32_16x16x32_bf16 v[164:167], a[76:79], a[216:219], v[164:167]
    v_add_u32 v11, 6144, v11
    v_mfma_f32_16x16x32_bf16 v[168:171], a[80:83], a[216:219], v[168:171]
    global_load_dwordx4 a[120:123], v11, s[44:45] offset:-3072 sc1
    v_mfma_f32_16x16x32_bf16 v[172:175], a[72:75], a[220:223], v[172:175]
    ds_read_b128 a[216:219], v9 offset:25376
    v_mfma_f32_16x16x32_bf16 v[176:179], a[76:79], a[220:223], v[176:179]
    ds_write_b32 v4, v134 offset:29600
    v_mfma_f32_16x16x32_bf16 v[180:183], a[80:83], a[220:223], v[180:183]
    s_waitcnt lgkmcnt(5)
    v_add_u32 v4, 76032, v4
    v_mfma_f32_16x16x32_bf16 v[184:187], a[72:75], a[224:227], v[184:187]
    ds_read_b128 a[220:223], v9 offset:50720
    v_mfma_f32_16x16x32_bf16 v[188:191], a[76:79], a[224:227], v[188:191]
    v_mfma_f32_16x16x32_bf16 v[192:195], a[80:83], a[224:227], v[192:195]
    global_load_dwordx4 a[124:127], v11, s[44:45] offset:-2048 sc1
    v_mfma_f32_16x16x32_bf16 v[196:199], a[72:75], a[228:231], v[196:199]
    ds_read_b128 a[224:227], v10 offset:32
    v_mfma_f32_16x16x32_bf16 v[200:203], a[76:79], a[228:231], v[200:203]
HOP1_55:
    s_cbranch_execz HOP1_56
    v_mfma_f32_16x16x32_bf16 v[204:207], a[80:83], a[228:231], v[204:207]
    s_waitcnt lgkmcnt(6)
    global_load_dwordx4 a[128:131], v11, s[44:45] offset:-1024 sc1
    v_mfma_f32_16x16x32_bf16 v[208:211], a[72:75], a[232:235], v[208:211]
    ds_read_b128 a[228:231], v10 offset:25376
    v_mfma_f32_16x16x32_bf16 v[212:215], a[76:79], a[232:235], v[212:215]
    v_mfma_f32_16x16x32_bf16 v[216:219], a[80:83], a[232:235], v[216:219]
    s_waitcnt vmcnt(9) lgkmcnt(4)
    v_mfma_f32_16x16x32_bf16 v[160:163], a[84:87], a[236:239], v[160:163]
    ds_read_b128 a[232:235], v9 offset:64
    v_mfma_f32_16x16x32_bf16 v[164:167], a[88:91], a[236:239], v[164:167]
    v_mfma_f32_16x16x32_bf16 v[168:171], a[92:95], a[236:239], v[168:171]
    global_load_dwordx4 a[132:135], v11, s[44:45] offset:0 sc1
    v_mfma_f32_16x16x32_bf16 v[172:175], a[84:87], a[216:219], v[172:175]
    ds_read_b128 a[236:239], v9 offset:25408
    v_mfma_f32_16x16x32_bf16 v[176:179], a[88:91], a[216:219], v[176:179]
    v_mfma_f32_16x16x32_bf16 v[180:183], a[92:95], a[216:219], v[180:183]
    s_waitcnt lgkmcnt(3)
    v_mfma_f32_16x16x32_bf16 v[184:187], a[84:87], a[220:223], v[184:187]
    ds_read_b128 a[216:219], v9 offset:50752
    v_mfma_f32_16x16x32_bf16 v[188:191], a[88:91], a[220:223], v[188:191]
    v_mfma_f32_16x16x32_bf16 v[192:195], a[92:95], a[220:223], v[192:195]
    global_load_dwordx4 a[136:139], v11, s[44:45] offset:1024 sc1
    v_mfma_f32_16x16x32_bf16 v[196:199], a[84:87], a[224:227], v[196:199]
    ds_read_b128 a[220:223], v10 offset:64
    v_mfma_f32_16x16x32_bf16 v[200:203], a[88:91], a[224:227], v[200:203]
    v_mfma_f32_16x16x32_bf16 v[204:207], a[92:95], a[224:227], v[204:207]
    s_waitcnt lgkmcnt(4)
    global_load_dwordx4 a[140:143], v11, s[44:45] offset:2048 sc1
    v_mfma_f32_16x16x32_bf16 v[208:211], a[84:87], a[228:231], v[208:211]
    ds_read_b128 a[224:227], v10 offset:25408
    v_mfma_f32_16x16x32_bf16 v[212:215], a[88:91], a[228:231], v[212:215]
    v_mfma_f32_16x16x32_bf16 v[216:219], a[92:95], a[228:231], v[216:219]
    s_waitcnt vmcnt(9) lgkmcnt(3)
    v_add_u32 v9, 4128, v9
    v_mfma_f32_16x16x32_bf16 v[160:163], a[96:99], a[232:235], v[160:163]
HOP1_56:
    s_cbranch_execz HOP1_57
    ds_read_b128 a[228:231], v9 offset:32
    v_mfma_f32_16x16x32_bf16 v[164:167], a[100:103], a[232:235], v[164:167]
    v_add_u32 v11, 6144, v11
    v_mfma_f32_16x16x32_bf16 v[168:171], a[104:107], a[232:235], v[168:171]
    global_load_dwordx4 a[72:75], v11, s[44:45] offset:-3072 sc1
    v_mfma_f32_16x16x32_bf16 v[172:175], a[96:99], a[236:239], v[172:175]
    ds_read_b128 a[232:235], v9 offset:25376
    v_mfma_f32_16x16x32_bf16 v[176:179], a[100:103], a[236:239], v[176:179]
    v_mfma_f32_16x16x32_bf16 v[180:183], a[104:107], a[236:239], v[180:183]
    s_waitcnt lgkmcnt(3)
    v_mfma_f32_16x16x32_bf16 v[184:187], a[96:99], a[216:219], v[184:187]
    ds_read_b128 a[236:239], v9 offset:50720
    v_mfma_f32_16x16x32_bf16 v[188:191], a[100:103], a[216:219], v[188:191]
    v_mfma_f32_16x16x32_bf16 v[192:195], a[104:107], a[216:219], v[192:195]
    v_add_u32 v10, 4128, v10
    v_mfma_f32_16x16x32_bf16 v[196:199], a[96:99], a[220:223], v[196:199]
    ds_read_b128 a[216:219], v10 offset:32
    v_mfma_f32_16x16x32_bf16 v[200:203], a[100:103], a[220:223], v[200:203]
    global_load_dwordx4 a[76:79], v11, s[44:45] offset:-2048 sc1
    v_mfma_f32_16x16x32_bf16 v[204:207], a[104:107], a[220:223], v[204:207]
    s_waitcnt lgkmcnt(4)
    global_load_dwordx4 a[80:83], v11, s[44:45] offset:-1024 sc1
    v_mfma_f32_16x16x32_bf16 v[208:211], a[96:99], a[224:227], v[208:211]
    ds_read_b128 a[220:223], v10 offset:25376
    v_mfma_f32_16x16x32_bf16 v[212:215], a[100:103], a[224:227], v[212:215]
    v_mfma_f32_16x16x32_bf16 v[216:219], a[104:107], a[224:227], v[216:219]
    s_waitcnt vmcnt(6) lgkmcnt(1)
    v_mfma_f32_16x16x32_bf16 v[16:19], a[108:111], a[228:231], 0
    ds_read_b128 a[224:227], v10 offset:50720
    v_mfma_f32_16x16x32_bf16 v[20:23], a[112:115], a[228:231], 0
    ds_write_b64 v14, v[162:163] offset:0
    v_mfma_f32_16x16x32_bf16 v[24:27], a[116:119], a[228:231], 0
HOP1_57:
    s_cbranch_execz HOP1_58
    global_load_dwordx4 a[84:87], v11, s[44:45] offset:0 sc1
    v_mfma_f32_16x16x32_bf16 v[28:31], a[108:111], a[232:235], 0
    ds_read_b128 a[228:231], v9 offset:64
    v_mfma_f32_16x16x32_bf16 v[32:35], a[112:115], a[232:235], 0
    ds_write_b64 v14, v[166:167] offset:512
    v_mfma_f32_16x16x32_bf16 v[36:39], a[116:119], a[232:235], 0
    ds_write_b64 v14, v[170:171] offset:1024
    v_mfma_f32_16x16x32_bf16 v[16:19], a[120:123], a[232:235], v[16:19]
    global_load_dwordx4 a[88:91], v11, s[44:45] offset:1024 sc1
    v_mfma_f32_16x16x32_bf16 v[20:23], a[124:127], a[232:235], v[20:23]
    ds_write_b64 v14, v[174:175] offset:1536
    v_mfma_f32_16x16x32_bf16 v[24:27], a[128:131], a[232:235], v[24:27]
    ds_write_b64 v14, v[178:179] offset:2048
    v_mfma_f32_16x16x32_bf16 v[40:43], a[108:111], a[236:239], 0
    ds_read_b128 a[232:235], v9 offset:25408
    v_mfma_f32_16x16x32_bf16 v[44:47], a[112:115], a[236:239], 0
    ds_write_b64 v14, v[182:183] offset:2560
    v_mfma_f32_16x16x32_bf16 v[48:51], a[116:119], a[236:239], 0
    ds_write_b64 v14, v[186:187] offset:3072
    v_mfma_f32_16x16x32_bf16 v[28:31], a[120:123], a[236:239], v[28:31]
    global_load_dwordx4 a[92:95], v11, s[44:45] offset:2048 sc1
    v_mfma_f32_16x16x32_bf16 v[32:35], a[124:127], a[236:239], v[32:35]
    ds_write_b64 v14, v[190:191] offset:3584
    v_mfma_f32_16x16x32_bf16 v[36:39], a[128:131], a[236:239], v[36:39]
    ds_write_b64 v14, v[194:195] offset:25344
    v_mfma_f32_16x16x32_bf16 v[52:55], a[108:111], a[216:219], 0
    ds_read_b128 a[236:239], v9 offset:50752
    v_mfma_f32_16x16x32_bf16 v[56:59], a[112:115], a[216:219], 0
    ds_write_b64 v14, v[198:199] offset:25856
    v_mfma_f32_16x16x32_bf16 v[60:63], a[116:119], a[216:219], 0
    v_add_u32 v11, 6144, v11
    v_mfma_f32_16x16x32_bf16 v[40:43], a[120:123], a[216:219], v[40:43]
HOP1_58:
    s_cbranch_execz HOP1_59
    global_load_dwordx4 a[96:99], v11, s[44:45] offset:-3072 sc1
    v_mfma_f32_16x16x32_bf16 v[44:47], a[124:127], a[216:219], v[44:47]
    ds_write_b64 v14, v[202:203] offset:26368
    v_mfma_f32_16x16x32_bf16 v[48:51], a[128:131], a[216:219], v[48:51]
    s_waitcnt lgkmcnt(14)
    ds_write_b64 v14, v[206:207] offset:26880
    v_mfma_f32_16x16x32_bf16 v[64:67], a[108:111], a[220:223], 0
    ds_read_b128 a[216:219], v10 offset:64
    v_mfma_f32_16x16x32_bf16 v[68:71], a[112:115], a[220:223], 0
    ds_write_b64 v14, v[210:211] offset:27392
    v_mfma_f32_16x16x32_bf16 v[72:75], a[116:119], a[220:223], 0
    ds_write_b64 v14, v[214:215] offset:27904
    v_mfma_f32_16x16x32_bf16 v[52:55], a[120:123], a[220:223], v[52:55]
    global_load_dwordx4 a[100:103], v11, s[44:45] offset:-2048 sc1
    v_mfma_f32_16x16x32_bf16 v[56:59], a[124:127], a[220:223], v[56:59]
    ds_write_b64 v14, v[218:219] offset:28416
    v_mfma_f32_16x16x32_bf16 v[60:63], a[128:131], a[220:223], v[60:63]
    v_mfma_f32_16x16x32_bf16 v[64:67], a[120:123], a[224:227], v[64:67]
    ds_read_b128 a[220:223], v10 offset:25408
    v_mfma_f32_16x16x32_bf16 v[68:71], a[124:127], a[224:227], v[68:71]
    global_load_dwordx4 a[104:107], v11, s[44:45] offset:-1024 sc1
    v_mfma_f32_16x16x32_bf16 v[72:75], a[128:131], a[224:227], v[72:75]
    s_waitcnt vmcnt(6) lgkmcnt(1)
    v_mfma_f32_16x16x32_bf16 v[16:19], a[132:135], a[228:231], v[16:19]
    s_barrier
    ds_read_b128 a[224:227], v10 offset:50752
    v_mfma_f32_16x16x32_bf16 v[20:23], a[136:139], a[228:231], v[20:23]
    ds_read_b128 v[106:109], v5 offset:0
    ds_read_b128 v[110:113], v5 offset:25344
    v_mfma_f32_16x16x32_bf16 v[24:27], a[140:143], a[228:231], v[24:27]
    ds_read_b128 v[114:117], v5 offset:50688
    v_add_u32 v9, 96, v9
    v_mfma_f32_16x16x32_bf16 v[28:31], a[132:135], a[232:235], v[28:31]
HOP1_59:
    s_cbranch_execz HOP1_60
    ds_read_b128 a[228:231], v9 offset:0
    ds_read_b128 v[118:121], v5 offset:4224
    v_mfma_f32_16x16x32_bf16 v[32:35], a[136:139], a[232:235], v[32:35]
    global_load_dwordx4 a[108:111], v11, s[44:45] offset:0 sc1
    v_mfma_f32_16x16x32_bf16 v[36:39], a[140:143], a[232:235], v[36:39]
    ds_read_b128 v[122:125], v5 offset:29568
    v_add_u32 v5, 76032, v5
    v_mfma_f32_16x16x32_bf16 v[16:19], a[72:75], a[232:235], v[16:19]
    s_mov_b32 s56, 43008
    global_load_dwordx4 a[112:115], v11, s[44:45] offset:1024 sc1
    v_mfma_f32_16x16x32_bf16 v[20:23], a[76:79], a[232:235], v[20:23]
    v_add_f32 v76, v76, v160
    v_add_f32 v77, v77, v161
    v_mfma_f32_16x16x32_bf16 v[24:27], a[80:83], a[232:235], v[24:27]
    v_cvt_pk_bf16_f32 v76, v76, v77
    v_mfma_f32_16x16x32_bf16 v[40:43], a[132:135], a[236:239], v[40:43]
    ds_read_b128 a[232:235], v9 offset:25344
    v_mfma_f32_16x16x32_bf16 v[44:47], a[136:139], a[236:239], v[44:47]
    ds_write_b32 v4, v76 offset:0
    v_mfma_f32_16x16x32_bf16 v[48:51], a[140:143], a[236:239], v[48:51]
    v_add_f32 v78, v78, v164
    v_add_f32 v79, v79, v165
    v_mfma_f32_16x16x32_bf16 v[28:31], a[72:75], a[236:239], v[28:31]
    global_load_dwordx4 a[116:119], v11, s[44:45] offset:2048 sc1
    v_mfma_f32_16x16x32_bf16 v[32:35], a[76:79], a[236:239], v[32:35]
    v_cvt_pk_bf16_f32 v78, v78, v79
    v_mfma_f32_16x16x32_bf16 v[36:39], a[80:83], a[236:239], v[36:39]
    ds_write_b32 v4, v78 offset:16
    v_mfma_f32_16x16x32_bf16 v[52:55], a[132:135], a[216:219], v[52:55]
    ds_read_b128 a[236:239], v9 offset:50688
    v_add_f32 v80, v80, v168
    v_mfma_f32_16x16x32_bf16 v[56:59], a[136:139], a[216:219], v[56:59]
    v_add_f32 v81, v81, v169
    v_cvt_pk_bf16_f32 v80, v80, v81
    v_mfma_f32_16x16x32_bf16 v[60:63], a[140:143], a[216:219], v[60:63]
HOP1_60:
    s_cbranch_execz HOP1_61
    v_add_u32 v11, 6144, v11
    v_mfma_f32_16x16x32_bf16 v[40:43], a[72:75], a[216:219], v[40:43]
    global_load_dwordx4 a[120:123], v11, s[44:45] offset:-3072 sc1
    v_mfma_f32_16x16x32_bf16 v[44:47], a[76:79], a[216:219], v[44:47]
    ds_write_b32 v4, v80 offset:32
    v_mfma_f32_16x16x32_bf16 v[48:51], a[80:83], a[216:219], v[48:51]
    s_waitcnt lgkmcnt(11)
    v_add_u32 v10, 96, v10
    v_add_f32 v82, v82, v172
    v_mfma_f32_16x16x32_bf16 v[64:67], a[132:135], a[220:223], v[64:67]
    ds_read_b128 a[216:219], v10 offset:0
    v_add_f32 v83, v83, v173
    v_mfma_f32_16x16x32_bf16 v[68:71], a[136:139], a[220:223], v[68:71]
    v_cvt_pk_bf16_f32 v82, v82, v83
    v_mfma_f32_16x16x32_bf16 v[72:75], a[140:143], a[220:223], v[72:75]
    ds_write_b32 v4, v82 offset:4224
    v_mfma_f32_16x16x32_bf16 v[52:55], a[72:75], a[220:223], v[52:55]
    global_load_dwordx4 a[124:127], v11, s[44:45] offset:-2048 sc1
    v_mfma_f32_16x16x32_bf16 v[56:59], a[76:79], a[220:223], v[56:59]
    v_add_f32 v84, v84, v176
    v_add_f32 v85, v85, v177
    v_mfma_f32_16x16x32_bf16 v[60:63], a[80:83], a[220:223], v[60:63]
    v_cvt_pk_bf16_f32 v84, v84, v85
    v_mfma_f32_16x16x32_bf16 v[64:67], a[72:75], a[224:227], v[64:67]
    ds_read_b128 a[220:223], v10 offset:25344
    v_mfma_f32_16x16x32_bf16 v[68:71], a[76:79], a[224:227], v[68:71]
    global_load_dwordx4 a[128:131], v11, s[44:45] offset:-1024 sc1
    v_mfma_f32_16x16x32_bf16 v[72:75], a[80:83], a[224:227], v[72:75]
    s_waitcnt vmcnt(6) lgkmcnt(2)
    ds_write_b32 v4, v84 offset:4240
    v_mfma_f32_16x16x32_bf16 v[16:19], a[84:87], a[228:231], v[16:19]
    ds_read_b128 a[224:227], v10 offset:50688
    v_add_f32 v86, v86, v180
    v_mfma_f32_16x16x32_bf16 v[20:23], a[88:91], a[228:231], v[20:23]
HOP1_61:
    s_cbranch_execz HOP1_62
    v_add_f32 v87, v87, v181
    v_cvt_pk_bf16_f32 v86, v86, v87
    v_mfma_f32_16x16x32_bf16 v[24:27], a[92:95], a[228:231], v[24:27]
    global_load_dwordx4 a[132:135], v11, s[44:45] offset:0 sc1
    v_mfma_f32_16x16x32_bf16 v[28:31], a[84:87], a[232:235], v[28:31]
    ds_read_b128 a[228:231], v9 offset:32
    v_mfma_f32_16x16x32_bf16 v[32:35], a[88:91], a[232:235], v[32:35]
    ds_write_b32 v4, v86 offset:4256
    v_mfma_f32_16x16x32_bf16 v[36:39], a[92:95], a[232:235], v[36:39]
    v_add_f32 v88, v88, v184
    v_add_f32 v89, v89, v185
    v_mfma_f32_16x16x32_bf16 v[16:19], a[96:99], a[232:235], v[16:19]
    global_load_dwordx4 a[136:139], v11, s[44:45] offset:1024 sc1
    v_mfma_f32_16x16x32_bf16 v[20:23], a[100:103], a[232:235], v[20:23]
    v_cvt_pk_bf16_f32 v88, v88, v89
    v_mfma_f32_16x16x32_bf16 v[24:27], a[104:107], a[232:235], v[24:27]
    ds_write_b32 v4, v88 offset:33792
    v_mfma_f32_16x16x32_bf16 v[40:43], a[84:87], a[236:239], v[40:43]
    ds_read_b128 a[232:235], v9 offset:25376
    v_add_f32 v90, v90, v188
    v_mfma_f32_16x16x32_bf16 v[44:47], a[88:91], a[236:239], v[44:47]
    v_add_f32 v91, v91, v189
    v_cvt_pk_bf16_f32 v90, v90, v91
    v_mfma_f32_16x16x32_bf16 v[48:51], a[92:95], a[236:239], v[48:51]
    ds_write_b32 v4, v90 offset:33808
    v_mfma_f32_16x16x32_bf16 v[28:31], a[96:99], a[236:239], v[28:31]
    global_load_dwordx4 a[140:143], v11, s[44:45] offset:2048 sc1
    v_mfma_f32_16x16x32_bf16 v[32:35], a[100:103], a[236:239], v[32:35]
    v_add_f32 v92, v92, v192
    v_add_f32 v93, v93, v193
    v_mfma_f32_16x16x32_bf16 v[36:39], a[104:107], a[236:239], v[36:39]
    v_cvt_pk_bf16_f32 v92, v92, v93
    v_mfma_f32_16x16x32_bf16 v[52:55], a[84:87], a[216:219], v[52:55]
    ds_read_b128 a[236:239], v9 offset:50720
    v_mfma_f32_16x16x32_bf16 v[56:59], a[88:91], a[216:219], v[56:59]
HOP1_62:
    s_cbranch_execz HOP1_63
    ds_write_b32 v4, v92 offset:33824
    v_mfma_f32_16x16x32_bf16 v[60:63], a[92:95], a[216:219], v[60:63]
    v_add_u32 v11, 6144, v11
    v_add_f32 v94, v94, v196
    v_mfma_f32_16x16x32_bf16 v[40:43], a[96:99], a[216:219], v[40:43]
    global_load_dwordx4 a[72:75], v11, s[44:45] offset:-3072 sc1
    v_mfma_f32_16x16x32_bf16 v[44:47], a[100:103], a[216:219], v[44:47]
    v_add_f32 v95, v95, v197
    v_cvt_pk_bf16_f32 v94, v94, v95
    v_mfma_f32_16x16x32_bf16 v[48:51], a[104:107], a[216:219], v[48:51]
    s_waitcnt lgkmcnt(7)
    ds_write_b32 v4, v94 offset:38016
    v_mfma_f32_16x16x32_bf16 v[64:67], a[84:87], a[220:223], v[64:67]
    ds_read_b128 a[216:219], v10 offset:32
    v_add_f32 v96, v96, v200
    v_mfma_f32_16x16x32_bf16 v[68:71], a[88:91], a[220:223], v[68:71]
    v_add_f32 v97, v97, v201
    v_cvt_pk_bf16_f32 v96, v96, v97
    v_mfma_f32_16x16x32_bf16 v[72:75], a[92:95], a[220:223], v[72:75]
    ds_write_b32 v4, v96 offset:38032
    v_mfma_f32_16x16x32_bf16 v[52:55], a[96:99], a[220:223], v[52:55]
    global_load_dwordx4 a[76:79], v11, s[44:45] offset:-2048 sc1
    v_mfma_f32_16x16x32_bf16 v[56:59], a[100:103], a[220:223], v[56:59]
    v_add_f32 v98, v98, v204
    v_add_f32 v99, v99, v205
    v_mfma_f32_16x16x32_bf16 v[60:63], a[104:107], a[220:223], v[60:63]
    v_cvt_pk_bf16_f32 v98, v98, v99
    v_mfma_f32_16x16x32_bf16 v[64:67], a[96:99], a[224:227], v[64:67]
    ds_read_b128 a[220:223], v10 offset:25376
    v_mfma_f32_16x16x32_bf16 v[68:71], a[100:103], a[224:227], v[68:71]
    global_load_dwordx4 a[80:83], v11, s[44:45] offset:-1024 sc1
    v_mfma_f32_16x16x32_bf16 v[72:75], a[104:107], a[224:227], v[72:75]
    s_waitcnt vmcnt(6) lgkmcnt(2)
    ds_write_b32 v4, v98 offset:38048
    v_mfma_f32_16x16x32_bf16 v[16:19], a[108:111], a[228:231], v[16:19]
HOP1_63:
    s_cbranch_execz HOP1_64
    ds_read_b128 a[224:227], v10 offset:50720
    v_add_f32 v100, v100, v208
    v_mfma_f32_16x16x32_bf16 v[20:23], a[112:115], a[228:231], v[20:23]
    buffer_store_dwordx4 v[106:109], v15, s[36:39], s56 offen sc1
    v_mfma_f32_16x16x32_bf16 v[24:27], a[116:119], a[228:231], v[24:27]
    s_mov_b32 s56, 172032
    v_add_f32 v101, v101, v209
    v_cvt_pk_bf16_f32 v100, v100, v101
    v_mfma_f32_16x16x32_bf16 v[28:31], a[108:111], a[232:235], v[28:31]
    ds_read_b128 a[228:231], v9 offset:64
    v_mfma_f32_16x16x32_bf16 v[32:35], a[112:115], a[232:235], v[32:35]
    ds_write_b32 v4, v100 offset:59136
    v_mfma_f32_16x16x32_bf16 v[36:39], a[116:119], a[232:235], v[36:39]
    buffer_store_dwordx4 v[110:113], v15, s[36:39], s56 offen sc1
    v_mfma_f32_16x16x32_bf16 v[16:19], a[120:123], a[232:235], v[16:19]
    s_mov_b32 s56, 301056
    v_add_f32 v102, v102, v212
    v_add_f32 v103, v103, v213
    v_mfma_f32_16x16x32_bf16 v[20:23], a[124:127], a[232:235], v[20:23]
    v_cvt_pk_bf16_f32 v102, v102, v103
    v_mfma_f32_16x16x32_bf16 v[24:27], a[128:131], a[232:235], v[24:27]
    ds_write_b32 v4, v102 offset:59152
    v_mfma_f32_16x16x32_bf16 v[40:43], a[108:111], a[236:239], v[40:43]
    ds_read_b128 a[232:235], v9 offset:25408
    v_add_f32 v104, v104, v216
    v_mfma_f32_16x16x32_bf16 v[44:47], a[112:115], a[236:239], v[44:47]
    buffer_store_dwordx4 v[114:117], v15, s[36:39], s56 offen sc1
    v_mfma_f32_16x16x32_bf16 v[48:51], a[116:119], a[236:239], v[48:51]
    s_mov_b32 s56, 430080
    v_add_f32 v105, v105, v217
    v_cvt_pk_bf16_f32 v104, v104, v105
    v_mfma_f32_16x16x32_bf16 v[28:31], a[120:123], a[236:239], v[28:31]
    ds_write_b32 v4, v104 offset:59168
    v_mfma_f32_16x16x32_bf16 v[32:35], a[124:127], a[236:239], v[32:35]
HOP1_64:
    s_cbranch_execz HOP1_65
    v_mfma_f32_16x16x32_bf16 v[36:39], a[128:131], a[236:239], v[36:39]
    buffer_store_dwordx4 v[118:121], v15, s[36:39], s56 offen sc1
    v_mfma_f32_16x16x32_bf16 v[52:55], a[108:111], a[216:219], v[52:55]
    s_mov_b32 s56, 559104
    ds_read_b128 a[236:239], v9 offset:50752
    v_mfma_f32_16x16x32_bf16 v[56:59], a[112:115], a[216:219], v[56:59]
    v_mfma_f32_16x16x32_bf16 v[60:63], a[116:119], a[216:219], v[60:63]
    v_mfma_f32_16x16x32_bf16 v[40:43], a[120:123], a[216:219], v[40:43]
    buffer_store_dwordx4 v[122:125], v15, s[36:39], s56 offen sc1
    v_mfma_f32_16x16x32_bf16 v[44:47], a[124:127], a[216:219], v[44:47]
    v_mfma_f32_16x16x32_bf16 v[48:51], a[128:131], a[216:219], v[48:51]
    s_waitcnt lgkmcnt(6)
    v_mfma_f32_16x16x32_bf16 v[64:67], a[108:111], a[220:223], v[64:67]
    ds_read_b128 a[216:219], v10 offset:64
    v_mfma_f32_16x16x32_bf16 v[68:71], a[112:115], a[220:223], v[68:71]
    s_waitcnt lgkmcnt(2)
    v_mfma_f32_16x16x32_bf16 v[72:75], a[116:119], a[220:223], v[72:75]
    s_barrier
    v_subrev_u32 v4, 76032, v4
    v_mfma_f32_16x16x32_bf16 v[52:55], a[120:123], a[220:223], v[52:55]
    ds_read_b128 v[160:163], v5 offset:0
    ds_read_b128 v[164:167], v5 offset:4224
    v_mfma_f32_16x16x32_bf16 v[56:59], a[124:127], a[220:223], v[56:59]
    ds_read_b128 v[168:171], v5 offset:33792
    ds_read_b128 v[172:175], v5 offset:38016
    v_mfma_f32_16x16x32_bf16 v[60:63], a[128:131], a[220:223], v[60:63]
    ds_read_b128 v[176:179], v5 offset:59136
    v_subrev_u32 v5, 76032, v5
    v_mfma_f32_16x16x32_bf16 v[64:67], a[120:123], a[224:227], v[64:67]
    s_mov_b32 s55, 0
    ds_read_b128 a[220:223], v10 offset:25408
    v_mfma_f32_16x16x32_bf16 v[68:71], a[124:127], a[224:227], v[68:71]
    v_mfma_f32_16x16x32_bf16 v[72:75], a[128:131], a[224:227], v[72:75]
    s_waitcnt vmcnt(5) lgkmcnt(6)
    v_mfma_f32_16x16x32_bf16 v[16:19], a[132:135], a[228:231], v[16:19]
HOP1_65:
    s_cbranch_execz HOP1_66
    ds_read_b128 a[224:227], v10 offset:50752
    v_mfma_f32_16x16x32_bf16 v[20:23], a[136:139], a[228:231], v[20:23]
    s_waitcnt lgkmcnt(6)
    v_mfma_f32_16x16x32_bf16 v[24:27], a[140:143], a[228:231], v[24:27]
    buffer_store_dwordx4 v[160:163], v15, s[36:39], s55 offen sc1
    v_mfma_f32_16x16x32_bf16 v[28:31], a[132:135], a[232:235], v[28:31]
    s_mov_b32 s55, 129024
    v_mfma_f32_16x16x32_bf16 v[32:35], a[136:139], a[232:235], v[32:35]
    v_mfma_f32_16x16x32_bf16 v[36:39], a[140:143], a[232:235], v[36:39]
    s_waitcnt lgkmcnt(5)
    v_mfma_f32_16x16x32_bf16 v[16:19], a[72:75], a[232:235], v[16:19]
    buffer_store_dwordx4 v[164:167], v15, s[36:39], s55 offen sc1
    v_mfma_f32_16x16x32_bf16 v[20:23], a[76:79], a[232:235], v[20:23]
    s_mov_b32 s55, 258048
    v_mfma_f32_16x16x32_bf16 v[24:27], a[80:83], a[232:235], v[24:27]
    v_mfma_f32_16x16x32_bf16 v[40:43], a[132:135], a[236:239], v[40:43]
    s_waitcnt lgkmcnt(4)
    v_mfma_f32_16x16x32_bf16 v[44:47], a[136:139], a[236:239], v[44:47]
    buffer_store_dwordx4 v[168:171], v15, s[36:39], s55 offen sc1
    v_mfma_f32_16x16x32_bf16 v[48:51], a[140:143], a[236:239], v[48:51]
    s_mov_b32 s55, 387072
    v_mfma_f32_16x16x32_bf16 v[28:31], a[72:75], a[236:239], v[28:31]
    v_mfma_f32_16x16x32_bf16 v[32:35], a[76:79], a[236:239], v[32:35]
    s_waitcnt lgkmcnt(3)
    v_mfma_f32_16x16x32_bf16 v[36:39], a[80:83], a[236:239], v[36:39]
    buffer_store_dwordx4 v[172:175], v15, s[36:39], s55 offen sc1
    v_mfma_f32_16x16x32_bf16 v[52:55], a[132:135], a[216:219], v[52:55]
    s_mov_b32 s55, 516096
    ds_write_b64 v12, v[18:19] offset:8448
    v_mfma_f32_16x16x32_bf16 v[56:59], a[136:139], a[216:219], v[56:59]
    ds_write_b64 v12, v[22:23] offset:8960
    v_mfma_f32_16x16x32_bf16 v[60:63], a[140:143], a[216:219], v[60:63]
    s_waitcnt lgkmcnt(4)
    ds_write_b64 v12, v[26:27] offset:9472
    v_mfma_f32_16x16x32_bf16 v[40:43], a[72:75], a[216:219], v[40:43]
    buffer_store_dwordx4 v[176:179], v15, s[36:39], s55 offen sc1
    v_mfma_f32_16x16x32_bf16 v[44:47], a[76:79], a[216:219], v[44:47]
HOP1_66:
    s_cbranch_execz HOP1_67
    v_mfma_f32_16x16x32_bf16 v[48:51], a[80:83], a[216:219], v[48:51]
    s_waitcnt lgkmcnt(3)
    ds_write_b64 v12, v[30:31] offset:9984
    v_mfma_f32_16x16x32_bf16 v[64:67], a[132:135], a[220:223], v[64:67]
    ds_write_b64 v12, v[34:35] offset:10496
    v_mfma_f32_16x16x32_bf16 v[68:71], a[136:139], a[220:223], v[68:71]
    ds_write_b64 v12, v[38:39] offset:11008
    v_mfma_f32_16x16x32_bf16 v[72:75], a[140:143], a[220:223], v[72:75]
    v_mfma_f32_16x16x32_bf16 v[52:55], a[72:75], a[220:223], v[52:55]
    v_mfma_f32_16x16x32_bf16 v[56:59], a[76:79], a[220:223], v[56:59]
    v_mfma_f32_16x16x32_bf16 v[60:63], a[80:83], a[220:223], v[60:63]
    ds_write_b64 v12, v[42:43] offset:11520
    v_mfma_f32_16x16x32_bf16 v[64:67], a[72:75], a[224:227], v[64:67]
    ds_write_b64 v12, v[46:47] offset:12032
    v_mfma_f32_16x16x32_bf16 v[68:71], a[76:79], a[224:227], v[68:71]
    ds_write_b64 v12, v[50:51] offset:33792
    v_mfma_f32_16x16x32_bf16 v[72:75], a[80:83], a[224:227], v[72:75]
    v_pk_add_f32 v[136:137], v[136:137], v[16:17]
    v_pk_add_f32 v[138:139], v[138:139], v[20:21]
    v_pk_add_f32 v[140:141], v[140:141], v[24:25]
    ds_write_b64 v12, v[54:55] offset:34304
    ds_write_b64 v12, v[58:59] offset:34816
    ds_write_b64 v12, v[62:63] offset:35328
    ds_write_b64 v12, v[66:67] offset:35840
    ds_write_b64 v12, v[70:71] offset:36352
    ds_write_b64 v12, v[74:75] offset:36864
    v_pk_add_f32 v[142:143], v[142:143], v[28:29]
    v_pk_add_f32 v[144:145], v[144:145], v[32:33]
HOP1_67:
    s_cbranch_execz HOP1_68
    s_nop 0
    v_pk_add_f32 v[146:147], v[146:147], v[36:37]
    v_pk_add_f32 v[148:149], v[148:149], v[40:41]
    v_pk_add_f32 v[150:151], v[150:151], v[44:45]
    v_pk_add_f32 v[152:153], v[152:153], v[48:49]
    v_pk_add_f32 v[154:155], v[154:155], v[52:53]
    v_pk_add_f32 v[156:157], v[156:157], v[56:57]
    v_pk_add_f32 v[158:159], v[158:159], v[60:61]
    v_pk_add_f32 v[220:221], v[220:221], v[64:65]
    v_pk_add_f32 v[222:223], v[222:223], v[68:69]
    v_pk_add_f32 v[224:225], v[224:225], v[72:73]
    s_waitcnt lgkmcnt(0)
    s_barrier
    ds_read_b64 v[226:227], v13 offset:8448
    ds_read_b64 v[228:229], v13 offset:8960
    ds_read_b64 v[230:231], v13 offset:9472
    ds_read_b64 v[232:233], v13 offset:9984
    ds_read_b64 v[234:235], v13 offset:10496
    ds_read_b64 v[236:237], v13 offset:11008
    ds_read_b64 v[238:239], v13 offset:11520
    ds_read_b64 v[240:241], v13 offset:12032
    ds_read_b64 v[242:243], v13 offset:33792
    ds_read_b64 v[244:245], v13 offset:34304
    ds_read_b64 v[246:247], v13 offset:34816
    ds_read_b64 v[248:249], v13 offset:35328
    ds_read_b64 v[250:251], v13 offset:35840
    ds_read_b64 v[252:253], v13 offset:36352
    ds_read_b64 v[254:255], v13 offset:36864
    s_waitcnt lgkmcnt(12)
    v_pk_add_f32 v[136:137], v[136:137], v[226:227]
    v_cvt_pk_bf16_f32 v136, v136, v137
    v_pk_add_f32 v[138:139], v[138:139], v[228:229]
    v_cvt_pk_bf16_f32 v138, v138, v139
    v_pk_add_f32 v[140:141], v[140:141], v[230:231]
HOP1_68:
    s_cbranch_execz HOP1_69
    v_cvt_pk_bf16_f32 v140, v140, v141
    ds_write_b32 v4, v136 offset:0
    ds_write_b32 v4, v138 offset:16
    ds_write_b32 v4, v140 offset:32
    s_waitcnt lgkmcnt(12)
    v_pk_add_f32 v[142:143], v[142:143], v[232:233]
    v_cvt_pk_bf16_f32 v142, v142, v143
    v_pk_add_f32 v[144:145], v[144:145], v[234:235]
    v_cvt_pk_bf16_f32 v144, v144, v145
    v_pk_add_f32 v[146:147], v[146:147], v[236:237]
    v_cvt_pk_bf16_f32 v146, v146, v147
    ds_write_b32 v4, v142 offset:25344
    ds_write_b32 v4, v144 offset:25360
    ds_write_b32 v4, v146 offset:25376
    s_waitcnt lgkmcnt(12)
    v_pk_add_f32 v[148:149], v[148:149], v[238:239]
    v_cvt_pk_bf16_f32 v148, v148, v149
    v_pk_add_f32 v[150:151], v[150:151], v[240:241]
    v_cvt_pk_bf16_f32 v150, v150, v151
    v_pk_add_f32 v[152:153], v[152:153], v[242:243]
    v_cvt_pk_bf16_f32 v152, v152, v153
    ds_write_b32 v4, v148 offset:50688
    ds_write_b32 v4, v150 offset:50704
    ds_write_b32 v4, v152 offset:50720
    s_waitcnt lgkmcnt(12)
    v_pk_add_f32 v[154:155], v[154:155], v[244:245]
    v_cvt_pk_bf16_f32 v154, v154, v155
    v_pk_add_f32 v[156:157], v[156:157], v[246:247]
    v_cvt_pk_bf16_f32 v156, v156, v157
    v_pk_add_f32 v[158:159], v[158:159], v[248:249]
    v_cvt_pk_bf16_f32 v158, v158, v159
    ds_write_b32 v4, v154 offset:4224
    ds_write_b32 v4, v156 offset:4240
HOP1_69:
    s_cbranch_execz HOPRET1
    ds_write_b32 v4, v158 offset:4256
    s_waitcnt lgkmcnt(12)
    v_pk_add_f32 v[220:221], v[220:221], v[250:251]
    v_cvt_pk_bf16_f32 v220, v220, v221
    v_pk_add_f32 v[222:223], v[222:223], v[252:253]
    v_cvt_pk_bf16_f32 v222, v222, v223
    v_pk_add_f32 v[224:225], v[224:225], v[254:255]
    v_cvt_pk_bf16_f32 v224, v224, v225
    ds_write_b32 v4, v220 offset:29568
    ds_write_b32 v4, v222 offset:29584
    ds_write_b32 v4, v224 offset:29600
    s_waitcnt lgkmcnt(0)
    s_barrier
    ds_read_b128 v[76:79], v5 offset:0
    ds_read_b128 v[80:83], v5 offset:25344
    ds_read_b128 v[84:87], v5 offset:50688
    ds_read_b128 v[88:91], v5 offset:4224
    ds_read_b128 v[92:95], v5 offset:29568
    s_mov_b32 s54, 86016
    s_waitcnt lgkmcnt(4)
    buffer_store_dwordx4 v[76:79], v15, s[36:39], s54 offen sc1
    s_mov_b32 s54, 215040
    s_waitcnt lgkmcnt(3)
    buffer_store_dwordx4 v[80:83], v15, s[36:39], s54 offen sc1
    s_mov_b32 s54, 344064
    s_waitcnt lgkmcnt(2)
    buffer_store_dwordx4 v[84:87], v15, s[36:39], s54 offen sc1
    s_mov_b32 s54, 473088
    s_waitcnt lgkmcnt(1)
    buffer_store_dwordx4 v[88:91], v15, s[36:39], s54 offen sc1
    v_add_u32 v15, 602112, v15
    s_waitcnt lgkmcnt(0)
    buffer_store_dwordx4 v[92:95], v15, s[36:39], 0 offen sc1
    s_endpgm
.p2align 8
L_P3B:
    s_waitcnt vmcnt(6) lgkmcnt(1)
    v_mfma_f32_16x16x32_bf16 v[160:163], a[72:75], a[216:219], 0
    s_barrier
    ds_read_b128 a[236:239], v10 offset:50688
    v_mfma_f32_16x16x32_bf16 v[164:167], a[76:79], a[216:219], 0
HOP1_1:
    s_cbranch_execz HOP1_2
    v_add_u32 v11, 6144, v11
    v_mfma_f32_16x16x32_bf16 v[168:171], a[80:83], a[216:219], 0
    global_load_dwordx4 a[120:123], v11, s[44:45] offset:-3072 sc1
    v_mfma_f32_16x16x32_bf16 v[172:175], a[72:75], a[220:223], 0
    ds_read_b128 a[216:219], v9 offset:32
    v_mfma_f32_16x16x32_bf16 v[176:179], a[76:79], a[220:223], 0
    ds_write_b32 v12, v18 offset:8448
    v_mfma_f32_16x16x32_bf16 v[180:183], a[80:83], a[220:223], 0
    ds_write_b32 v12, v19 offset:8452
    v_mfma_f32_16x16x32_bf16 v[160:163], a[84:87], a[220:223], v[160:163]
    global_load_dwordx4 a[124:127], v11, s[44:45] offset:-2048 sc1
    v_mfma_f32_16x16x32_bf16 v[164:167], a[88:91], a[220:223], v[164:167]
    ds_write_b32 v12, v22 offset:8960
    v_mfma_f32_16x16x32_bf16 v[168:171], a[92:95], a[220:223], v[168:171]
    ds_write_b32 v12, v23 offset:8964
    v_mfma_f32_16x16x32_bf16 v[184:187], a[72:75], a[224:227], 0
    ds_read_b128 a[220:223], v9 offset:25376
    v_mfma_f32_16x16x32_bf16 v[188:191], a[76:79], a[224:227], 0
    ds_write_b32 v12, v26 offset:9472
    v_mfma_f32_16x16x32_bf16 v[192:195], a[80:83], a[224:227], 0
    ds_write_b32 v12, v27 offset:9476
    v_mfma_f32_16x16x32_bf16 v[172:175], a[84:87], a[224:227], v[172:175]
    global_load_dwordx4 a[128:131], v11, s[44:45] offset:-1024 sc1
    v_mfma_f32_16x16x32_bf16 v[176:179], a[88:91], a[224:227], v[176:179]
    ds_write_b32 v12, v30 offset:9984
    v_mfma_f32_16x16x32_bf16 v[180:183], a[92:95], a[224:227], v[180:183]
    ds_write_b32 v12, v31 offset:9988
    v_mfma_f32_16x16x32_bf16 v[196:199], a[72:75], a[228:231], 0
HOP1_2:
    s_cbranch_execz HOP1_3
    ds_read_b128 a[224:227], v9 offset:50720
    v_mfma_f32_16x16x32_bf16 v[200:203], a[76:79], a[228:231], 0
    ds_write_b32 v12, v34 offset:10496
    v_mfma_f32_16x16x32_bf16 v[204:207], a[80:83], a[228:231], 0
    ds_write_b32 v12, v35 offset:10500
    v_mfma_f32_16x16x32_bf16 v[184:187], a[84:87], a[228:231], v[184:187]
    global_load_dwordx4 a[132:135], v11, s[44:45] offset:0 sc1
    v_mfma_f32_16x16x32_bf16 v[188:191], a[88:91], a[228:231], v[188:191]
    ds_write_b32 v12, v38 offset:11008
    v_mfma_f32_16x16x32_bf16 v[192:195], a[92:95], a[228:231], v[192:195]
    s_waitcnt lgkmcnt(14)
    ds_write_b32 v12, v39 offset:11012
    v_mfma_f32_16x16x32_bf16 v[208:211], a[72:75], a[232:235], 0
    ds_read_b128 a[228:231], v10 offset:32
    v_mfma_f32_16x16x32_bf16 v[212:215], a[76:79], a[232:235], 0
    ds_write_b32 v12, v42 offset:11520
    v_mfma_f32_16x16x32_bf16 v[216:219], a[80:83], a[232:235], 0
    ds_write_b32 v12, v43 offset:11524
    v_mfma_f32_16x16x32_bf16 v[196:199], a[84:87], a[232:235], v[196:199]
    global_load_dwordx4 a[136:139], v11, s[44:45] offset:1024 sc1
    v_mfma_f32_16x16x32_bf16 v[200:203], a[88:91], a[232:235], v[200:203]
    ds_write_b32 v12, v46 offset:12032
    v_mfma_f32_16x16x32_bf16 v[204:207], a[92:95], a[232:235], v[204:207]
    ds_write_b32 v12, v47 offset:12036
    v_mfma_f32_16x16x32_bf16 v[208:211], a[84:87], a[236:239], v[208:211]
    ds_read_b128 a[232:235], v10 offset:25376
    v_mfma_f32_16x16x32_bf16 v[212:215], a[88:91], a[236:239], v[212:215]
    global_load_dwordx4 a[140:143], v11, s[44:45] offset:2048 sc1
    v_mfma_f32_16x16x32_bf16 v[216:219], a[92:95], a[236:239], v[216:219]
    s_waitcnt vmcnt(6) lgkmcnt(5)
    ds_write_b32 v12, v50 offset:33792
    v_mfma_f32_16x16x32_bf16 v[160:163], a[96:99], a[216:219], v[160:163]
HOP1_3:
    s_cbranch_execz HOP1_4
    ds_read_b128 a[236:239], v10 offset:50720
    v_mfma_f32_16x16x32_bf16 v[164:167], a[100:103], a[216:219], v[164:167]
    v_add_u32 v11, 6144, v11
    v_mfma_f32_16x16x32_bf16 v[168:171], a[104:107], a[216:219], v[168:171]
    global_load_dwordx4 a[72:75], v11, s[44:45] offset:-3072 sc1
    v_mfma_f32_16x16x32_bf16 v[172:175], a[96:99], a[220:223], v[172:175]
    ds_read_b128 a[216:219], v9 offset:64
    v_mfma_f32_16x16x32_bf16 v[176:179], a[100:103], a[220:223], v[176:179]
    ds_write_b32 v12, v51 offset:33796
    v_mfma_f32_16x16x32_bf16 v[180:183], a[104:107], a[220:223], v[180:183]
    ds_write_b32 v12, v54 offset:34304
    v_mfma_f32_16x16x32_bf16 v[160:163], a[108:111], a[220:223], v[160:163]
    global_load_dwordx4 a[76:79], v11, s[44:45] offset:-2048 sc1
    v_mfma_f32_16x16x32_bf16 v[164:167], a[112:115], a[220:223], v[164:167]
    ds_write_b32 v12, v55 offset:34308
    v_mfma_f32_16x16x32_bf16 v[168:171], a[116:119], a[220:223], v[168:171]
    ds_write_b32 v12, v58 offset:34816
    v_mfma_f32_16x16x32_bf16 v[184:187], a[96:99], a[224:227], v[184:187]
    ds_read_b128 a[220:223], v9 offset:25408
    v_mfma_f32_16x16x32_bf16 v[188:191], a[100:103], a[224:227], v[188:191]
    ds_write_b32 v12, v59 offset:34820
    v_mfma_f32_16x16x32_bf16 v[192:195], a[104:107], a[224:227], v[192:195]
    ds_write_b32 v12, v62 offset:35328
    v_mfma_f32_16x16x32_bf16 v[172:175], a[108:111], a[224:227], v[172:175]
    global_load_dwordx4 a[80:83], v11, s[44:45] offset:-1024 sc1
    v_mfma_f32_16x16x32_bf16 v[176:179], a[112:115], a[224:227], v[176:179]
    ds_write_b32 v12, v63 offset:35332
    v_mfma_f32_16x16x32_bf16 v[180:183], a[116:119], a[224:227], v[180:183]
    ds_write_b32 v12, v66 offset:35840
    v_mfma_f32_16x16x32_bf16 v[196:199], a[96:99], a[228:231], v[196:199]
    ds_read_b128 a[224:227], v9 offset:50752
    v_mfma_f32_16x16x32_bf16 v[200:203], a[100:103], a[228:231], v[200:203]
HOP1_4:
    s_cbranch_execz HOP1_5
    ds_write_b32 v12, v67 offset:35844
    v_mfma_f32_16x16x32_bf16 v[204:207], a[104:107], a[228:231], v[204:207]
    ds_write_b32 v12, v70 offset:36352
    v_mfma_f32_16x16x32_bf16 v[184:187], a[108:111], a[228:231], v[184:187]
    global_load_dwordx4 a[84:87], v11, s[44:45] offset:0 sc1
    v_mfma_f32_16x16x32_bf16 v[188:191], a[112:115], a[228:231], v[188:191]
    ds_write_b32 v12, v71 offset:36356
    v_mfma_f32_16x16x32_bf16 v[192:195], a[116:119], a[228:231], v[192:195]
    s_waitcnt lgkmcnt(14)
    ds_write_b32 v12, v74 offset:36864
    v_mfma_f32_16x16x32_bf16 v[208:211], a[96:99], a[232:235], v[208:211]
    ds_read_b128 a[228:231], v10 offset:64
    v_mfma_f32_16x16x32_bf16 v[212:215], a[100:103], a[232:235], v[212:215]
    ds_write_b32 v12, v75 offset:36868
    v_mfma_f32_16x16x32_bf16 v[216:219], a[104:107], a[232:235], v[216:219]
    v_mfma_f32_16x16x32_bf16 v[196:199], a[108:111], a[232:235], v[196:199]
    global_load_dwordx4 a[88:91], v11, s[44:45] offset:1024 sc1
    v_mfma_f32_16x16x32_bf16 v[200:203], a[112:115], a[232:235], v[200:203]
    v_mfma_f32_16x16x32_bf16 v[204:207], a[116:119], a[232:235], v[204:207]
    v_mfma_f32_16x16x32_bf16 v[208:211], a[108:111], a[236:239], v[208:211]
    ds_read_b128 a[232:235], v10 offset:25408
    v_mfma_f32_16x16x32_bf16 v[212:215], a[112:115], a[236:239], v[212:215]
    global_load_dwordx4 a[92:95], v11, s[44:45] offset:2048 sc1
    v_mfma_f32_16x16x32_bf16 v[216:219], a[116:119], a[236:239], v[216:219]
    s_waitcnt vmcnt(6) lgkmcnt(2)
    v_mfma_f32_16x16x32_bf16 v[160:163], a[120:123], a[216:219], v[160:163]
    ds_read_b128 a[236:239], v10 offset:50752
    v_mfma_f32_16x16x32_bf16 v[164:167], a[124:127], a[216:219], v[164:167]
    v_mfma_f32_16x16x32_bf16 v[168:171], a[128:131], a[216:219], v[168:171]
    v_add_u32 v9, 96, v9
    v_mfma_f32_16x16x32_bf16 v[172:175], a[120:123], a[220:223], v[172:175]
    ds_read_b128 a[216:219], v9 offset:0
    v_add_u32 v11, 6144, v11
    v_mfma_f32_16x16x32_bf16 v[176:179], a[124:127], a[220:223], v[176:179]
HOP1_5:
    s_cbranch_execz HOP1_6
    global_load_dwordx4 a[96:99], v11, s[44:45] offset:-3072 sc1
    v_mfma_f32_16x16x32_bf16 v[180:183], a[128:131], a[220:223], v[180:183]
    v_mfma_f32_16x16x32_bf16 v[160:163], a[132:135], a[220:223], v[160:163]
    global_load_dwordx4 a[100:103], v11, s[44:45] offset:-2048 sc1
    v_mfma_f32_16x16x32_bf16 v[164:167], a[136:139], a[220:223], v[164:167]
    v_mfma_f32_16x16x32_bf16 v[168:171], a[140:143], a[220:223], v[168:171]
    v_mfma_f32_16x16x32_bf16 v[184:187], a[120:123], a[224:227], v[184:187]
    ds_read_b128 a[220:223], v9 offset:25344
    v_mfma_f32_16x16x32_bf16 v[188:191], a[124:127], a[224:227], v[188:191]
    v_mfma_f32_16x16x32_bf16 v[192:195], a[128:131], a[224:227], v[192:195]
    v_mfma_f32_16x16x32_bf16 v[172:175], a[132:135], a[224:227], v[172:175]
    global_load_dwordx4 a[104:107], v11, s[44:45] offset:-1024 sc1
    v_mfma_f32_16x16x32_bf16 v[176:179], a[136:139], a[224:227], v[176:179]
    v_mfma_f32_16x16x32_bf16 v[180:183], a[140:143], a[224:227], v[180:183]
    v_mfma_f32_16x16x32_bf16 v[196:199], a[120:123], a[228:231], v[196:199]
    ds_read_b128 a[224:227], v9 offset:50688
    v_mfma_f32_16x16x32_bf16 v[200:203], a[124:127], a[228:231], v[200:203]
    v_mfma_f32_16x16x32_bf16 v[204:207], a[128:131], a[228:231], v[204:207]
    v_mfma_f32_16x16x32_bf16 v[184:187], a[132:135], a[228:231], v[184:187]
    global_load_dwordx4 a[108:111], v11, s[44:45] offset:0 sc1
    v_mfma_f32_16x16x32_bf16 v[188:191], a[136:139], a[228:231], v[188:191]
    v_mfma_f32_16x16x32_bf16 v[192:195], a[140:143], a[228:231], v[192:195]
    s_waitcnt lgkmcnt(3)
    v_add_u32 v10, 96, v10
    v_mfma_f32_16x16x32_bf16 v[208:211], a[120:123], a[232:235], v[208:211]
    ds_read_b128 a[228:231], v10 offset:0
    v_mfma_f32_16x16x32_bf16 v[212:215], a[124:127], a[232:235], v[212:215]
    s_barrier
    v_mfma_f32_16x16x32_bf16 v[216:219], a[128:131], a[232:235], v[216:219]
    ds_read_b64 v[226:227], v13 offset:8448
    ds_read_b64 v[228:229], v13 offset:8960
    v_mfma_f32_16x16x32_bf16 v[196:199], a[132:135], a[232:235], v[196:199]
HOP1_6:
    s_cbranch_execz HOP1_7
    global_load_dwordx4 a[112:115], v11, s[44:45] offset:1024 sc1
    v_mfma_f32_16x16x32_bf16 v[200:203], a[136:139], a[232:235], v[200:203]
    ds_read_b64 v[230:231], v13 offset:9472
    ds_read_b64 v[232:233], v13 offset:9984
    v_mfma_f32_16x16x32_bf16 v[204:207], a[140:143], a[232:235], v[204:207]
    v_mfma_f32_16x16x32_bf16 v[208:211], a[132:135], a[236:239], v[208:211]
    ds_read_b128 a[232:235], v10 offset:25344
    v_mfma_f32_16x16x32_bf16 v[212:215], a[136:139], a[236:239], v[212:215]
    global_load_dwordx4 a[116:119], v11, s[44:45] offset:2048 sc1
    v_mfma_f32_16x16x32_bf16 v[216:219], a[140:143], a[236:239], v[216:219]
    s_waitcnt vmcnt(6) lgkmcnt(4)
    v_sub_f32 v18, v16, v226
    v_add_f32 v226, v16, v226
    v_mfma_f32_16x16x32_bf16 v[160:163], a[72:75], a[216:219], v[160:163]
    ds_read_b128 a[236:239], v10 offset:50688
    v_sub_f32 v19, v17, v227
    v_mfma_f32_16x16x32_bf16 v[164:167], a[76:79], a[216:219], v[164:167]
    v_add_u32 v11, 6144, v11
    v_add_f32 v227, v17, v227
    v_mfma_f32_16x16x32_bf16 v[168:171], a[80:83], a[216:219], v[168:171]
    global_load_dwordx4 a[120:123], v11, s[44:45] offset:-3072 sc1
    v_mfma_f32_16x16x32_bf16 v[172:175], a[72:75], a[220:223], v[172:175]
    ds_read_b128 a[216:219], v9 offset:32
    v_fmac_f32 v106, s79, v18
    v_mfma_f32_16x16x32_bf16 v[176:179], a[76:79], a[220:223], v[176:179]
    v_add_f32 v76, v76, v226
    v_fmac_f32 v136, s68, v226
    v_mfma_f32_16x16x32_bf16 v[180:183], a[80:83], a[220:223], v[180:183]
    v_fmac_f32 v107, s79, v19
    v_add_f32 v77, v77, v227
    v_mfma_f32_16x16x32_bf16 v[160:163], a[84:87], a[220:223], v[160:163]
    global_load_dwordx4 a[124:127], v11, s[44:45] offset:-2048 sc1
    v_mfma_f32_16x16x32_bf16 v[164:167], a[88:91], a[220:223], v[164:167]
    ds_read_b64 v[234:235], v13 offset:10496
    v_fmac_f32 v137, s68, v227
    v_mfma_f32_16x16x32_bf16 v[168:171], a[92:95], a[220:223], v[168:171]
    s_waitcnt lgkmcnt(6)
    v_sub_f32 v22, v20, v228
    v_add_f32 v228, v20, v228
    v_mfma_f32_16x16x32_bf16 v[184:187], a[72:75], a[224:227], v[184:187]
    ds_read_b128 a[220:223], v9 offset:25376
    v_sub_f32 v23, v21, v229
    v_mfma_f32_16x16x32_bf16 v[188:191], a[76:79], a[224:227], v[188:191]
HOP1_7:
    s_cbranch_execz HOP1_8
    v_add_f32 v229, v21, v229
    v_fmac_f32 v108, s79, v22
    v_mfma_f32_16x16x32_bf16 v[192:195], a[80:83], a[224:227], v[192:195]
    v_add_f32 v78, v78, v228
    v_fmac_f32 v138, s68, v228
    v_mfma_f32_16x16x32_bf16 v[172:175], a[84:87], a[224:227], v[172:175]
    global_load_dwordx4 a[128:131], v11, s[44:45] offset:-1024 sc1
    v_mfma_f32_16x16x32_bf16 v[176:179], a[88:91], a[224:227], v[176:179]
    v_fmac_f32 v109, s79, v23
    v_add_f32 v79, v79, v229
    v_mfma_f32_16x16x32_bf16 v[180:183], a[92:95], a[224:227], v[180:183]
    ds_read_b64 v[236:237], v13 offset:11008
    v_fmac_f32 v139, s68, v229
    v_mfma_f32_16x16x32_bf16 v[196:199], a[72:75], a[228:231], v[196:199]
    s_waitcnt lgkmcnt(7)
    ds_read_b128 a[224:227], v9 offset:50720
    v_sub_f32 v26, v24, v230
    v_mfma_f32_16x16x32_bf16 v[200:203], a[76:79], a[228:231], v[200:203]
    v_add_f32 v230, v24, v230
    v_sub_f32 v27, v25, v231
    v_mfma_f32_16x16x32_bf16 v[204:207], a[80:83], a[228:231], v[204:207]
    v_add_f32 v231, v25, v231
    v_fmac_f32 v110, s79, v26
    v_mfma_f32_16x16x32_bf16 v[184:187], a[84:87], a[228:231], v[184:187]
    global_load_dwordx4 a[132:135], v11, s[44:45] offset:0 sc1
    v_mfma_f32_16x16x32_bf16 v[188:191], a[88:91], a[228:231], v[188:191]
    v_add_f32 v80, v80, v230
    v_fmac_f32 v140, s68, v230
    v_mfma_f32_16x16x32_bf16 v[192:195], a[92:95], a[228:231], v[192:195]
    s_waitcnt lgkmcnt(5)
    v_fmac_f32 v111, s79, v27
    v_add_f32 v81, v81, v231
    v_mfma_f32_16x16x32_bf16 v[208:211], a[72:75], a[232:235], v[208:211]
    ds_read_b128 a[228:231], v10 offset:32
    v_fmac_f32 v141, s68, v231
    v_mfma_f32_16x16x32_bf16 v[212:215], a[76:79], a[232:235], v[212:215]
HOP1_8:
    s_cbranch_execz HOP1_9
    ds_read_b64 v[238:239], v13 offset:11520
    v_sub_f32 v30, v28, v232
    v_mfma_f32_16x16x32_bf16 v[216:219], a[80:83], a[232:235], v[216:219]
    v_add_f32 v232, v28, v232
    v_sub_f32 v31, v29, v233
    v_mfma_f32_16x16x32_bf16 v[196:199], a[84:87], a[232:235], v[196:199]
    global_load_dwordx4 a[136:139], v11, s[44:45] offset:1024 sc1
    v_mfma_f32_16x16x32_bf16 v[200:203], a[88:91], a[232:235], v[200:203]
    v_add_f32 v233, v29, v233
    v_fmac_f32 v112, s79, v30
    v_mfma_f32_16x16x32_bf16 v[204:207], a[92:95], a[232:235], v[204:207]
    v_add_f32 v82, v82, v232
    v_fmac_f32 v142, s68, v232
    v_mfma_f32_16x16x32_bf16 v[208:211], a[84:87], a[236:239], v[208:211]
    ds_read_b128 a[232:235], v10 offset:25376
    v_fmac_f32 v113, s79, v31
    v_mfma_f32_16x16x32_bf16 v[212:215], a[88:91], a[236:239], v[212:215]
    global_load_dwordx4 a[140:143], v11, s[44:45] offset:2048 sc1
    v_mfma_f32_16x16x32_bf16 v[216:219], a[92:95], a[236:239], v[216:219]
    s_waitcnt vmcnt(6) lgkmcnt(2)
    v_add_f32 v83, v83, v233
    v_fmac_f32 v143, s68, v233
    v_mfma_f32_16x16x32_bf16 v[160:163], a[96:99], a[216:219], v[160:163]
    ds_read_b128 a[236:239], v10 offset:50720
    ds_read_b64 v[240:241], v13 offset:12032
    v_mfma_f32_16x16x32_bf16 v[164:167], a[100:103], a[216:219], v[164:167]
    v_add_u32 v11, 6144, v11
    v_sub_f32 v34, v32, v234
    v_mfma_f32_16x16x32_bf16 v[168:171], a[104:107], a[216:219], v[168:171]
    global_load_dwordx4 a[72:75], v11, s[44:45] offset:-3072 sc1
    v_mfma_f32_16x16x32_bf16 v[172:175], a[96:99], a[220:223], v[172:175]
    ds_read_b128 a[216:219], v9 offset:64
    v_add_f32 v234, v32, v234
    v_mfma_f32_16x16x32_bf16 v[176:179], a[100:103], a[220:223], v[176:179]
    v_sub_f32 v35, v33, v235
    v_add_f32 v235, v33, v235
    v_mfma_f32_16x16x32_bf16 v[180:183], a[104:107], a[220:223], v[180:183]
    v_fmac_f32 v114, s79, v34
    v_add_f32 v84, v84, v234
    v_mfma_f32_16x16x32_bf16 v[160:163], a[108:111], a[220:223], v[160:163]
HOP1_9:
    s_cbranch_execz HOP1_10
    global_load_dwordx4 a[76:79], v11, s[44:45] offset:-2048 sc1
    v_mfma_f32_16x16x32_bf16 v[164:167], a[112:115], a[220:223], v[164:167]
    v_fmac_f32 v144, s68, v234
    v_fmac_f32 v115, s79, v35
    v_mfma_f32_16x16x32_bf16 v[168:171], a[116:119], a[220:223], v[168:171]
    v_add_f32 v85, v85, v235
    v_fmac_f32 v145, s68, v235
    v_mfma_f32_16x16x32_bf16 v[184:187], a[96:99], a[224:227], v[184:187]
    ds_read_b128 a[220:223], v9 offset:25408
    ds_read_b64 v[242:243], v13 offset:33792
    v_mfma_f32_16x16x32_bf16 v[188:191], a[100:103], a[224:227], v[188:191]
    v_sub_f32 v38, v36, v236
    v_add_f32 v236, v36, v236
    v_mfma_f32_16x16x32_bf16 v[192:195], a[104:107], a[224:227], v[192:195]
    v_sub_f32 v39, v37, v237
    v_add_f32 v237, v37, v237
    v_mfma_f32_16x16x32_bf16 v[172:175], a[108:111], a[224:227], v[172:175]
    global_load_dwordx4 a[80:83], v11, s[44:45] offset:-1024 sc1
    v_mfma_f32_16x16x32_bf16 v[176:179], a[112:115], a[224:227], v[176:179]
    v_fmac_f32 v116, s79, v38
    v_add_f32 v86, v86, v236
    v_mfma_f32_16x16x32_bf16 v[180:183], a[116:119], a[224:227], v[180:183]
    v_fmac_f32 v146, s68, v236
    v_fmac_f32 v117, s79, v39
    v_mfma_f32_16x16x32_bf16 v[196:199], a[96:99], a[228:231], v[196:199]
    ds_read_b128 a[224:227], v9 offset:50752
    v_add_f32 v87, v87, v237
    v_mfma_f32_16x16x32_bf16 v[200:203], a[100:103], a[228:231], v[200:203]
    ds_read_b64 v[244:245], v13 offset:34304
    v_fmac_f32 v147, s68, v237
    v_mfma_f32_16x16x32_bf16 v[204:207], a[104:107], a[228:231], v[204:207]
    s_waitcnt lgkmcnt(8)
    v_sub_f32 v42, v40, v238
    v_add_f32 v238, v40, v238
    v_mfma_f32_16x16x32_bf16 v[184:187], a[108:111], a[228:231], v[184:187]
    global_load_dwordx4 a[84:87], v11, s[44:45] offset:0 sc1
    v_mfma_f32_16x16x32_bf16 v[188:191], a[112:115], a[228:231], v[188:191]
    v_sub_f32 v43, v41, v239
    v_add_f32 v239, v41, v239
    v_mfma_f32_16x16x32_bf16 v[192:195], a[116:119], a[228:231], v[192:195]
    s_waitcnt lgkmcnt(6)
    v_fmac_f32 v118, s79, v42
    v_add_f32 v88, v88, v238
    v_mfma_f32_16x16x32_bf16 v[208:211], a[96:99], a[232:235], v[208:211]
HOP1_10:
    s_cbranch_execz HOP1_11
    ds_read_b128 a[228:231], v10 offset:64
    v_fmac_f32 v148, s68, v238
    v_mfma_f32_16x16x32_bf16 v[212:215], a[100:103], a[232:235], v[212:215]
    v_fmac_f32 v119, s79, v43
    v_add_f32 v89, v89, v239
    v_mfma_f32_16x16x32_bf16 v[216:219], a[104:107], a[232:235], v[216:219]
    ds_read_b64 v[246:247], v13 offset:34816
    v_fmac_f32 v149, s68, v239
    v_mfma_f32_16x16x32_bf16 v[196:199], a[108:111], a[232:235], v[196:199]
    global_load_dwordx4 a[88:91], v11, s[44:45] offset:1024 sc1
    v_mfma_f32_16x16x32_bf16 v[200:203], a[112:115], a[232:235], v[200:203]
    s_waitcnt lgkmcnt(7)
    v_sub_f32 v46, v44, v240
    v_add_f32 v240, v44, v240
    v_mfma_f32_16x16x32_bf16 v[204:207], a[116:119], a[232:235], v[204:207]
    v_sub_f32 v47, v45, v241
    v_add_f32 v241, v45, v241
    v_mfma_f32_16x16x32_bf16 v[208:211], a[108:111], a[236:239], v[208:211]
    ds_read_b128 a[232:235], v10 offset:25408
    v_fmac_f32 v120, s79, v46
    v_mfma_f32_16x16x32_bf16 v[212:215], a[112:115], a[236:239], v[212:215]
    global_load_dwordx4 a[92:95], v11, s[44:45] offset:2048 sc1
    v_mfma_f32_16x16x32_bf16 v[216:219], a[116:119], a[236:239], v[216:219]
    s_waitcnt vmcnt(6) lgkmcnt(2)
    v_add_f32 v90, v90, v240
    v_fmac_f32 v150, s68, v240
    v_mfma_f32_16x16x32_bf16 v[160:163], a[120:123], a[216:219], v[160:163]
    ds_read_b128 a[236:239], v10 offset:50752
    v_fmac_f32 v121, s79, v47
    v_mfma_f32_16x16x32_bf16 v[164:167], a[124:127], a[216:219], v[164:167]
    v_add_f32 v91, v91, v241
    v_fmac_f32 v151, s68, v241
    v_mfma_f32_16x16x32_bf16 v[168:171], a[128:131], a[216:219], v[168:171]
    ds_read_b64 v[248:249], v13 offset:35328
    v_add_u32 v9, 96, v9
    v_mfma_f32_16x16x32_bf16 v[172:175], a[120:123], a[220:223], v[172:175]
    ds_read_b128 a[216:219], v9 offset:0
    v_add_u32 v11, 6144, v11
    v_mfma_f32_16x16x32_bf16 v[176:179], a[124:127], a[220:223], v[176:179]
HOP1_11:
    s_cbranch_execz HOP1_12
    global_load_dwordx4 a[96:99], v11, s[44:45] offset:-3072 sc1
    v_mfma_f32_16x16x32_bf16 v[180:183], a[128:131], a[220:223], v[180:183]
    v_sub_f32 v50, v48, v242
    v_add_f32 v242, v48, v242
    v_mfma_f32_16x16x32_bf16 v[160:163], a[132:135], a[220:223], v[160:163]
    global_load_dwordx4 a[100:103], v11, s[44:45] offset:-2048 sc1
    v_mfma_f32_16x16x32_bf16 v[164:167], a[136:139], a[220:223], v[164:167]
    v_sub_f32 v51, v49, v243
    v_add_f32 v243, v49, v243
    v_mfma_f32_16x16x32_bf16 v[168:171], a[140:143], a[220:223], v[168:171]
    v_fmac_f32 v122, s79, v50
    v_add_f32 v92, v92, v242
    v_mfma_f32_16x16x32_bf16 v[184:187], a[120:123], a[224:227], v[184:187]
    ds_read_b128 a[220:223], v9 offset:25344
    v_fmac_f32 v152, s68, v242
    v_mfma_f32_16x16x32_bf16 v[188:191], a[124:127], a[224:227], v[188:191]
    v_fmac_f32 v123, s79, v51
    v_add_f32 v93, v93, v243
    v_mfma_f32_16x16x32_bf16 v[192:195], a[128:131], a[224:227], v[192:195]
    ds_read_b64 v[250:251], v13 offset:35840
    v_fmac_f32 v153, s68, v243
    v_mfma_f32_16x16x32_bf16 v[172:175], a[132:135], a[224:227], v[172:175]
    global_load_dwordx4 a[104:107], v11, s[44:45] offset:-1024 sc1
    v_mfma_f32_16x16x32_bf16 v[176:179], a[136:139], a[224:227], v[176:179]
    v_sub_f32 v54, v52, v244
    v_add_f32 v244, v52, v244
    v_mfma_f32_16x16x32_bf16 v[180:183], a[140:143], a[224:227], v[180:183]
    v_sub_f32 v55, v53, v245
    v_add_f32 v245, v53, v245
    v_mfma_f32_16x16x32_bf16 v[196:199], a[120:123], a[228:231], v[196:199]
    ds_read_b128 a[224:227], v9 offset:50688
    v_fmac_f32 v124, s79, v54
    v_mfma_f32_16x16x32_bf16 v[200:203], a[124:127], a[228:231], v[200:203]
    v_add_f32 v94, v94, v244
    v_fmac_f32 v154, s68, v244
    v_mfma_f32_16x16x32_bf16 v[204:207], a[128:131], a[228:231], v[204:207]
    v_fmac_f32 v125, s79, v55
    v_add_f32 v95, v95, v245
    v_mfma_f32_16x16x32_bf16 v[184:187], a[132:135], a[228:231], v[184:187]
    global_load_dwordx4 a[108:111], v11, s[44:45] offset:0 sc1
    v_mfma_f32_16x16x32_bf16 v[188:191], a[136:139], a[228:231], v[188:191]
HOP1_12:
    s_cbranch_execz HOP1_13
    ds_read_b64 v[252:253], v13 offset:36352
    v_fmac_f32 v155, s68, v245
    v_mfma_f32_16x16x32_bf16 v[192:195], a[140:143], a[228:231], v[192:195]
    s_waitcnt lgkmcnt(6)
    v_add_u32 v10, 96, v10
    v_sub_f32 v58, v56, v246
    v_mfma_f32_16x16x32_bf16 v[208:211], a[120:123], a[232:235], v[208:211]
    ds_read_b128 a[228:231], v10 offset:0
    v_add_f32 v246, v56, v246
    v_mfma_f32_16x16x32_bf16 v[212:215], a[124:127], a[232:235], v[212:215]
    v_sub_f32 v59, v57, v247
    v_add_f32 v247, v57, v247
    v_mfma_f32_16x16x32_bf16 v[216:219], a[128:131], a[232:235], v[216:219]
    v_fmac_f32 v126, s79, v58
    v_add_f32 v96, v96, v246
    v_mfma_f32_16x16x32_bf16 v[196:199], a[132:135], a[232:235], v[196:199]
    global_load_dwordx4 a[112:115], v11, s[44:45] offset:1024 sc1
    v_mfma_f32_16x16x32_bf16 v[200:203], a[136:139], a[232:235], v[200:203]
    v_fmac_f32 v156, s68, v246
    v_fmac_f32 v127, s79, v59
    v_mfma_f32_16x16x32_bf16 v[204:207], a[140:143], a[232:235], v[204:207]
    v_add_f32 v97, v97, v247
    v_fmac_f32 v157, s68, v247
    v_mfma_f32_16x16x32_bf16 v[208:211], a[132:135], a[236:239], v[208:211]
    ds_read_b128 a[232:235], v10 offset:25344
    ds_read_b64 v[254:255], v13 offset:36864
    v_mfma_f32_16x16x32_bf16 v[212:215], a[136:139], a[236:239], v[212:215]
    global_load_dwordx4 a[116:119], v11, s[44:45] offset:2048 sc1
    v_mfma_f32_16x16x32_bf16 v[216:219], a[140:143], a[236:239], v[216:219]
    s_waitcnt vmcnt(6) lgkmcnt(2)
    v_sub_f32 v62, v60, v248
    v_add_f32 v248, v60, v248
    v_mfma_f32_16x16x32_bf16 v[160:163], a[72:75], a[216:219], v[160:163]
    ds_read_b128 a[236:239], v10 offset:50688
    v_sub_f32 v63, v61, v249
    v_mfma_f32_16x16x32_bf16 v[164:167], a[76:79], a[216:219], v[164:167]
    v_add_u32 v11, 6144, v11
    v_add_f32 v249, v61, v249
    v_mfma_f32_16x16x32_bf16 v[168:171], a[80:83], a[216:219], v[168:171]
HOP1_13:
    s_cbranch_execz HOP1_14
    global_load_dwordx4 a[120:123], v11, s[44:45] offset:-3072 sc1
    v_mfma_f32_16x16x32_bf16 v[172:175], a[72:75], a[220:223], v[172:175]
    ds_read_b128 a[216:219], v9 offset:32
    v_fmac_f32 v128, s79, v62
    v_mfma_f32_16x16x32_bf16 v[176:179], a[76:79], a[220:223], v[176:179]
    v_add_f32 v98, v98, v248
    v_fmac_f32 v158, s68, v248
    v_mfma_f32_16x16x32_bf16 v[180:183], a[80:83], a[220:223], v[180:183]
    v_fmac_f32 v129, s79, v63
    v_add_f32 v99, v99, v249
    v_mfma_f32_16x16x32_bf16 v[160:163], a[84:87], a[220:223], v[160:163]
    global_load_dwordx4 a[124:127], v11, s[44:45] offset:-2048 sc1
    v_mfma_f32_16x16x32_bf16 v[164:167], a[88:91], a[220:223], v[164:167]
    v_fmac_f32 v159, s68, v249
    v_sub_f32 v66, v64, v250
    v_mfma_f32_16x16x32_bf16 v[168:171], a[92:95], a[220:223], v[168:171]
    v_add_f32 v250, v64, v250
    v_sub_f32 v67, v65, v251
    v_mfma_f32_16x16x32_bf16 v[184:187], a[72:75], a[224:227], v[184:187]
    ds_read_b128 a[220:223], v9 offset:25376
    v_add_f32 v251, v65, v251
    v_mfma_f32_16x16x32_bf16 v[188:191], a[76:79], a[224:227], v[188:191]
    v_fmac_f32 v130, s79, v66
    v_add_f32 v100, v100, v250
    v_mfma_f32_16x16x32_bf16 v[192:195], a[80:83], a[224:227], v[192:195]
    v_fmac_f32 v220, s68, v250
    v_fmac_f32 v131, s79, v67
    v_mfma_f32_16x16x32_bf16 v[172:175], a[84:87], a[224:227], v[172:175]
    global_load_dwordx4 a[128:131], v11, s[44:45] offset:-1024 sc1
    v_mfma_f32_16x16x32_bf16 v[176:179], a[88:91], a[224:227], v[176:179]
    v_add_f32 v101, v101, v251
    v_fmac_f32 v221, s68, v251
    v_mfma_f32_16x16x32_bf16 v[180:183], a[92:95], a[224:227], v[180:183]
    v_sub_f32 v70, v68, v252
    v_add_f32 v252, v68, v252
    v_mfma_f32_16x16x32_bf16 v[196:199], a[72:75], a[228:231], v[196:199]
    ds_read_b128 a[224:227], v9 offset:50720
    v_sub_f32 v71, v69, v253
    v_mfma_f32_16x16x32_bf16 v[200:203], a[76:79], a[228:231], v[200:203]
    v_add_f32 v253, v69, v253
    v_fmac_f32 v132, s79, v70
    v_mfma_f32_16x16x32_bf16 v[204:207], a[80:83], a[228:231], v[204:207]
HOP1_14:
    s_cbranch_execz HOP1_15
    v_add_f32 v102, v102, v252
    v_fmac_f32 v222, s68, v252
    v_mfma_f32_16x16x32_bf16 v[184:187], a[84:87], a[228:231], v[184:187]
    global_load_dwordx4 a[132:135], v11, s[44:45] offset:0 sc1
    v_mfma_f32_16x16x32_bf16 v[188:191], a[88:91], a[228:231], v[188:191]
    v_fmac_f32 v133, s79, v71
    v_add_f32 v103, v103, v253
    v_mfma_f32_16x16x32_bf16 v[192:195], a[92:95], a[228:231], v[192:195]
    s_waitcnt lgkmcnt(3)
    v_fmac_f32 v223, s68, v253
    v_sub_f32 v74, v72, v254
    v_mfma_f32_16x16x32_bf16 v[208:211], a[72:75], a[232:235], v[208:211]
    ds_read_b128 a[228:231], v10 offset:32
    v_add_f32 v254, v72, v254
    v_mfma_f32_16x16x32_bf16 v[212:215], a[76:79], a[232:235], v[212:215]
    v_sub_f32 v75, v73, v255
    v_add_f32 v255, v73, v255
    v_mfma_f32_16x16x32_bf16 v[216:219], a[80:83], a[232:235], v[216:219]
    v_fmac_f32 v134, s79, v74
    v_add_f32 v104, v104, v254
    v_mfma_f32_16x16x32_bf16 v[196:199], a[84:87], a[232:235], v[196:199]
    global_load_dwordx4 a[136:139], v11, s[44:45] offset:1024 sc1
    v_mfma_f32_16x16x32_bf16 v[200:203], a[88:91], a[232:235], v[200:203]
    v_fmac_f32 v224, s68, v254
    v_fmac_f32 v135, s79, v75
    v_mfma_f32_16x16x32_bf16 v[204:207], a[92:95], a[232:235], v[204:207]
    v_add_f32 v105, v105, v255
    v_fmac_f32 v225, s68, v255
    v_mfma_f32_16x16x32_bf16 v[208:211], a[84:87], a[236:239], v[208:211]
    ds_read_b128 a[232:235], v10 offset:25376
    v_cvt_pk_bf16_f32 v106, v106, v107
    v_mfma_f32_16x16x32_bf16 v[212:215], a[88:91], a[236:239], v[212:215]
    global_load_dwordx4 a[140:143], v11, s[44:45] offset:2048 sc1
    v_mfma_f32_16x16x32_bf16 v[216:219], a[92:95], a[236:239], v[216:219]
    s_waitcnt vmcnt(6) lgkmcnt(1)
    ds_write_b32 v4, v106 offset:0
    v_mfma_f32_16x16x32_bf16 v[160:163], a[96:99], a[216:219], v[160:163]
    ds_read_b128 a[236:239], v10 offset:50720
    v_cvt_pk_bf16_f32 v108, v108, v109
    v_mfma_f32_16x16x32_bf16 v[164:167], a[100:103], a[216:219], v[164:167]
HOP1_15:
    s_cbranch_execz HOP1_16
    v_add_u32 v11, 6144, v11
    v_mfma_f32_16x16x32_bf16 v[168:171], a[104:107], a[216:219], v[168:171]
    global_load_dwordx4 a[72:75], v11, s[44:45] offset:-3072 sc1
    v_mfma_f32_16x16x32_bf16 v[172:175], a[96:99], a[220:223], v[172:175]
    ds_read_b128 a[216:219], v9 offset:64
    v_mfma_f32_16x16x32_bf16 v[176:179], a[100:103], a[220:223], v[176:179]
    ds_write_b32 v4, v108 offset:16
    v_mfma_f32_16x16x32_bf16 v[180:183], a[104:107], a[220:223], v[180:183]
    v_cvt_pk_bf16_f32 v110, v110, v111
    v_mfma_f32_16x16x32_bf16 v[160:163], a[108:111], a[220:223], v[160:163]
    global_load_dwordx4 a[76:79], v11, s[44:45] offset:-2048 sc1
    v_mfma_f32_16x16x32_bf16 v[164:167], a[112:115], a[220:223], v[164:167]
    ds_write_b32 v4, v110 offset:32
    v_mfma_f32_16x16x32_bf16 v[168:171], a[116:119], a[220:223], v[168:171]
    v_cvt_pk_bf16_f32 v112, v112, v113
    v_mfma_f32_16x16x32_bf16 v[184:187], a[96:99], a[224:227], v[184:187]
    ds_read_b128 a[220:223], v9 offset:25408
    v_mfma_f32_16x16x32_bf16 v[188:191], a[100:103], a[224:227], v[188:191]
    ds_write_b32 v4, v112 offset:25344
    v_mfma_f32_16x16x32_bf16 v[192:195], a[104:107], a[224:227], v[192:195]
    v_cvt_pk_bf16_f32 v114, v114, v115
    v_mfma_f32_16x16x32_bf16 v[172:175], a[108:111], a[224:227], v[172:175]
    global_load_dwordx4 a[80:83], v11, s[44:45] offset:-1024 sc1
    v_mfma_f32_16x16x32_bf16 v[176:179], a[112:115], a[224:227], v[176:179]
    ds_write_b32 v4, v114 offset:25360
    v_mfma_f32_16x16x32_bf16 v[180:183], a[116:119], a[224:227], v[180:183]
    v_cvt_pk_bf16_f32 v116, v116, v117
    v_mfma_f32_16x16x32_bf16 v[196:199], a[96:99], a[228:231], v[196:199]
    ds_read_b128 a[224:227], v9 offset:50752
    v_mfma_f32_16x16x32_bf16 v[200:203], a[100:103], a[228:231], v[200:203]
    ds_write_b32 v4, v116 offset:25376
    v_mfma_f32_16x16x32_bf16 v[204:207], a[104:107], a[228:231], v[204:207]
HOP1_16:
    s_cbranch_execz HOP1_17
    v_cvt_pk_bf16_f32 v118, v118, v119
    v_mfma_f32_16x16x32_bf16 v[184:187], a[108:111], a[228:231], v[184:187]
    global_load_dwordx4 a[84:87], v11, s[44:45] offset:0 sc1
    v_mfma_f32_16x16x32_bf16 v[188:191], a[112:115], a[228:231], v[188:191]
    ds_write_b32 v4, v118 offset:50688
    v_mfma_f32_16x16x32_bf16 v[192:195], a[116:119], a[228:231], v[192:195]
    s_waitcnt lgkmcnt(9)
    v_cvt_pk_bf16_f32 v120, v120, v121
    v_mfma_f32_16x16x32_bf16 v[208:211], a[96:99], a[232:235], v[208:211]
    ds_read_b128 a[228:231], v10 offset:64
    v_mfma_f32_16x16x32_bf16 v[212:215], a[100:103], a[232:235], v[212:215]
    ds_write_b32 v4, v120 offset:50704
    v_mfma_f32_16x16x32_bf16 v[216:219], a[104:107], a[232:235], v[216:219]
    v_cvt_pk_bf16_f32 v122, v122, v123
    v_mfma_f32_16x16x32_bf16 v[196:199], a[108:111], a[232:235], v[196:199]
    global_load_dwordx4 a[88:91], v11, s[44:45] offset:1024 sc1
    v_mfma_f32_16x16x32_bf16 v[200:203], a[112:115], a[232:235], v[200:203]
    ds_write_b32 v4, v122 offset:50720
    v_mfma_f32_16x16x32_bf16 v[204:207], a[116:119], a[232:235], v[204:207]
    v_cvt_pk_bf16_f32 v124, v124, v125
    v_mfma_f32_16x16x32_bf16 v[208:211], a[108:111], a[236:239], v[208:211]
    ds_read_b128 a[232:235], v10 offset:25408
    v_mfma_f32_16x16x32_bf16 v[212:215], a[112:115], a[236:239], v[212:215]
    global_load_dwordx4 a[92:95], v11, s[44:45] offset:2048 sc1
    v_mfma_f32_16x16x32_bf16 v[216:219], a[116:119], a[236:239], v[216:219]
    s_waitcnt vmcnt(6) lgkmcnt(3)
    ds_write_b32 v4, v124 offset:4224
    v_mfma_f32_16x16x32_bf16 v[160:163], a[120:123], a[216:219], v[160:163]
    ds_read_b128 a[236:239], v10 offset:50752
    v_cvt_pk_bf16_f32 v126, v126, v127
    v_mfma_f32_16x16x32_bf16 v[164:167], a[124:127], a[216:219], v[164:167]
    ds_write_b32 v4, v126 offset:4240
    v_mfma_f32_16x16x32_bf16 v[168:171], a[128:131], a[216:219], v[168:171]
HOP1_17:
    s_cbranch_execz HOP1_18
    v_add_u32 v9, 96, v9
    v_cvt_pk_bf16_f32 v128, v128, v129
    v_mfma_f32_16x16x32_bf16 v[172:175], a[120:123], a[220:223], v[172:175]
    ds_read_b128 a[216:219], v9 offset:0
    v_add_u32 v11, 6144, v11
    v_mfma_f32_16x16x32_bf16 v[176:179], a[124:127], a[220:223], v[176:179]
    global_load_dwordx4 a[96:99], v11, s[44:45] offset:-3072 sc1
    v_mfma_f32_16x16x32_bf16 v[180:183], a[128:131], a[220:223], v[180:183]
    ds_write_b32 v4, v128 offset:4256
    v_mfma_f32_16x16x32_bf16 v[160:163], a[132:135], a[220:223], v[160:163]
    global_load_dwordx4 a[100:103], v11, s[44:45] offset:-2048 sc1
    v_mfma_f32_16x16x32_bf16 v[164:167], a[136:139], a[220:223], v[164:167]
    v_cvt_pk_bf16_f32 v130, v130, v131
    v_mfma_f32_16x16x32_bf16 v[168:171], a[140:143], a[220:223], v[168:171]
    ds_write_b32 v4, v130 offset:29568
    v_mfma_f32_16x16x32_bf16 v[184:187], a[120:123], a[224:227], v[184:187]
    ds_read_b128 a[220:223], v9 offset:25344
    v_cvt_pk_bf16_f32 v132, v132, v133
    v_mfma_f32_16x16x32_bf16 v[188:191], a[124:127], a[224:227], v[188:191]
    ds_write_b32 v4, v132 offset:29584
    v_mfma_f32_16x16x32_bf16 v[192:195], a[128:131], a[224:227], v[192:195]
    v_cvt_pk_bf16_f32 v134, v134, v135
    v_mfma_f32_16x16x32_bf16 v[172:175], a[132:135], a[224:227], v[172:175]
    global_load_dwordx4 a[104:107], v11, s[44:45] offset:-1024 sc1
    v_mfma_f32_16x16x32_bf16 v[176:179], a[136:139], a[224:227], v[176:179]
    ds_write_b32 v4, v134 offset:29600
    v_mfma_f32_16x16x32_bf16 v[180:183], a[140:143], a[224:227], v[180:183]
    v_add_u32 v4, 76032, v4
    v_mfma_f32_16x16x32_bf16 v[196:199], a[120:123], a[228:231], v[196:199]
    ds_read_b128 a[224:227], v9 offset:50688
    v_mfma_f32_16x16x32_bf16 v[200:203], a[124:127], a[228:231], v[200:203]
HOP1_18:
    s_cbranch_execz HOP1_19
    v_mfma_f32_16x16x32_bf16 v[204:207], a[128:131], a[228:231], v[204:207]
    v_mfma_f32_16x16x32_bf16 v[184:187], a[132:135], a[228:231], v[184:187]
    global_load_dwordx4 a[108:111], v11, s[44:45] offset:0 sc1
    v_mfma_f32_16x16x32_bf16 v[188:191], a[136:139], a[228:231], v[188:191]
    v_mfma_f32_16x16x32_bf16 v[192:195], a[140:143], a[228:231], v[192:195]
    s_waitcnt lgkmcnt(8)
    v_add_u32 v10, 96, v10
    v_mfma_f32_16x16x32_bf16 v[208:211], a[120:123], a[232:235], v[208:211]
    ds_read_b128 a[228:231], v10 offset:0
    v_mfma_f32_16x16x32_bf16 v[212:215], a[124:127], a[232:235], v[212:215]
    v_mfma_f32_16x16x32_bf16 v[216:219], a[128:131], a[232:235], v[216:219]
    v_mfma_f32_16x16x32_bf16 v[196:199], a[132:135], a[232:235], v[196:199]
    global_load_dwordx4 a[112:115], v11, s[44:45] offset:1024 sc1
    v_mfma_f32_16x16x32_bf16 v[200:203], a[136:139], a[232:235], v[200:203]
    v_mfma_f32_16x16x32_bf16 v[204:207], a[140:143], a[232:235], v[204:207]
    v_mfma_f32_16x16x32_bf16 v[208:211], a[132:135], a[236:239], v[208:211]
    ds_read_b128 a[232:235], v10 offset:25344
    v_mfma_f32_16x16x32_bf16 v[212:215], a[136:139], a[236:239], v[212:215]
    global_load_dwordx4 a[116:119], v11, s[44:45] offset:2048 sc1
    v_mfma_f32_16x16x32_bf16 v[216:219], a[140:143], a[236:239], v[216:219]
    s_waitcnt vmcnt(6) lgkmcnt(1)
    v_mfma_f32_16x16x32_bf16 v[160:163], a[72:75], a[216:219], v[160:163]
    ds_read_b128 a[236:239], v10 offset:50688
    v_mfma_f32_16x16x32_bf16 v[164:167], a[76:79], a[216:219], v[164:167]
    v_add_u32 v11, 6144, v11
    v_mfma_f32_16x16x32_bf16 v[168:171], a[80:83], a[216:219], v[168:171]
    global_load_dwordx4 a[120:123], v11, s[44:45] offset:-3072 sc1
    v_mfma_f32_16x16x32_bf16 v[172:175], a[72:75], a[220:223], v[172:175]
    ds_read_b128 a[216:219], v9 offset:32
    v_mfma_f32_16x16x32_bf16 v[176:179], a[76:79], a[220:223], v[176:179]
    v_mfma_f32_16x16x32_bf16 v[180:183], a[80:83], a[220:223], v[180:183]
    v_mfma_f32_16x16x32_bf16 v[160:163], a[84:87], a[220:223], v[160:163]
HOP1_19:
    s_cbranch_execz HOP1_20
    global_load_dwordx4 a[124:127], v11, s[44:45] offset:-2048 sc1
    v_mfma_f32_16x16x32_bf16 v[164:167], a[88:91], a[220:223], v[164:167]
    v_mfma_f32_16x16x32_bf16 v[168:171], a[92:95], a[220:223], v[168:171]
    v_mfma_f32_16x16x32_bf16 v[184:187], a[72:75], a[224:227], v[184:187]
    ds_read_b128 a[220:223], v9 offset:25376
    v_mfma_f32_16x16x32_bf16 v[188:191], a[76:79], a[224:227], v[188:191]
    v_mfma_f32_16x16x32_bf16 v[192:195], a[80:83], a[224:227], v[192:195]
    v_mfma_f32_16x16x32_bf16 v[172:175], a[84:87], a[224:227], v[172:175]
    global_load_dwordx4 a[128:131], v11, s[44:45] offset:-1024 sc1
    v_mfma_f32_16x16x32_bf16 v[176:179], a[88:91], a[224:227], v[176:179]
    v_mfma_f32_16x16x32_bf16 v[180:183], a[92:95], a[224:227], v[180:183]
    v_mfma_f32_16x16x32_bf16 v[196:199], a[72:75], a[228:231], v[196:199]
    ds_read_b128 a[224:227], v9 offset:50720
    v_mfma_f32_16x16x32_bf16 v[200:203], a[76:79], a[228:231], v[200:203]
    v_mfma_f32_16x16x32_bf16 v[204:207], a[80:83], a[228:231], v[204:207]
    v_mfma_f32_16x16x32_bf16 v[184:187], a[84:87], a[228:231], v[184:187]
    global_load_dwordx4 a[132:135], v11, s[44:45] offset:0 sc1
    v_mfma_f32_16x16x32_bf16 v[188:191], a[88:91], a[228:231], v[188:191]
    v_mfma_f32_16x16x32_bf16 v[192:195], a[92:95], a[228:231], v[192:195]
    s_waitcnt lgkmcnt(3)
    v_mfma_f32_16x16x32_bf16 v[208:211], a[72:75], a[232:235], v[208:211]
    ds_read_b128 a[228:231], v10 offset:32
    v_mfma_f32_16x16x32_bf16 v[212:215], a[76:79], a[232:235], v[212:215]
    v_mfma_f32_16x16x32_bf16 v[216:219], a[80:83], a[232:235], v[216:219]
    v_mfma_f32_16x16x32_bf16 v[196:199], a[84:87], a[232:235], v[196:199]
    global_load_dwordx4 a[136:139], v11, s[44:45] offset:1024 sc1
    v_mfma_f32_16x16x32_bf16 v[200:203], a[88:91], a[232:235], v[200:203]
    v_mfma_f32_16x16x32_bf16 v[204:207], a[92:95], a[232:235], v[204:207]
    v_mfma_f32_16x16x32_bf16 v[208:211], a[84:87], a[236:239], v[208:211]
    ds_read_b128 a[232:235], v10 offset:25376
    v_mfma_f32_16x16x32_bf16 v[212:215], a[88:91], a[236:239], v[212:215]
    global_load_dwordx4 a[140:143], v11, s[44:45] offset:2048 sc1
    v_mfma_f32_16x16x32_bf16 v[216:219], a[92:95], a[236:239], v[216:219]
HOP1_20:
    s_cbranch_execz HOP1_21
    s_waitcnt vmcnt(6) lgkmcnt(1)
    v_mfma_f32_16x16x32_bf16 v[160:163], a[96:99], a[216:219], v[160:163]
    ds_read_b128 a[236:239], v10 offset:50720
    v_mfma_f32_16x16x32_bf16 v[164:167], a[100:103], a[216:219], v[164:167]
    v_add_u32 v11, 6144, v11
    v_mfma_f32_16x16x32_bf16 v[168:171], a[104:107], a[216:219], v[168:171]
    global_load_dwordx4 a[72:75], v11, s[44:45] offset:-3072 sc1
    v_mfma_f32_16x16x32_bf16 v[172:175], a[96:99], a[220:223], v[172:175]
    ds_read_b128 a[216:219], v9 offset:64
    v_mfma_f32_16x16x32_bf16 v[176:179], a[100:103], a[220:223], v[176:179]
    v_mfma_f32_16x16x32_bf16 v[180:183], a[104:107], a[220:223], v[180:183]
    v_mfma_f32_16x16x32_bf16 v[160:163], a[108:111], a[220:223], v[160:163]
    global_load_dwordx4 a[76:79], v11, s[44:45] offset:-2048 sc1
    v_mfma_f32_16x16x32_bf16 v[164:167], a[112:115], a[220:223], v[164:167]
    v_mfma_f32_16x16x32_bf16 v[168:171], a[116:119], a[220:223], v[168:171]
    v_mfma_f32_16x16x32_bf16 v[184:187], a[96:99], a[224:227], v[184:187]
    ds_read_b128 a[220:223], v9 offset:25408
    v_mfma_f32_16x16x32_bf16 v[188:191], a[100:103], a[224:227], v[188:191]
    v_mfma_f32_16x16x32_bf16 v[192:195], a[104:107], a[224:227], v[192:195]
    v_mfma_f32_16x16x32_bf16 v[172:175], a[108:111], a[224:227], v[172:175]
    global_load_dwordx4 a[80:83], v11, s[44:45] offset:-1024 sc1
    v_mfma_f32_16x16x32_bf16 v[176:179], a[112:115], a[224:227], v[176:179]
    v_mfma_f32_16x16x32_bf16 v[180:183], a[116:119], a[224:227], v[180:183]
    v_mfma_f32_16x16x32_bf16 v[196:199], a[96:99], a[228:231], v[196:199]
    ds_read_b128 a[224:227], v9 offset:50752
    v_mfma_f32_16x16x32_bf16 v[200:203], a[100:103], a[228:231], v[200:203]
    v_mfma_f32_16x16x32_bf16 v[204:207], a[104:107], a[228:231], v[204:207]
    v_mfma_f32_16x16x32_bf16 v[184:187], a[108:111], a[228:231], v[184:187]
    global_load_dwordx4 a[84:87], v11, s[44:45] offset:0 sc1
    v_mfma_f32_16x16x32_bf16 v[188:191], a[112:115], a[228:231], v[188:191]
    v_mfma_f32_16x16x32_bf16 v[192:195], a[116:119], a[228:231], v[192:195]
HOP1_21:
    s_cbranch_execz HOP1_22
    s_waitcnt lgkmcnt(3)
    v_mfma_f32_16x16x32_bf16 v[208:211], a[96:99], a[232:235], v[208:211]
    ds_read_b128 a[228:231], v10 offset:64
    v_mfma_f32_16x16x32_bf16 v[212:215], a[100:103], a[232:235], v[212:215]
    v_mfma_f32_16x16x32_bf16 v[216:219], a[104:107], a[232:235], v[216:219]
    v_mfma_f32_16x16x32_bf16 v[196:199], a[108:111], a[232:235], v[196:199]
    global_load_dwordx4 a[88:91], v11, s[44:45] offset:1024 sc1
    v_mfma_f32_16x16x32_bf16 v[200:203], a[112:115], a[232:235], v[200:203]
    v_mfma_f32_16x16x32_bf16 v[204:207], a[116:119], a[232:235], v[204:207]
    v_mfma_f32_16x16x32_bf16 v[208:211], a[108:111], a[236:239], v[208:211]
    ds_read_b128 a[232:235], v10 offset:25408
    v_mfma_f32_16x16x32_bf16 v[212:215], a[112:115], a[236:239], v[212:215]
    global_load_dwordx4 a[92:95], v11, s[44:45] offset:2048 sc1
    v_mfma_f32_16x16x32_bf16 v[216:219], a[116:119], a[236:239], v[216:219]
    s_waitcnt vmcnt(6) lgkmcnt(1)
    v_mfma_f32_16x16x32_bf16 v[160:163], a[120:123], a[216:219], v[160:163]
    ds_read_b128 a[236:239], v10 offset:50752
    v_mfma_f32_16x16x32_bf16 v[164:167], a[124:127], a[216:219], v[164:167]
    v_mfma_f32_16x16x32_bf16 v[168:171], a[128:131], a[216:219], v[168:171]
    v_add_u32 v9, 96, v9
    v_mfma_f32_16x16x32_bf16 v[172:175], a[120:123], a[220:223], v[172:175]
    ds_read_b128 a[216:219], v9 offset:0
    v_add_u32 v11, 6144, v11
    v_mfma_f32_16x16x32_bf16 v[176:179], a[124:127], a[220:223], v[176:179]
    global_load_dwordx4 a[96:99], v11, s[44:45] offset:-3072 sc1
    v_mfma_f32_16x16x32_bf16 v[180:183], a[128:131], a[220:223], v[180:183]
    v_mfma_f32_16x16x32_bf16 v[160:163], a[132:135], a[220:223], v[160:163]
    global_load_dwordx4 a[100:103], v11, s[44:45] offset:-2048 sc1
    v_mfma_f32_16x16x32_bf16 v[164:167], a[136:139], a[220:223], v[164:167]
    v_mfma_f32_16x16x32_bf16 v[168:171], a[140:143], a[220:223], v[168:171]
    v_mfma_f32_16x16x32_bf16 v[184:187], a[120:123], a[224:227], v[184:187]
    ds_read_b128 a[220:223], v9 offset:25344
    v_mfma_f32_16x16x32_bf16 v[188:191], a[124:127], a[224:227], v[188:191]
HOP1_22:
    s_cbranch_execz HOP1_23
    v_mfma_f32_16x16x32_bf16 v[192:195], a[128:131], a[224:227], v[192:195]
    v_mfma_f32_16x16x32_bf16 v[172:175], a[132:135], a[224:227], v[172:175]
    global_load_dwordx4 a[104:107], v11, s[44:45] offset:-1024 sc1
    v_mfma_f32_16x16x32_bf16 v[176:179], a[136:139], a[224:227], v[176:179]
    v_mfma_f32_16x16x32_bf16 v[180:183], a[140:143], a[224:227], v[180:183]
    v_mfma_f32_16x16x32_bf16 v[196:199], a[120:123], a[228:231], v[196:199]
    ds_read_b128 a[224:227], v9 offset:50688
    v_mfma_f32_16x16x32_bf16 v[200:203], a[124:127], a[228:231], v[200:203]
    v_mfma_f32_16x16x32_bf16 v[204:207], a[128:131], a[228:231], v[204:207]
    v_mfma_f32_16x16x32_bf16 v[184:187], a[132:135], a[228:231], v[184:187]
    global_load_dwordx4 a[108:111], v11, s[44:45] offset:0 sc1
    v_mfma_f32_16x16x32_bf16 v[188:191], a[136:139], a[228:231], v[188:191]
    v_mfma_f32_16x16x32_bf16 v[192:195], a[140:143], a[228:231], v[192:195]
    s_waitcnt lgkmcnt(3)
    v_add_u32 v10, 96, v10
    v_mfma_f32_16x16x32_bf16 v[208:211], a[120:123], a[232:235], v[208:211]
    ds_read_b128 a[228:231], v10 offset:0
    v_mfma_f32_16x16x32_bf16 v[212:215], a[124:127], a[232:235], v[212:215]
    v_mfma_f32_16x16x32_bf16 v[216:219], a[128:131], a[232:235], v[216:219]
    v_mfma_f32_16x16x32_bf16 v[196:199], a[132:135], a[232:235], v[196:199]
    global_load_dwordx4 a[112:115], v11, s[44:45] offset:1024 sc1
    v_mfma_f32_16x16x32_bf16 v[200:203], a[136:139], a[232:235], v[200:203]
    v_mfma_f32_16x16x32_bf16 v[204:207], a[140:143], a[232:235], v[204:207]
    v_mfma_f32_16x16x32_bf16 v[208:211], a[132:135], a[236:239], v[208:211]
    ds_read_b128 a[232:235], v10 offset:25344
    v_mfma_f32_16x16x32_bf16 v[212:215], a[136:139], a[236:239], v[212:215]
    global_load_dwordx4 a[116:119], v11, s[44:45] offset:2048 sc1
    v_mfma_f32_16x16x32_bf16 v[216:219], a[140:143], a[236:239], v[216:219]
    s_waitcnt vmcnt(6) lgkmcnt(1)
    v_mfma_f32_16x16x32_bf16 v[160:163], a[72:75], a[216:219], v[160:163]
    s_barrier
    ds_read_b128 a[236:239], v10 offset:50688
    v_mfma_f32_16x16x32_bf16 v[164:167], a[76:79], a[216:219], v[164:167]
HOP1_23:
    s_cbranch_execz HOP1_24
    ds_read_b128 v[106:109], v5 offset:0
    v_add_u32 v11, 6144, v11
    v_mfma_f32_16x16x32_bf16 v[168:171], a[80:83], a[216:219], v[168:171]
    global_load_dwordx4 a[120:123], v11, s[44:45] offset:-3072 sc1
    v_mfma_f32_16x16x32_bf16 v[172:175], a[72:75], a[220:223], v[172:175]
    ds_read_b128 a[216:219], v9 offset:32
    ds_read_b128 v[110:113], v5 offset:25344
    v_mfma_f32_16x16x32_bf16 v[176:179], a[76:79], a[220:223], v[176:179]
    ds_read_b128 v[114:117], v5 offset:50688
    ds_read_b128 v[118:121], v5 offset:4224
    v_mfma_f32_16x16x32_bf16 v[180:183], a[80:83], a[220:223], v[180:183]
    ds_read_b128 v[122:125], v5 offset:29568
    v_add_u32 v5, 76032, v5
    v_mfma_f32_16x16x32_bf16 v[160:163], a[84:87], a[220:223], v[160:163]
    s_mov_b32 s56, 43008
    global_load_dwordx4 a[124:127], v11, s[44:45] offset:-2048 sc1
    v_mfma_f32_16x16x32_bf16 v[164:167], a[88:91], a[220:223], v[164:167]
    ds_read_b64 v[226:227], v14 offset:0
    ds_read_b64 v[228:229], v14 offset:512
    v_mfma_f32_16x16x32_bf16 v[168:171], a[92:95], a[220:223], v[168:171]
    ds_read_b64 v[230:231], v14 offset:1024
    ds_read_b64 v[232:233], v14 offset:1536
    v_mfma_f32_16x16x32_bf16 v[184:187], a[72:75], a[224:227], v[184:187]
    ds_read_b128 a[220:223], v9 offset:25376
    v_mfma_f32_16x16x32_bf16 v[188:191], a[76:79], a[224:227], v[188:191]
    v_mfma_f32_16x16x32_bf16 v[192:195], a[80:83], a[224:227], v[192:195]
    v_mfma_f32_16x16x32_bf16 v[172:175], a[84:87], a[224:227], v[172:175]
    global_load_dwordx4 a[128:131], v11, s[44:45] offset:-1024 sc1
    v_mfma_f32_16x16x32_bf16 v[176:179], a[88:91], a[224:227], v[176:179]
    s_waitcnt lgkmcnt(4)
    v_add_f32 v76, v76, v226
    v_add_f32 v77, v77, v227
    v_mfma_f32_16x16x32_bf16 v[180:183], a[92:95], a[224:227], v[180:183]
HOP1_24:
    s_cbranch_execz HOP1_25
    v_cvt_pk_bf16_f32 v76, v76, v77
    v_mfma_f32_16x16x32_bf16 v[196:199], a[72:75], a[228:231], v[196:199]
    ds_read_b128 a[224:227], v9 offset:50720
    v_mfma_f32_16x16x32_bf16 v[200:203], a[76:79], a[228:231], v[200:203]
    ds_write_b32 v4, v76 offset:0
    v_mfma_f32_16x16x32_bf16 v[204:207], a[80:83], a[228:231], v[204:207]
    s_waitcnt lgkmcnt(5)
    ds_read_b64 v[234:235], v14 offset:2048
    v_add_f32 v78, v78, v228
    v_mfma_f32_16x16x32_bf16 v[184:187], a[84:87], a[228:231], v[184:187]
    global_load_dwordx4 a[132:135], v11, s[44:45] offset:0 sc1
    v_mfma_f32_16x16x32_bf16 v[188:191], a[88:91], a[228:231], v[188:191]
    v_add_f32 v79, v79, v229
    v_cvt_pk_bf16_f32 v78, v78, v79
    v_mfma_f32_16x16x32_bf16 v[192:195], a[92:95], a[228:231], v[192:195]
    ds_write_b32 v4, v78 offset:16
    v_mfma_f32_16x16x32_bf16 v[208:211], a[72:75], a[232:235], v[208:211]
    ds_read_b128 a[228:231], v10 offset:32
    ds_read_b64 v[236:237], v14 offset:2560
    v_mfma_f32_16x16x32_bf16 v[212:215], a[76:79], a[232:235], v[212:215]
    s_waitcnt lgkmcnt(8)
    v_add_f32 v80, v80, v230
    v_add_f32 v81, v81, v231
    v_mfma_f32_16x16x32_bf16 v[216:219], a[80:83], a[232:235], v[216:219]
    v_cvt_pk_bf16_f32 v80, v80, v81
    v_mfma_f32_16x16x32_bf16 v[196:199], a[84:87], a[232:235], v[196:199]
    global_load_dwordx4 a[136:139], v11, s[44:45] offset:1024 sc1
    v_mfma_f32_16x16x32_bf16 v[200:203], a[88:91], a[232:235], v[200:203]
    ds_write_b32 v4, v80 offset:32
    v_mfma_f32_16x16x32_bf16 v[204:207], a[92:95], a[232:235], v[204:207]
    s_waitcnt lgkmcnt(8)
    ds_read_b64 v[238:239], v14 offset:3072
    v_add_f32 v82, v82, v232
    v_mfma_f32_16x16x32_bf16 v[208:211], a[84:87], a[236:239], v[208:211]
    ds_read_b128 a[232:235], v10 offset:25376
    v_add_f32 v83, v83, v233
    v_mfma_f32_16x16x32_bf16 v[212:215], a[88:91], a[236:239], v[212:215]
HOP1_25:
    s_cbranch_execz HOP1_26
    global_load_dwordx4 a[140:143], v11, s[44:45] offset:2048 sc1
    v_mfma_f32_16x16x32_bf16 v[216:219], a[92:95], a[236:239], v[216:219]
    s_waitcnt vmcnt(6) lgkmcnt(4)
    v_cvt_pk_bf16_f32 v82, v82, v83
    v_mfma_f32_16x16x32_bf16 v[160:163], a[96:99], a[216:219], v[160:163]
    ds_read_b128 a[236:239], v10 offset:50720
    v_mfma_f32_16x16x32_bf16 v[164:167], a[100:103], a[216:219], v[164:167]
    v_add_u32 v11, 6144, v11
    v_mfma_f32_16x16x32_bf16 v[168:171], a[104:107], a[216:219], v[168:171]
    global_load_dwordx4 a[72:75], v11, s[44:45] offset:-3072 sc1
    v_mfma_f32_16x16x32_bf16 v[172:175], a[96:99], a[220:223], v[172:175]
    ds_read_b128 a[216:219], v9 offset:64
    v_mfma_f32_16x16x32_bf16 v[176:179], a[100:103], a[220:223], v[176:179]
    ds_write_b32 v4, v82 offset:4224
    v_mfma_f32_16x16x32_bf16 v[180:183], a[104:107], a[220:223], v[180:183]
    ds_read_b64 v[240:241], v14 offset:3584
    v_add_f32 v84, v84, v234
    v_mfma_f32_16x16x32_bf16 v[160:163], a[108:111], a[220:223], v[160:163]
    global_load_dwordx4 a[76:79], v11, s[44:45] offset:-2048 sc1
    v_mfma_f32_16x16x32_bf16 v[164:167], a[112:115], a[220:223], v[164:167]
    v_add_f32 v85, v85, v235
    v_cvt_pk_bf16_f32 v84, v84, v85
    v_mfma_f32_16x16x32_bf16 v[168:171], a[116:119], a[220:223], v[168:171]
    ds_write_b32 v4, v84 offset:4240
    v_mfma_f32_16x16x32_bf16 v[184:187], a[96:99], a[224:227], v[184:187]
    ds_read_b128 a[220:223], v9 offset:25408
    ds_read_b64 v[242:243], v14 offset:25344
    v_mfma_f32_16x16x32_bf16 v[188:191], a[100:103], a[224:227], v[188:191]
    s_waitcnt lgkmcnt(10)
    v_add_f32 v86, v86, v236
    v_add_f32 v87, v87, v237
    v_mfma_f32_16x16x32_bf16 v[192:195], a[104:107], a[224:227], v[192:195]
    v_cvt_pk_bf16_f32 v86, v86, v87
    v_mfma_f32_16x16x32_bf16 v[172:175], a[108:111], a[224:227], v[172:175]
HOP1_26:
    s_cbranch_execz HOP1_27
    global_load_dwordx4 a[80:83], v11, s[44:45] offset:-1024 sc1
    v_mfma_f32_16x16x32_bf16 v[176:179], a[112:115], a[224:227], v[176:179]
    ds_write_b32 v4, v86 offset:4256
    v_mfma_f32_16x16x32_bf16 v[180:183], a[116:119], a[224:227], v[180:183]
    s_waitcnt lgkmcnt(9)
    ds_read_b64 v[244:245], v14 offset:25856
    v_add_f32 v88, v88, v238
    v_mfma_f32_16x16x32_bf16 v[196:199], a[96:99], a[228:231], v[196:199]
    ds_read_b128 a[224:227], v9 offset:50752
    v_add_f32 v89, v89, v239
    v_mfma_f32_16x16x32_bf16 v[200:203], a[100:103], a[228:231], v[200:203]
    v_cvt_pk_bf16_f32 v88, v88, v89
    v_mfma_f32_16x16x32_bf16 v[204:207], a[104:107], a[228:231], v[204:207]
    ds_write_b32 v4, v88 offset:33792
    v_mfma_f32_16x16x32_bf16 v[184:187], a[108:111], a[228:231], v[184:187]
    global_load_dwordx4 a[84:87], v11, s[44:45] offset:0 sc1
    v_mfma_f32_16x16x32_bf16 v[188:191], a[112:115], a[228:231], v[188:191]
    s_waitcnt lgkmcnt(7)
    ds_read_b64 v[246:247], v14 offset:26368
    v_add_f32 v90, v90, v240
    v_mfma_f32_16x16x32_bf16 v[192:195], a[116:119], a[228:231], v[192:195]
    v_add_f32 v91, v91, v241
    v_cvt_pk_bf16_f32 v90, v90, v91
    v_mfma_f32_16x16x32_bf16 v[208:211], a[96:99], a[232:235], v[208:211]
    ds_read_b128 a[228:231], v10 offset:64
    v_mfma_f32_16x16x32_bf16 v[212:215], a[100:103], a[232:235], v[212:215]
    ds_write_b32 v4, v90 offset:33808
    v_mfma_f32_16x16x32_bf16 v[216:219], a[104:107], a[232:235], v[216:219]
    s_waitcnt lgkmcnt(7)
    ds_read_b64 v[248:249], v14 offset:26880
    v_add_f32 v92, v92, v242
    v_mfma_f32_16x16x32_bf16 v[196:199], a[108:111], a[232:235], v[196:199]
    global_load_dwordx4 a[88:91], v11, s[44:45] offset:1024 sc1
    v_mfma_f32_16x16x32_bf16 v[200:203], a[112:115], a[232:235], v[200:203]
HOP1_27:
    s_cbranch_execz HOP1_28
    v_add_f32 v93, v93, v243
    v_cvt_pk_bf16_f32 v92, v92, v93
    v_mfma_f32_16x16x32_bf16 v[204:207], a[116:119], a[232:235], v[204:207]
    ds_write_b32 v4, v92 offset:33824
    v_mfma_f32_16x16x32_bf16 v[208:211], a[108:111], a[236:239], v[208:211]
    ds_read_b128 a[232:235], v10 offset:25408
    ds_read_b64 v[250:251], v14 offset:27392
    v_mfma_f32_16x16x32_bf16 v[212:215], a[112:115], a[236:239], v[212:215]
    global_load_dwordx4 a[92:95], v11, s[44:45] offset:2048 sc1
    v_mfma_f32_16x16x32_bf16 v[216:219], a[116:119], a[236:239], v[216:219]
    s_waitcnt vmcnt(6) lgkmcnt(5)
    v_add_f32 v94, v94, v244
    v_add_f32 v95, v95, v245
    v_mfma_f32_16x16x32_bf16 v[160:163], a[120:123], a[216:219], v[160:163]
    ds_read_b128 a[236:239], v10 offset:50752
    v_cvt_pk_bf16_f32 v94, v94, v95
    v_mfma_f32_16x16x32_bf16 v[164:167], a[124:127], a[216:219], v[164:167]
    buffer_store_dwordx4 v[106:109], v15, s[36:39], s56 offen sc1
    v_mfma_f32_16x16x32_bf16 v[168:171], a[128:131], a[216:219], v[168:171]
    s_mov_b32 s56, 172032
    v_add_u32 v9, 96, v9
    v_mfma_f32_16x16x32_bf16 v[172:175], a[120:123], a[220:223], v[172:175]
    ds_read_b128 a[216:219], v9 offset:0
    v_mfma_f32_16x16x32_bf16 v[176:179], a[124:127], a[220:223], v[176:179]
    ds_write_b32 v4, v94 offset:38016
    v_mfma_f32_16x16x32_bf16 v[180:183], a[128:131], a[220:223], v[180:183]
    buffer_store_dwordx4 v[110:113], v15, s[36:39], s56 offen sc1
    v_mfma_f32_16x16x32_bf16 v[160:163], a[132:135], a[220:223], v[160:163]
    s_mov_b32 s56, 301056
    ds_read_b64 v[252:253], v14 offset:27904
    v_add_f32 v96, v96, v246
    v_mfma_f32_16x16x32_bf16 v[164:167], a[136:139], a[220:223], v[164:167]
    v_add_f32 v97, v97, v247
    v_cvt_pk_bf16_f32 v96, v96, v97
    v_mfma_f32_16x16x32_bf16 v[168:171], a[140:143], a[220:223], v[168:171]
HOP1_28:
    s_cbranch_execz HOP1_29
    ds_write_b32 v4, v96 offset:38032
    v_mfma_f32_16x16x32_bf16 v[184:187], a[120:123], a[224:227], v[184:187]
    s_waitcnt lgkmcnt(8)
    ds_read_b128 a[220:223], v9 offset:25344
    ds_read_b64 v[254:255], v14 offset:28416
    v_mfma_f32_16x16x32_bf16 v[188:191], a[124:127], a[224:227], v[188:191]
    buffer_store_dwordx4 v[114:117], v15, s[36:39], s56 offen sc1
    v_mfma_f32_16x16x32_bf16 v[192:195], a[128:131], a[224:227], v[192:195]
    s_mov_b32 s56, 430080
    v_add_f32 v98, v98, v248
    v_add_f32 v99, v99, v249
    v_mfma_f32_16x16x32_bf16 v[172:175], a[132:135], a[224:227], v[172:175]
    v_cvt_pk_bf16_f32 v98, v98, v99
    v_mfma_f32_16x16x32_bf16 v[176:179], a[136:139], a[224:227], v[176:179]
    s_waitcnt lgkmcnt(7)
    ds_write_b32 v4, v98 offset:38048
    v_mfma_f32_16x16x32_bf16 v[180:183], a[140:143], a[224:227], v[180:183]
    buffer_store_dwordx4 v[118:121], v15, s[36:39], s56 offen sc1
    v_mfma_f32_16x16x32_bf16 v[196:199], a[120:123], a[228:231], v[196:199]
    s_mov_b32 s56, 559104
    ds_read_b128 a[224:227], v9 offset:50688
    v_add_f32 v100, v100, v250
    v_mfma_f32_16x16x32_bf16 v[200:203], a[124:127], a[228:231], v[200:203]
    v_add_f32 v101, v101, v251
    v_cvt_pk_bf16_f32 v100, v100, v101
    v_mfma_f32_16x16x32_bf16 v[204:207], a[128:131], a[228:231], v[204:207]
    ds_write_b32 v4, v100 offset:59136
    v_mfma_f32_16x16x32_bf16 v[184:187], a[132:135], a[228:231], v[184:187]
    buffer_store_dwordx4 v[122:125], v15, s[36:39], s56 offen sc1
    v_mfma_f32_16x16x32_bf16 v[188:191], a[136:139], a[228:231], v[188:191]
    s_waitcnt lgkmcnt(6)
    v_add_f32 v102, v102, v252
    v_add_f32 v103, v103, v253
    v_mfma_f32_16x16x32_bf16 v[192:195], a[140:143], a[228:231], v[192:195]
    v_add_u32 v10, 96, v10
    v_cvt_pk_bf16_f32 v102, v102, v103
    v_mfma_f32_16x16x32_bf16 v[208:211], a[120:123], a[232:235], v[208:211]
HOP1_29:
    s_cbranch_execz HOP1_30
    ds_read_b128 a[228:231], v10 offset:0
    v_mfma_f32_16x16x32_bf16 v[212:215], a[124:127], a[232:235], v[212:215]
    ds_write_b32 v4, v102 offset:59152
    v_mfma_f32_16x16x32_bf16 v[216:219], a[128:131], a[232:235], v[216:219]
    s_waitcnt lgkmcnt(5)
    v_add_f32 v104, v104, v254
    v_add_f32 v105, v105, v255
    v_mfma_f32_16x16x32_bf16 v[196:199], a[132:135], a[232:235], v[196:199]
    v_cvt_pk_bf16_f32 v104, v104, v105
    v_mfma_f32_16x16x32_bf16 v[200:203], a[136:139], a[232:235], v[200:203]
    ds_write_b32 v4, v104 offset:59168
    v_mfma_f32_16x16x32_bf16 v[204:207], a[140:143], a[232:235], v[204:207]
    s_waitcnt lgkmcnt(0)
    s_barrier
    v_subrev_u32 v4, 76032, v4
    v_mfma_f32_16x16x32_bf16 v[208:211], a[132:135], a[236:239], v[208:211]
    ds_read_b128 a[232:235], v10 offset:25344
    ds_read_b128 v[16:19], v5 offset:0
    v_mfma_f32_16x16x32_bf16 v[212:215], a[136:139], a[236:239], v[212:215]
    ds_read_b128 v[20:23], v5 offset:4224
    ds_read_b128 v[24:27], v5 offset:33792
    v_mfma_f32_16x16x32_bf16 v[216:219], a[140:143], a[236:239], v[216:219]
    s_waitcnt vmcnt(5)
    ds_read_b128 v[28:31], v5 offset:38016
    ds_read_b128 v[32:35], v5 offset:59136
    v_mfma_f32_16x16x32_bf16 v[160:163], a[72:75], a[216:219], v[160:163]
    s_mov_b32 s55, 0
    ds_read_b128 a[236:239], v10 offset:50688
    v_subrev_u32 v5, 76032, v5
    v_mfma_f32_16x16x32_bf16 v[164:167], a[76:79], a[216:219], v[164:167]
    v_mfma_f32_16x16x32_bf16 v[168:171], a[80:83], a[216:219], v[168:171]
    v_mfma_f32_16x16x32_bf16 v[172:175], a[72:75], a[220:223], v[172:175]
    v_mfma_f32_16x16x32_bf16 v[176:179], a[76:79], a[220:223], v[176:179]
    s_waitcnt lgkmcnt(5)
    v_mfma_f32_16x16x32_bf16 v[180:183], a[80:83], a[220:223], v[180:183]
    buffer_store_dwordx4 v[16:19], v15, s[36:39], s55 offen sc1
    v_mfma_f32_16x16x32_bf16 v[160:163], a[84:87], a[220:223], v[160:163]
    s_mov_b32 s55, 129024
    v_mfma_f32_16x16x32_bf16 v[164:167], a[88:91], a[220:223], v[164:167]
HOP1_30:
    s_cbranch_execz HOP1_31
    v_mfma_f32_16x16x32_bf16 v[168:171], a[92:95], a[220:223], v[168:171]
    s_waitcnt lgkmcnt(4)
    v_mfma_f32_16x16x32_bf16 v[184:187], a[72:75], a[224:227], v[184:187]
    buffer_store_dwordx4 v[20:23], v15, s[36:39], s55 offen sc1
    v_mfma_f32_16x16x32_bf16 v[188:191], a[76:79], a[224:227], v[188:191]
    s_mov_b32 s55, 258048
    v_mfma_f32_16x16x32_bf16 v[192:195], a[80:83], a[224:227], v[192:195]
    v_mfma_f32_16x16x32_bf16 v[172:175], a[84:87], a[224:227], v[172:175]
    s_waitcnt lgkmcnt(3)
    v_mfma_f32_16x16x32_bf16 v[176:179], a[88:91], a[224:227], v[176:179]
    buffer_store_dwordx4 v[24:27], v15, s[36:39], s55 offen sc1
    v_mfma_f32_16x16x32_bf16 v[180:183], a[92:95], a[224:227], v[180:183]
    s_mov_b32 s55, 387072
    ds_write_b64 v12, v[162:163] offset:8448
    v_mfma_f32_16x16x32_bf16 v[196:199], a[72:75], a[228:231], v[196:199]
    ds_write_b64 v12, v[166:167] offset:8960
    v_mfma_f32_16x16x32_bf16 v[200:203], a[76:79], a[228:231], v[200:203]
    s_waitcnt lgkmcnt(4)
    ds_write_b64 v12, v[170:171] offset:9472
    v_mfma_f32_16x16x32_bf16 v[204:207], a[80:83], a[228:231], v[204:207]
    buffer_store_dwordx4 v[28:31], v15, s[36:39], s55 offen sc1
    v_mfma_f32_16x16x32_bf16 v[184:187], a[84:87], a[228:231], v[184:187]
    s_mov_b32 s55, 516096
    v_mfma_f32_16x16x32_bf16 v[188:191], a[88:91], a[228:231], v[188:191]
    v_mfma_f32_16x16x32_bf16 v[192:195], a[92:95], a[228:231], v[192:195]
    s_waitcnt lgkmcnt(3)
    ds_write_b64 v12, v[174:175] offset:9984
    v_mfma_f32_16x16x32_bf16 v[208:211], a[72:75], a[232:235], v[208:211]
    buffer_store_dwordx4 v[32:35], v15, s[36:39], s55 offen sc1
    v_mfma_f32_16x16x32_bf16 v[212:215], a[76:79], a[232:235], v[212:215]
    ds_write_b64 v12, v[178:179] offset:10496
    v_mfma_f32_16x16x32_bf16 v[216:219], a[80:83], a[232:235], v[216:219]
    ds_write_b64 v12, v[182:183] offset:11008
    v_mfma_f32_16x16x32_bf16 v[196:199], a[84:87], a[232:235], v[196:199]
HOP1_31:
    s_cbranch_execz HOP1_32
    v_mfma_f32_16x16x32_bf16 v[200:203], a[88:91], a[232:235], v[200:203]
    v_mfma_f32_16x16x32_bf16 v[204:207], a[92:95], a[232:235], v[204:207]
    ds_write_b64 v12, v[186:187] offset:11520
    v_mfma_f32_16x16x32_bf16 v[208:211], a[84:87], a[236:239], v[208:211]
    ds_write_b64 v12, v[190:191] offset:12032
    v_mfma_f32_16x16x32_bf16 v[212:215], a[88:91], a[236:239], v[212:215]
    ds_write_b64 v12, v[194:195] offset:33792
    v_mfma_f32_16x16x32_bf16 v[216:219], a[92:95], a[236:239], v[216:219]
    v_pk_add_f32 v[136:137], v[136:137], v[160:161]
    v_pk_add_f32 v[138:139], v[138:139], v[164:165]
    v_pk_add_f32 v[140:141], v[140:141], v[168:169]
    ds_write_b64 v12, v[198:199] offset:34304
    ds_write_b64 v12, v[202:203] offset:34816
    ds_write_b64 v12, v[206:207] offset:35328
    ds_write_b64 v12, v[210:211] offset:35840
    ds_write_b64 v12, v[214:215] offset:36352
    ds_write_b64 v12, v[218:219] offset:36864
    v_pk_add_f32 v[142:143], v[142:143], v[172:173]
    v_pk_add_f32 v[144:145], v[144:145], v[176:177]
    v_pk_add_f32 v[146:147], v[146:147], v[180:181]
    v_pk_add_f32 v[148:149], v[148:149], v[184:185]
    v_pk_add_f32 v[150:151], v[150:151], v[188:189]
    v_pk_add_f32 v[152:153], v[152:153], v[192:193]
    v_pk_add_f32 v[154:155], v[154:155], v[196:197]
    v_pk_add_f32 v[156:157], v[156:157], v[200:201]
    v_pk_add_f32 v[158:159], v[158:159], v[204:205]
HOP1_32:
    s_cbranch_execz HOP1_33
    s_nop 0
    v_pk_add_f32 v[220:221], v[220:221], v[208:209]
    v_pk_add_f32 v[222:223], v[222:223], v[212:213]
    v_pk_add_f32 v[224:225], v[224:225], v[216:217]
    s_waitcnt lgkmcnt(0)
    s_barrier
    ds_read_b64 v[226:227], v13 offset:8448
    ds_read_b64 v[228:229], v13 offset:8960
    ds_read_b64 v[230:231], v13 offset:9472
    ds_read_b64 v[232:233], v13 offset:9984
    ds_read_b64 v[234:235], v13 offset:10496
    ds_read_b64 v[236:237], v13 offset:11008
    ds_read_b64 v[238:239], v13 offset:11520
    ds_read_b64 v[240:241], v13 offset:12032
    ds_read_b64 v[242:243], v13 offset:33792
    ds_read_b64 v[244:245], v13 offset:34304
    ds_read_b64 v[246:247], v13 offset:34816
    ds_read_b64 v[248:249], v13 offset:35328
    ds_read_b64 v[250:251], v13 offset:35840
    ds_read_b64 v[252:253], v13 offset:36352
    ds_read_b64 v[254:255], v13 offset:36864
    s_waitcnt lgkmcnt(12)
    v_pk_add_f32 v[136:137], v[136:137], v[226:227]
    v_cvt_pk_bf16_f32 v136, v136, v137
    v_pk_add_f32 v[138:139], v[138:139], v[228:229]
    v_cvt_pk_bf16_f32 v138, v138, v139
    v_pk_add_f32 v[140:141], v[140:141], v[230:231]
    v_cvt_pk_bf16_f32 v140, v140, v141
    ds_write_b32 v4, v136 offset:0
    ds_write_b32 v4, v138 offset:16
    ds_write_b32 v4, v140 offset:32
    s_waitcnt lgkmcnt(12)
    v_pk_add_f32 v[142:143], v[142:143], v[232:233]
    v_cvt_pk_bf16_f32 v142, v142, v143
HOP1_33:
    s_cbranch_execz HOP1_34
    s_nop 0
    v_pk_add_f32 v[144:145], v[144:145], v[234:235]
    v_cvt_pk_bf16_f32 v144, v144, v145
    v_pk_add_f32 v[146:147], v[146:147], v[236:237]
    v_cvt_pk_bf16_f32 v146, v146, v147
    ds_write_b32 v4, v142 offset:25344
    ds_write_b32 v4, v144 offset:25360
    ds_write_b32 v4, v146 offset:25376
    s_waitcnt lgkmcnt(12)
    v_pk_add_f32 v[148:149], v[148:149], v[238:239]
    v_cvt_pk_bf16_f32 v148, v148, v149
    v_pk_add_f32 v[150:151], v[150:151], v[240:241]
    v_cvt_pk_bf16_f32 v150, v150, v151
    v_pk_add_f32 v[152:153], v[152:153], v[242:243]
    v_cvt_pk_bf16_f32 v152, v152, v153
    ds_write_b32 v4, v148 offset:50688
    ds_write_b32 v4, v150 offset:50704
    ds_write_b32 v4, v152 offset:50720
    s_waitcnt lgkmcnt(12)
    v_pk_add_f32 v[154:155], v[154:155], v[244:245]
    v_cvt_pk_bf16_f32 v154, v154, v155
    v_pk_add_f32 v[156:157], v[156:157], v[246:247]
    v_cvt_pk_bf16_f32 v156, v156, v157
    v_pk_add_f32 v[158:159], v[158:159], v[248:249]
    v_cvt_pk_bf16_f32 v158, v158, v159
    ds_write_b32 v4, v154 offset:4224
    ds_write_b32 v4, v156 offset:4240
    ds_write_b32 v4, v158 offset:4256
    s_waitcnt lgkmcnt(12)
    v_pk_add_f32 v[220:221], v[220:221], v[250:251]
    v_cvt_pk_bf16_f32 v220, v220, v221
    v_pk_add_f32 v[222:223], v[222:223], v[252:253]
    v_cvt_pk_bf16_f32 v222, v222, v223
    v_pk_add_f32 v[224:225], v[224:225], v[254:255]
HOP1_34:
    s_cbranch_execz HOP1_35
    v_cvt_pk_bf16_f32 v224, v224, v225
    ds_write_b32 v4, v220 offset:29568
    ds_write_b32 v4, v222 offset:29584
    ds_write_b32 v4, v224 offset:29600
    s_waitcnt lgkmcnt(0)
    s_barrier
    ds_read_b128 v[76:79], v5 offset:0
    ds_read_b128 v[80:83], v5 offset:25344
    ds_read_b128 v[84:87], v5 offset:50688
    ds_read_b128 v[88:91], v5 offset:4224
    ds_read_b128 v[92:95], v5 offset:29568
    s_mov_b32 s54, 86016
    s_waitcnt lgkmcnt(4)
    buffer_store_dwordx4 v[76:79], v15, s[36:39], s54 offen sc1
    s_mov_b32 s54, 215040
    s_waitcnt lgkmcnt(3)
    buffer_store_dwordx4 v[80:83], v15, s[36:39], s54 offen sc1
    s_mov_b32 s54, 344064
    s_waitcnt lgkmcnt(2)
    buffer_store_dwordx4 v[84:87], v15, s[36:39], s54 offen sc1
    s_mov_b32 s54, 473088
    s_waitcnt lgkmcnt(1)
    buffer_store_dwordx4 v[88:91], v15, s[36:39], s54 offen sc1
    v_add_u32 v15, 602112, v15
    s_waitcnt lgkmcnt(0)
    buffer_store_dwordx4 v[92:95], v15, s[36:39], 0 offen sc1
L_END:
    s_endpgm
L_HELP:
    s_barrier
    s_mov_b32 s54, 0x51371d03
    s_mov_b32 s55, 0x51371d03
    s_lshl_b32 s56, s52, 3
    s_lshr_b64 s[54:55], s[54:55], s56
    s_and_b32 s54, s54, 0xff
    s_add_u32 s56, s54, s57
    s_sub_u32 s56, s56, 8
    s_mul_i32 s54, s56, 9363
    s_lshr_b32 s54, s54, 16
    s_lshr_b32 s55, s52, 2
    s_sub_u32 s55, s55, s54
    s_mul_i32 s55, s55, 7
    s_add_u32 s55, s55, s56
    s_mul_i32 s49, s54, 15
    s_lshl_b32 s50, s55, 4
    s_load_dwordx2 s[36:37], s[0:1], 32
    s_load_dwordx2 s[40:41], s[0:1], 40
    s_load_dwordx2 s[44:45], s[0:1], 48
    s_mov_b32 s38, 9633792
    s_mov_b32 s39, 0x20000
    s_mov_b32 s42, 256
    s_mov_b32 s43, 0x20000
    s_mov_b32 s46, 268435456
    s_mov_b32 s47, 0x20000
    s_lshr_b32 s19, s18, 1
    s_and_b32 s48, s18, 1
    s_mov_b32 s59, 7872
    s_mov_b32 s68, 0x3ec80000
    s_mov_b32 s69, s68
    s_mov_b32 s62, 0x3fc00000
    s_mov_b32 s63, s62
    s_mov_b32 s66, 0x40100000
    s_mov_b32 s67, s66
    s_mov_b32 s64, 0x3f200000
    s_mov_b32 s65, s64
    s_mov_b32 s70, 0x404048d1
    s_mov_b32 s71, s70
    s_mov_b32 s74, 0x40290000
    s_mov_b32 s75, s74
    s_mov_b32 s72, 0x3f91a2b4
    s_mov_b32 s73, s72
    s_mov_b32 s76, 0x3f610000
    s_mov_b32 s77, s76
    s_mul_i32 s11, s19, 4224
    s_mul_i32 s51, s18, 356352
    s_add_u32 s51, s51, 3072
    v_lshrrev_b32 v232, 1, v3
    v_mul_u32_u24 v232, 2112, v232
    v_and_b32 v233, 1, v3
    v_lshl_add_u32 v232, v233, 4, v232
    v_mul_u32_u24 v9, 96, v2
    v_add3_u32 v9, v9, v232, s11
    v_add_u32 v10, 76032, v9
    v_add_u32 v11, s51, v11
    s_waitcnt lgkmcnt(0)
    s_barrier
    s_mov_b64 exec, 0
    s_branch HOP1_0
HOPRET1:
    s_mov_b64 exec, -1
    v_mov_b32 v234, 0
    s_mov_b32 s54, -1
    s_mov_b32 s55, -1
    s_mov_b32 s52, 0x400000
L_POLLC:
    buffer_load_dword v235, v234, s[40:43], 0 offen sc1
    s_waitcnt vmcnt(0)
    v_cmp_eq_u32 vcc, 42, v235
    s_nop 0
    s_cmp_eq_u64 vcc, s[54:55]
    s_cbranch_scc1 L_POLLEDC
    s_sleep 2
    s_sub_u32 s52, s52, 1
    s_cmp_lg_u32 s52, 0
    s_cbranch_scc1 L_POLLC
    s_branch L_POLLEDC
.p2align 8
L_REVB:
.p2align 3
HOP1_0:
    s_cbranch_execz HOP1_1
    s_nop 0
    v_pk_fma_f32 v[192:193], v[64:65], s[68:69], v[112:113] neg_lo:[0,1,0] neg_hi:[0,1,0]
    v_pk_fma_f32 v[194:195], v[66:67], s[68:69], v[114:115] neg_lo:[0,1,0] neg_hi:[0,1,0]
    v_pk_fma_f32 v[196:197], v[68:69], s[68:69], v[116:117] neg_lo:[0,1,0] neg_hi:[0,1,0]
    v_pk_fma_f32 v[198:199], v[70:71], s[68:69], v[118:119] neg_lo:[0,1,0] neg_hi:[0,1,0]
    v_pk_fma_f32 v[200:201], v[40:41], s[68:69], v[88:89] neg_lo:[0,1,0] neg_hi:[0,1,0]
    v_pk_fma_f32 v[202:203], v[42:43], s[68:69], v[90:91] neg_lo:[0,1,0] neg_hi:[0,1,0]
    v_pk_fma_f32 v[204:205], v[44:45], s[68:69], v[92:93] neg_lo:[0,1,0] neg_hi:[0,1,0]
    v_pk_fma_f32 v[206:207], v[46:47], s[68:69], v[94:95] neg_lo:[0,1,0] neg_hi:[0,1,0]
    v_pk_fma_f32 v[160:161], v[200:201], s[62:63], v[192:193]
    v_pk_fma_f32 v[162:163], v[202:203], s[62:63], v[194:195]
    v_pk_fma_f32 v[164:165], v[204:205], s[62:63], v[196:197]
    v_pk_fma_f32 v[166:167], v[206:207], s[62:63], v[198:199]
    v_pk_fma_f32 v[168:169], v[200:201], s[62:63], v[192:193] neg_lo:[0,1,0] neg_hi:[0,1,0]
    v_pk_fma_f32 v[170:171], v[202:203], s[62:63], v[194:195] neg_lo:[0,1,0] neg_hi:[0,1,0]
    v_pk_fma_f32 v[172:173], v[204:205], s[62:63], v[196:197] neg_lo:[0,1,0] neg_hi:[0,1,0]
    v_pk_fma_f32 v[174:175], v[206:207], s[62:63], v[198:199] neg_lo:[0,1,0] neg_hi:[0,1,0]
    v_pk_fma_f32 v[192:193], v[64:65], s[66:67], v[112:113] neg_lo:[0,1,0] neg_hi:[0,1,0]
    v_pk_fma_f32 v[194:195], v[66:67], s[66:67], v[114:115] neg_lo:[0,1,0] neg_hi:[0,1,0]
    v_pk_fma_f32 v[196:197], v[68:69], s[66:67], v[116:117] neg_lo:[0,1,0] neg_hi:[0,1,0]
    v_pk_fma_f32 v[198:199], v[70:71], s[66:67], v[118:119] neg_lo:[0,1,0] neg_hi:[0,1,0]
    v_pk_fma_f32 v[200:201], v[40:41], s[66:67], v[88:89] neg_lo:[0,1,0] neg_hi:[0,1,0]
    v_pk_fma_f32 v[202:203], v[42:43], s[66:67], v[90:91] neg_lo:[0,1,0] neg_hi:[0,1,0]
    v_pk_fma_f32 v[204:205], v[44:45], s[66:67], v[92:93] neg_lo:[0,1,0] neg_hi:[0,1,0]
    v_pk_fma_f32 v[206:207], v[46:47], s[66:67], v[94:95] neg_lo:[0,1,0] neg_hi:[0,1,0]
    buffer_load_dwordx4 a[180:183], v4, s[20:23], 0 offen offset:0
    buffer_load_dwordx4 a[184:187], v4, s[20:23], 0 offen offset:64
    buffer_load_dwordx4 a[188:191], v4, s[20:23], 0 offen offset:128
    v_add_u32 v4, 43008, v4
    v_pk_fma_f32 v[176:177], v[200:201], s[64:65], v[192:193]
    v_pk_fma_f32 v[178:179], v[202:203], s[64:65], v[194:195]
    v_pk_fma_f32 v[180:181], v[204:205], s[64:65], v[196:197]
    v_pk_fma_f32 v[182:183], v[206:207], s[64:65], v[198:199]
    v_pk_fma_f32 v[184:185], v[200:201], s[64:65], v[192:193] neg_lo:[0,1,0] neg_hi:[0,1,0]
    v_pk_fma_f32 v[186:187], v[202:203], s[64:65], v[194:195] neg_lo:[0,1,0] neg_hi:[0,1,0]
    v_pk_fma_f32 v[188:189], v[204:205], s[64:65], v[196:197] neg_lo:[0,1,0] neg_hi:[0,1,0]
    v_pk_fma_f32 v[190:191], v[206:207], s[64:65], v[198:199] neg_lo:[0,1,0] neg_hi:[0,1,0]
    v_pk_fma_f32 v[192:193], v[64:65], s[70:71], v[16:17] neg_lo:[0,1,0] neg_hi:[0,1,0]
    v_pk_fma_f32 v[194:195], v[66:67], s[70:71], v[18:19] neg_lo:[0,1,0] neg_hi:[0,1,0]
    v_pk_fma_f32 v[196:197], v[68:69], s[70:71], v[20:21] neg_lo:[0,1,0] neg_hi:[0,1,0]
    v_pk_fma_f32 v[198:199], v[70:71], s[70:71], v[22:23] neg_lo:[0,1,0] neg_hi:[0,1,0]
    v_pk_fma_f32 v[200:201], v[88:89], s[74:75], v[136:137] neg_lo:[0,1,0] neg_hi:[0,1,0]
    v_pk_fma_f32 v[202:203], v[90:91], s[74:75], v[138:139] neg_lo:[0,1,0] neg_hi:[0,1,0]
    v_pk_fma_f32 v[204:205], v[92:93], s[74:75], v[140:141] neg_lo:[0,1,0] neg_hi:[0,1,0]
    v_pk_fma_f32 v[206:207], v[94:95], s[74:75], v[142:143] neg_lo:[0,1,0] neg_hi:[0,1,0]
    v_pk_fma_f32 v[192:193], v[112:113], s[72:73], v[192:193]
    v_pk_fma_f32 v[194:195], v[114:115], s[72:73], v[194:195]
    v_pk_fma_f32 v[196:197], v[116:117], s[72:73], v[196:197]
    v_pk_fma_f32 v[198:199], v[118:119], s[72:73], v[198:199]
    v_pk_fma_f32 v[200:201], v[40:41], s[76:77], v[200:201]
    v_pk_fma_f32 v[202:203], v[42:43], s[76:77], v[202:203]
    v_pk_fma_f32 v[204:205], v[44:45], s[76:77], v[204:205]
    v_pk_fma_f32 v[206:207], v[46:47], s[76:77], v[206:207]
    s_waitcnt lgkmcnt(2)
    v_mul_u32_u24 v88, v252, v208
    v_and_b32 v89, v253, v208
    v_mul_u32_u24 v90, v252, v209
    v_and_b32 v91, v253, v209
    v_mul_u32_u24 v92, v252, v210
    v_and_b32 v93, v253, v210
    v_mul_u32_u24 v94, v252, v211
    v_and_b32 v95, v253, v211
    s_waitcnt lgkmcnt(1)
    v_mul_u32_u24 v112, v252, v212
    v_and_b32 v113, v253, v212
    v_mul_u32_u24 v114, v252, v213
    v_and_b32 v115, v253, v213
    v_mul_u32_u24 v116, v252, v214
    v_and_b32 v117, v253, v214
    v_mul_u32_u24 v118, v252, v215
    v_and_b32 v119, v253, v215
    s_waitcnt lgkmcnt(0)
    v_mul_u32_u24 v136, v252, v216
    v_and_b32 v137, v253, v216
    v_mul_u32_u24 v138, v252, v217
    v_and_b32 v139, v253, v217
    v_mul_u32_u24 v140, v252, v218
    v_and_b32 v141, v253, v218
    v_mul_u32_u24 v142, v252, v219
    v_and_b32 v143, v253, v219
    ds_read_b128 v[220:223], v5 offset:6976
    ds_read_b128 v[224:227], v6 offset:6976
    ds_read_b128 v[228:231], v5 offset:9280
    s_waitcnt vmcnt(11)
    v_mfma_f32_16x16x32_bf16 v[88:91], a[0:3], a[144:147], v[88:91]
    v_cvt_pk_bf16_f32 v192, v192, v193
    v_cvt_pk_bf16_f32 v193, v194, v195
    v_mfma_f32_16x16x32_bf16 v[92:95], a[12:15], a[144:147], v[92:95]
    s_waitcnt vmcnt(8)
    v_cvt_pk_bf16_f32 v194, v196, v197
    v_cvt_pk_bf16_f32 v195, v198, v199
    v_mfma_f32_16x16x32_bf16 v[112:115], a[0:3], a[156:159], v[112:115]
    ds_write_b128 v8, v[192:195] offset:16896
    v_mfma_f32_16x16x32_bf16 v[116:119], a[12:15], a[156:159], v[116:119]
    s_waitcnt vmcnt(5)
    v_cvt_pk_bf16_f32 v200, v200, v201
    v_cvt_pk_bf16_f32 v201, v202, v203
    v_mfma_f32_16x16x32_bf16 v[136:139], a[0:3], a[168:171], v[136:139]
    v_cvt_pk_bf16_f32 v202, v204, v205
    v_cvt_pk_bf16_f32 v203, v206, v207
    v_mfma_f32_16x16x32_bf16 v[140:143], a[12:15], a[168:171], v[140:143]
    ds_write_b128 v8, v[200:203] offset:21120
    v_mfma_f32_16x16x32_bf16 v[88:91], a[4:7], a[148:151], v[88:91]
    v_cvt_pk_bf16_f32 v160, v160, v161
    v_cvt_pk_bf16_f32 v161, v162, v163
    v_mfma_f32_16x16x32_bf16 v[92:95], a[16:19], a[148:151], v[92:95]
    v_cvt_pk_bf16_f32 v162, v164, v165
    v_cvt_pk_bf16_f32 v163, v166, v167
    v_mfma_f32_16x16x32_bf16 v[112:115], a[4:7], a[160:163], v[112:115]
    ds_write_b128 v8, v[160:163] offset:0
    v_mfma_f32_16x16x32_bf16 v[116:119], a[16:19], a[160:163], v[116:119]
    s_waitcnt vmcnt(4)
    v_cvt_pk_bf16_f32 v168, v168, v169
    v_cvt_pk_bf16_f32 v169, v170, v171
    v_mfma_f32_16x16x32_bf16 v[136:139], a[4:7], a[172:175], v[136:139]
    v_cvt_pk_bf16_f32 v170, v172, v173
    v_cvt_pk_bf16_f32 v171, v174, v175
    v_mfma_f32_16x16x32_bf16 v[140:143], a[16:19], a[172:175], v[140:143]
    ds_write_b128 v8, v[168:171] offset:4224
    v_mfma_f32_16x16x32_bf16 v[88:91], a[8:11], a[152:155], v[88:91]
    v_cvt_pk_bf16_f32 v176, v176, v177
    v_cvt_pk_bf16_f32 v177, v178, v179
    v_mfma_f32_16x16x32_bf16 v[92:95], a[20:23], a[152:155], v[92:95]
    v_cvt_pk_bf16_f32 v178, v180, v181
    v_cvt_pk_bf16_f32 v179, v182, v183
    v_mfma_f32_16x16x32_bf16 v[112:115], a[8:11], a[164:167], v[112:115]
    ds_write_b128 v8, v[176:179] offset:8448
    v_mfma_f32_16x16x32_bf16 v[116:119], a[20:23], a[164:167], v[116:119]
    s_waitcnt vmcnt(3)
    v_cvt_pk_bf16_f32 v184, v184, v185
    v_cvt_pk_bf16_f32 v185, v186, v187
    v_mfma_f32_16x16x32_bf16 v[136:139], a[8:11], a[176:179], v[136:139]
    v_cvt_pk_bf16_f32 v186, v188, v189
    v_cvt_pk_bf16_f32 v187, v190, v191
    v_mfma_f32_16x16x32_bf16 v[140:143], a[20:23], a[176:179], v[140:143]
    ds_write_b128 v8, v[184:187] offset:12672
.p2align 3
    v_pk_fma_f32 v[192:193], v[72:73], s[68:69], v[120:121] neg_lo:[0,1,0] neg_hi:[0,1,0]
    v_pk_fma_f32 v[194:195], v[74:75], s[68:69], v[122:123] neg_lo:[0,1,0] neg_hi:[0,1,0]
    v_pk_fma_f32 v[196:197], v[76:77], s[68:69], v[124:125] neg_lo:[0,1,0] neg_hi:[0,1,0]
    v_pk_fma_f32 v[198:199], v[78:79], s[68:69], v[126:127] neg_lo:[0,1,0] neg_hi:[0,1,0]
    v_pk_fma_f32 v[200:201], v[48:49], s[68:69], v[96:97] neg_lo:[0,1,0] neg_hi:[0,1,0]
    v_pk_fma_f32 v[202:203], v[50:51], s[68:69], v[98:99] neg_lo:[0,1,0] neg_hi:[0,1,0]
    v_pk_fma_f32 v[204:205], v[52:53], s[68:69], v[100:101] neg_lo:[0,1,0] neg_hi:[0,1,0]
    v_pk_fma_f32 v[206:207], v[54:55], s[68:69], v[102:103] neg_lo:[0,1,0] neg_hi:[0,1,0]
    v_pk_fma_f32 v[160:161], v[200:201], s[62:63], v[192:193]
    v_pk_fma_f32 v[162:163], v[202:203], s[62:63], v[194:195]
    v_pk_fma_f32 v[164:165], v[204:205], s[62:63], v[196:197]
    v_pk_fma_f32 v[166:167], v[206:207], s[62:63], v[198:199]
    v_pk_fma_f32 v[168:169], v[200:201], s[62:63], v[192:193] neg_lo:[0,1,0] neg_hi:[0,1,0]
    v_pk_fma_f32 v[170:171], v[202:203], s[62:63], v[194:195] neg_lo:[0,1,0] neg_hi:[0,1,0]
    v_pk_fma_f32 v[172:173], v[204:205], s[62:63], v[196:197] neg_lo:[0,1,0] neg_hi:[0,1,0]
    v_pk_fma_f32 v[174:175], v[206:207], s[62:63], v[198:199] neg_lo:[0,1,0] neg_hi:[0,1,0]
    v_pk_fma_f32 v[192:193], v[72:73], s[66:67], v[120:121] neg_lo:[0,1,0] neg_hi:[0,1,0]
    v_pk_fma_f32 v[194:195], v[74:75], s[66:67], v[122:123] neg_lo:[0,1,0] neg_hi:[0,1,0]
    v_pk_fma_f32 v[196:197], v[76:77], s[66:67], v[124:125] neg_lo:[0,1,0] neg_hi:[0,1,0]
    v_pk_fma_f32 v[198:199], v[78:79], s[66:67], v[126:127] neg_lo:[0,1,0] neg_hi:[0,1,0]
    v_pk_fma_f32 v[200:201], v[48:49], s[66:67], v[96:97] neg_lo:[0,1,0] neg_hi:[0,1,0]
    v_pk_fma_f32 v[202:203], v[50:51], s[66:67], v[98:99] neg_lo:[0,1,0] neg_hi:[0,1,0]
    v_pk_fma_f32 v[204:205], v[52:53], s[66:67], v[100:101] neg_lo:[0,1,0] neg_hi:[0,1,0]
    v_pk_fma_f32 v[206:207], v[54:55], s[66:67], v[102:103] neg_lo:[0,1,0] neg_hi:[0,1,0]
    buffer_load_dwordx4 a[192:195], v4, s[20:23], 0 offen offset:0
    buffer_load_dwordx4 a[196:199], v4, s[20:23], 0 offen offset:64
    buffer_load_dwordx4 a[200:203], v4, s[20:23], 0 offen offset:128
    v_add_u32 v4, 43008, v4
    v_pk_fma_f32 v[176:177], v[200:201], s[64:65], v[192:193]
    v_pk_fma_f32 v[178:179], v[202:203], s[64:65], v[194:195]
    v_pk_fma_f32 v[180:181], v[204:205], s[64:65], v[196:197]
    v_pk_fma_f32 v[182:183], v[206:207], s[64:65], v[198:199]
    v_pk_fma_f32 v[184:185], v[200:201], s[64:65], v[192:193] neg_lo:[0,1,0] neg_hi:[0,1,0]
    v_pk_fma_f32 v[186:187], v[202:203], s[64:65], v[194:195] neg_lo:[0,1,0] neg_hi:[0,1,0]
    v_pk_fma_f32 v[188:189], v[204:205], s[64:65], v[196:197] neg_lo:[0,1,0] neg_hi:[0,1,0]
    v_pk_fma_f32 v[190:191], v[206:207], s[64:65], v[198:199] neg_lo:[0,1,0] neg_hi:[0,1,0]
    v_pk_fma_f32 v[192:193], v[72:73], s[70:71], v[24:25] neg_lo:[0,1,0] neg_hi:[0,1,0]
    v_pk_fma_f32 v[194:195], v[74:75], s[70:71], v[26:27] neg_lo:[0,1,0] neg_hi:[0,1,0]
    v_pk_fma_f32 v[196:197], v[76:77], s[70:71], v[28:29] neg_lo:[0,1,0] neg_hi:[0,1,0]
    v_pk_fma_f32 v[198:199], v[78:79], s[70:71], v[30:31] neg_lo:[0,1,0] neg_hi:[0,1,0]
    v_pk_fma_f32 v[200:201], v[96:97], s[74:75], v[144:145] neg_lo:[0,1,0] neg_hi:[0,1,0]
    v_pk_fma_f32 v[202:203], v[98:99], s[74:75], v[146:147] neg_lo:[0,1,0] neg_hi:[0,1,0]
    v_pk_fma_f32 v[204:205], v[100:101], s[74:75], v[148:149] neg_lo:[0,1,0] neg_hi:[0,1,0]
    v_pk_fma_f32 v[206:207], v[102:103], s[74:75], v[150:151] neg_lo:[0,1,0] neg_hi:[0,1,0]
    v_pk_fma_f32 v[192:193], v[120:121], s[72:73], v[192:193]
    v_pk_fma_f32 v[194:195], v[122:123], s[72:73], v[194:195]
    v_pk_fma_f32 v[196:197], v[124:125], s[72:73], v[196:197]
    v_pk_fma_f32 v[198:199], v[126:127], s[72:73], v[198:199]
    v_pk_fma_f32 v[200:201], v[48:49], s[76:77], v[200:201]
    v_pk_fma_f32 v[202:203], v[50:51], s[76:77], v[202:203]
    v_pk_fma_f32 v[204:205], v[52:53], s[76:77], v[204:205]
    v_pk_fma_f32 v[206:207], v[54:55], s[76:77], v[206:207]
    s_waitcnt lgkmcnt(8)
    v_mul_u32_u24 v96, v252, v220
    v_and_b32 v97, v253, v220
    v_mul_u32_u24 v98, v252, v221
    v_and_b32 v99, v253, v221
    v_mul_u32_u24 v100, v252, v222
    v_and_b32 v101, v253, v222
    v_mul_u32_u24 v102, v252, v223
    v_and_b32 v103, v253, v223
    s_waitcnt lgkmcnt(7)
    v_mul_u32_u24 v120, v252, v224
    v_and_b32 v121, v253, v224
    v_mul_u32_u24 v122, v252, v225
    v_and_b32 v123, v253, v225
    v_mul_u32_u24 v124, v252, v226
    v_and_b32 v125, v253, v226
    v_mul_u32_u24 v126, v252, v227
    v_and_b32 v127, v253, v227
    s_waitcnt lgkmcnt(6)
    v_mul_u32_u24 v144, v252, v228
    v_and_b32 v145, v253, v228
    v_mul_u32_u24 v146, v252, v229
    v_and_b32 v147, v253, v229
    v_mul_u32_u24 v148, v252, v230
    v_and_b32 v149, v253, v230
    v_mul_u32_u24 v150, v252, v231
    v_and_b32 v151, v253, v231
    ds_read_b128 v[208:211], v5 offset:7040
    ds_read_b128 v[212:215], v6 offset:7040
    ds_read_b128 v[216:219], v5 offset:9344
    v_mfma_f32_16x16x32_bf16 v[96:99], a[24:27], a[144:147], v[96:99]
    v_cvt_pk_bf16_f32 v192, v192, v193
    v_cvt_pk_bf16_f32 v193, v194, v195
    v_mfma_f32_16x16x32_bf16 v[100:103], a[36:39], a[144:147], v[100:103]
    v_cvt_pk_bf16_f32 v194, v196, v197
    v_cvt_pk_bf16_f32 v195, v198, v199
    v_mfma_f32_16x16x32_bf16 v[120:123], a[24:27], a[156:159], v[120:123]
    ds_write_b128 v8, v[192:195] offset:16928
    v_mfma_f32_16x16x32_bf16 v[124:127], a[36:39], a[156:159], v[124:127]
    v_cvt_pk_bf16_f32 v200, v200, v201
    v_cvt_pk_bf16_f32 v201, v202, v203
    v_mfma_f32_16x16x32_bf16 v[144:147], a[24:27], a[168:171], v[144:147]
    v_cvt_pk_bf16_f32 v202, v204, v205
    v_cvt_pk_bf16_f32 v203, v206, v207
    v_mfma_f32_16x16x32_bf16 v[148:151], a[36:39], a[168:171], v[148:151]
    ds_write_b128 v8, v[200:203] offset:21152
    v_mfma_f32_16x16x32_bf16 v[96:99], a[28:31], a[148:151], v[96:99]
    v_cvt_pk_bf16_f32 v160, v160, v161
    v_cvt_pk_bf16_f32 v161, v162, v163
    v_mfma_f32_16x16x32_bf16 v[100:103], a[40:43], a[148:151], v[100:103]
    v_cvt_pk_bf16_f32 v162, v164, v165
    v_cvt_pk_bf16_f32 v163, v166, v167
    v_mfma_f32_16x16x32_bf16 v[120:123], a[28:31], a[160:163], v[120:123]
    ds_write_b128 v8, v[160:163] offset:32
    v_mfma_f32_16x16x32_bf16 v[124:127], a[40:43], a[160:163], v[124:127]
    v_cvt_pk_bf16_f32 v168, v168, v169
    v_cvt_pk_bf16_f32 v169, v170, v171
    v_mfma_f32_16x16x32_bf16 v[144:147], a[28:31], a[172:175], v[144:147]
    v_cvt_pk_bf16_f32 v170, v172, v173
    v_cvt_pk_bf16_f32 v171, v174, v175
    v_mfma_f32_16x16x32_bf16 v[148:151], a[40:43], a[172:175], v[148:151]
    ds_write_b128 v8, v[168:171] offset:4256
    v_mfma_f32_16x16x32_bf16 v[96:99], a[32:35], a[152:155], v[96:99]
    v_cvt_pk_bf16_f32 v176, v176, v177
    v_cvt_pk_bf16_f32 v177, v178, v179
    v_mfma_f32_16x16x32_bf16 v[100:103], a[44:47], a[152:155], v[100:103]
    v_cvt_pk_bf16_f32 v178, v180, v181
    v_cvt_pk_bf16_f32 v179, v182, v183
    v_mfma_f32_16x16x32_bf16 v[120:123], a[32:35], a[164:167], v[120:123]
    ds_write_b128 v8, v[176:179] offset:8480
    v_mfma_f32_16x16x32_bf16 v[124:127], a[44:47], a[164:167], v[124:127]
    v_cvt_pk_bf16_f32 v184, v184, v185
    v_cvt_pk_bf16_f32 v185, v186, v187
    v_mfma_f32_16x16x32_bf16 v[144:147], a[32:35], a[176:179], v[144:147]
    v_cvt_pk_bf16_f32 v186, v188, v189
    v_cvt_pk_bf16_f32 v187, v190, v191
    v_mfma_f32_16x16x32_bf16 v[148:151], a[44:47], a[176:179], v[148:151]
    ds_write_b128 v8, v[184:187] offset:12704
.p2align 3
    v_pk_fma_f32 v[192:193], v[80:81], s[68:69], v[128:129] neg_lo:[0,1,0] neg_hi:[0,1,0]
    v_pk_fma_f32 v[194:195], v[82:83], s[68:69], v[130:131] neg_lo:[0,1,0] neg_hi:[0,1,0]
    v_pk_fma_f32 v[196:197], v[84:85], s[68:69], v[132:133] neg_lo:[0,1,0] neg_hi:[0,1,0]
    v_pk_fma_f32 v[198:199], v[86:87], s[68:69], v[134:135] neg_lo:[0,1,0] neg_hi:[0,1,0]
    v_pk_fma_f32 v[200:201], v[56:57], s[68:69], v[104:105] neg_lo:[0,1,0] neg_hi:[0,1,0]
    v_pk_fma_f32 v[202:203], v[58:59], s[68:69], v[106:107] neg_lo:[0,1,0] neg_hi:[0,1,0]
    v_pk_fma_f32 v[204:205], v[60:61], s[68:69], v[108:109] neg_lo:[0,1,0] neg_hi:[0,1,0]
    v_pk_fma_f32 v[206:207], v[62:63], s[68:69], v[110:111] neg_lo:[0,1,0] neg_hi:[0,1,0]
    v_pk_fma_f32 v[160:161], v[200:201], s[62:63], v[192:193]
    v_pk_fma_f32 v[162:163], v[202:203], s[62:63], v[194:195]
    v_pk_fma_f32 v[164:165], v[204:205], s[62:63], v[196:197]
    v_pk_fma_f32 v[166:167], v[206:207], s[62:63], v[198:199]
    v_pk_fma_f32 v[168:169], v[200:201], s[62:63], v[192:193] neg_lo:[0,1,0] neg_hi:[0,1,0]
    v_pk_fma_f32 v[170:171], v[202:203], s[62:63], v[194:195] neg_lo:[0,1,0] neg_hi:[0,1,0]
    v_pk_fma_f32 v[172:173], v[204:205], s[62:63], v[196:197] neg_lo:[0,1,0] neg_hi:[0,1,0]
    v_pk_fma_f32 v[174:175], v[206:207], s[62:63], v[198:199] neg_lo:[0,1,0] neg_hi:[0,1,0]
    v_pk_fma_f32 v[192:193], v[80:81], s[66:67], v[128:129] neg_lo:[0,1,0] neg_hi:[0,1,0]
    v_pk_fma_f32 v[194:195], v[82:83], s[66:67], v[130:131] neg_lo:[0,1,0] neg_hi:[0,1,0]
    v_pk_fma_f32 v[196:197], v[84:85], s[66:67], v[132:133] neg_lo:[0,1,0] neg_hi:[0,1,0]
    v_pk_fma_f32 v[198:199], v[86:87], s[66:67], v[134:135] neg_lo:[0,1,0] neg_hi:[0,1,0]
    v_pk_fma_f32 v[200:201], v[56:57], s[66:67], v[104:105] neg_lo:[0,1,0] neg_hi:[0,1,0]
    v_pk_fma_f32 v[202:203], v[58:59], s[66:67], v[106:107] neg_lo:[0,1,0] neg_hi:[0,1,0]
    v_pk_fma_f32 v[204:205], v[60:61], s[66:67], v[108:109] neg_lo:[0,1,0] neg_hi:[0,1,0]
    v_pk_fma_f32 v[206:207], v[62:63], s[66:67], v[110:111] neg_lo:[0,1,0] neg_hi:[0,1,0]
    buffer_load_dwordx4 a[204:207], v4, s[20:23], 0 offen offset:0
    buffer_load_dwordx4 a[208:211], v4, s[20:23], 0 offen offset:64
    buffer_load_dwordx4 a[212:215], v4, s[20:23], 0 offen offset:128
    v_add_u32 v4, 43008, v4
    v_pk_fma_f32 v[176:177], v[200:201], s[64:65], v[192:193]
    v_pk_fma_f32 v[178:179], v[202:203], s[64:65], v[194:195]
    v_pk_fma_f32 v[180:181], v[204:205], s[64:65], v[196:197]
    v_pk_fma_f32 v[182:183], v[206:207], s[64:65], v[198:199]
    v_pk_fma_f32 v[184:185], v[200:201], s[64:65], v[192:193] neg_lo:[0,1,0] neg_hi:[0,1,0]
    v_pk_fma_f32 v[186:187], v[202:203], s[64:65], v[194:195] neg_lo:[0,1,0] neg_hi:[0,1,0]
    v_pk_fma_f32 v[188:189], v[204:205], s[64:65], v[196:197] neg_lo:[0,1,0] neg_hi:[0,1,0]
    v_pk_fma_f32 v[190:191], v[206:207], s[64:65], v[198:199] neg_lo:[0,1,0] neg_hi:[0,1,0]
    v_pk_fma_f32 v[192:193], v[80:81], s[70:71], v[32:33] neg_lo:[0,1,0] neg_hi:[0,1,0]
    v_pk_fma_f32 v[194:195], v[82:83], s[70:71], v[34:35] neg_lo:[0,1,0] neg_hi:[0,1,0]
    v_pk_fma_f32 v[196:197], v[84:85], s[70:71], v[36:37] neg_lo:[0,1,0] neg_hi:[0,1,0]
    v_pk_fma_f32 v[198:199], v[86:87], s[70:71], v[38:39] neg_lo:[0,1,0] neg_hi:[0,1,0]
    v_pk_fma_f32 v[200:201], v[104:105], s[74:75], v[152:153] neg_lo:[0,1,0] neg_hi:[0,1,0]
    v_pk_fma_f32 v[202:203], v[106:107], s[74:75], v[154:155] neg_lo:[0,1,0] neg_hi:[0,1,0]
    v_pk_fma_f32 v[204:205], v[108:109], s[74:75], v[156:157] neg_lo:[0,1,0] neg_hi:[0,1,0]
    v_pk_fma_f32 v[206:207], v[110:111], s[74:75], v[158:159] neg_lo:[0,1,0] neg_hi:[0,1,0]
    v_pk_fma_f32 v[192:193], v[128:129], s[72:73], v[192:193]
    v_pk_fma_f32 v[194:195], v[130:131], s[72:73], v[194:195]
    v_pk_fma_f32 v[196:197], v[132:133], s[72:73], v[196:197]
    v_pk_fma_f32 v[198:199], v[134:135], s[72:73], v[198:199]
    v_pk_fma_f32 v[200:201], v[56:57], s[76:77], v[200:201]
    v_pk_fma_f32 v[202:203], v[58:59], s[76:77], v[202:203]
    v_pk_fma_f32 v[204:205], v[60:61], s[76:77], v[204:205]
    v_pk_fma_f32 v[206:207], v[62:63], s[76:77], v[206:207]
    s_waitcnt lgkmcnt(8)
    v_mul_u32_u24 v104, v252, v208
    v_and_b32 v105, v253, v208
    v_mul_u32_u24 v106, v252, v209
    v_and_b32 v107, v253, v209
    v_mul_u32_u24 v108, v252, v210
    v_and_b32 v109, v253, v210
    v_mul_u32_u24 v110, v252, v211
    v_and_b32 v111, v253, v211
    s_waitcnt lgkmcnt(7)
    v_mul_u32_u24 v128, v252, v212
    v_and_b32 v129, v253, v212
    v_mul_u32_u24 v130, v252, v213
    v_and_b32 v131, v253, v213
    v_mul_u32_u24 v132, v252, v214
    v_and_b32 v133, v253, v214
    v_mul_u32_u24 v134, v252, v215
    v_and_b32 v135, v253, v215
    s_waitcnt lgkmcnt(6)
    v_mul_u32_u24 v152, v252, v216
    v_and_b32 v153, v253, v216
    v_mul_u32_u24 v154, v252, v217
    v_and_b32 v155, v253, v217
    v_mul_u32_u24 v156, v252, v218
    v_and_b32 v157, v253, v218
    v_mul_u32_u24 v158, v252, v219
    v_and_b32 v159, v253, v219
    v_add_u32 v5, s9, v5
    v_add_u32 v6, s9, v6
    ds_read_b128 v[220:223], v6 offset:9216
    ds_read_b128 v[224:227], v5 offset:11520
    ds_read_b128 v[228:231], v6 offset:11520
    v_mfma_f32_16x16x32_bf16 v[104:107], a[48:51], a[144:147], v[104:107]
    v_cvt_pk_bf16_f32 v192, v192, v193
    v_cvt_pk_bf16_f32 v193, v194, v195
    v_mfma_f32_16x16x32_bf16 v[108:111], a[60:63], a[144:147], v[108:111]
    v_cvt_pk_bf16_f32 v194, v196, v197
    v_cvt_pk_bf16_f32 v195, v198, v199
    v_mfma_f32_16x16x32_bf16 v[128:131], a[48:51], a[156:159], v[128:131]
    ds_write_b128 v8, v[192:195] offset:16960
    v_mfma_f32_16x16x32_bf16 v[132:135], a[60:63], a[156:159], v[132:135]
    v_cvt_pk_bf16_f32 v200, v200, v201
    v_cvt_pk_bf16_f32 v201, v202, v203
    v_mfma_f32_16x16x32_bf16 v[152:155], a[48:51], a[168:171], v[152:155]
    v_cvt_pk_bf16_f32 v202, v204, v205
    v_cvt_pk_bf16_f32 v203, v206, v207
    v_mfma_f32_16x16x32_bf16 v[156:159], a[60:63], a[168:171], v[156:159]
    ds_write_b128 v8, v[200:203] offset:21184
    v_mfma_f32_16x16x32_bf16 v[104:107], a[52:55], a[148:151], v[104:107]
    v_cvt_pk_bf16_f32 v160, v160, v161
    v_cvt_pk_bf16_f32 v161, v162, v163
    v_mfma_f32_16x16x32_bf16 v[108:111], a[64:67], a[148:151], v[108:111]
    v_cvt_pk_bf16_f32 v162, v164, v165
    v_cvt_pk_bf16_f32 v163, v166, v167
    v_mfma_f32_16x16x32_bf16 v[128:131], a[52:55], a[160:163], v[128:131]
    ds_write_b128 v8, v[160:163] offset:64
    v_mfma_f32_16x16x32_bf16 v[132:135], a[64:67], a[160:163], v[132:135]
    v_cvt_pk_bf16_f32 v168, v168, v169
    v_cvt_pk_bf16_f32 v169, v170, v171
    v_mfma_f32_16x16x32_bf16 v[152:155], a[52:55], a[172:175], v[152:155]
    v_cvt_pk_bf16_f32 v170, v172, v173
    v_cvt_pk_bf16_f32 v171, v174, v175
    v_mfma_f32_16x16x32_bf16 v[156:159], a[64:67], a[172:175], v[156:159]
    ds_write_b128 v8, v[168:171] offset:4288
    v_mfma_f32_16x16x32_bf16 v[104:107], a[56:59], a[152:155], v[104:107]
    v_cvt_pk_bf16_f32 v176, v176, v177
    v_cvt_pk_bf16_f32 v177, v178, v179
    v_mfma_f32_16x16x32_bf16 v[108:111], a[68:71], a[152:155], v[108:111]
    v_cvt_pk_bf16_f32 v178, v180, v181
    v_cvt_pk_bf16_f32 v179, v182, v183
    v_mfma_f32_16x16x32_bf16 v[128:131], a[56:59], a[164:167], v[128:131]
    ds_write_b128 v8, v[176:179] offset:8512
    v_mfma_f32_16x16x32_bf16 v[132:135], a[68:71], a[164:167], v[132:135]
    v_cvt_pk_bf16_f32 v184, v184, v185
    v_cvt_pk_bf16_f32 v185, v186, v187
    v_mfma_f32_16x16x32_bf16 v[152:155], a[56:59], a[176:179], v[152:155]
    v_cvt_pk_bf16_f32 v186, v188, v189
    v_cvt_pk_bf16_f32 v187, v190, v191
    v_mfma_f32_16x16x32_bf16 v[156:159], a[68:71], a[176:179], v[156:159]
    ds_write_b128 v8, v[184:187] offset:12736
    v_add_u32 v8, s6, v8
.p2align 3
    v_pk_fma_f32 v[192:193], v[136:137], s[68:69], v[40:41] neg_lo:[0,1,0] neg_hi:[0,1,0]
    v_pk_fma_f32 v[194:195], v[138:139], s[68:69], v[42:43] neg_lo:[0,1,0] neg_hi:[0,1,0]
    v_pk_fma_f32 v[196:197], v[140:141], s[68:69], v[44:45] neg_lo:[0,1,0] neg_hi:[0,1,0]
    v_pk_fma_f32 v[198:199], v[142:143], s[68:69], v[46:47] neg_lo:[0,1,0] neg_hi:[0,1,0]
    v_pk_fma_f32 v[200:201], v[112:113], s[68:69], v[16:17] neg_lo:[0,1,0] neg_hi:[0,1,0]
    v_pk_fma_f32 v[202:203], v[114:115], s[68:69], v[18:19] neg_lo:[0,1,0] neg_hi:[0,1,0]
    v_pk_fma_f32 v[204:205], v[116:117], s[68:69], v[20:21] neg_lo:[0,1,0] neg_hi:[0,1,0]
    v_pk_fma_f32 v[206:207], v[118:119], s[68:69], v[22:23] neg_lo:[0,1,0] neg_hi:[0,1,0]
    v_pk_fma_f32 v[160:161], v[200:201], s[62:63], v[192:193]
    v_pk_fma_f32 v[162:163], v[202:203], s[62:63], v[194:195]
    v_pk_fma_f32 v[164:165], v[204:205], s[62:63], v[196:197]
    v_pk_fma_f32 v[166:167], v[206:207], s[62:63], v[198:199]
    v_pk_fma_f32 v[168:169], v[200:201], s[62:63], v[192:193] neg_lo:[0,1,0] neg_hi:[0,1,0]
    v_pk_fma_f32 v[170:171], v[202:203], s[62:63], v[194:195] neg_lo:[0,1,0] neg_hi:[0,1,0]
    v_pk_fma_f32 v[172:173], v[204:205], s[62:63], v[196:197] neg_lo:[0,1,0] neg_hi:[0,1,0]
    v_pk_fma_f32 v[174:175], v[206:207], s[62:63], v[198:199] neg_lo:[0,1,0] neg_hi:[0,1,0]
    v_pk_fma_f32 v[192:193], v[136:137], s[66:67], v[40:41] neg_lo:[0,1,0] neg_hi:[0,1,0]
    v_pk_fma_f32 v[194:195], v[138:139], s[66:67], v[42:43] neg_lo:[0,1,0] neg_hi:[0,1,0]
    v_pk_fma_f32 v[196:197], v[140:141], s[66:67], v[44:45] neg_lo:[0,1,0] neg_hi:[0,1,0]
    v_pk_fma_f32 v[198:199], v[142:143], s[66:67], v[46:47] neg_lo:[0,1,0] neg_hi:[0,1,0]
    v_pk_fma_f32 v[200:201], v[112:113], s[66:67], v[16:17] neg_lo:[0,1,0] neg_hi:[0,1,0]
    v_pk_fma_f32 v[202:203], v[114:115], s[66:67], v[18:19] neg_lo:[0,1,0] neg_hi:[0,1,0]
    v_pk_fma_f32 v[204:205], v[116:117], s[66:67], v[20:21] neg_lo:[0,1,0] neg_hi:[0,1,0]
    v_pk_fma_f32 v[206:207], v[118:119], s[66:67], v[22:23] neg_lo:[0,1,0] neg_hi:[0,1,0]
    v_pk_fma_f32 v[176:177], v[200:201], s[64:65], v[192:193]
    v_pk_fma_f32 v[178:179], v[202:203], s[64:65], v[194:195]
    v_pk_fma_f32 v[180:181], v[204:205], s[64:65], v[196:197]
    v_pk_fma_f32 v[182:183], v[206:207], s[64:65], v[198:199]
    v_pk_fma_f32 v[184:185], v[200:201], s[64:65], v[192:193] neg_lo:[0,1,0] neg_hi:[0,1,0]
    v_pk_fma_f32 v[186:187], v[202:203], s[64:65], v[194:195] neg_lo:[0,1,0] neg_hi:[0,1,0]
    v_pk_fma_f32 v[188:189], v[204:205], s[64:65], v[196:197] neg_lo:[0,1,0] neg_hi:[0,1,0]
    v_pk_fma_f32 v[190:191], v[206:207], s[64:65], v[198:199] neg_lo:[0,1,0] neg_hi:[0,1,0]
    v_pk_fma_f32 v[192:193], v[136:137], s[70:71], v[88:89] neg_lo:[0,1,0] neg_hi:[0,1,0]
    v_pk_fma_f32 v[194:195], v[138:139], s[70:71], v[90:91] neg_lo:[0,1,0] neg_hi:[0,1,0]
    v_pk_fma_f32 v[196:197], v[140:141], s[70:71], v[92:93] neg_lo:[0,1,0] neg_hi:[0,1,0]
    v_pk_fma_f32 v[198:199], v[142:143], s[70:71], v[94:95] neg_lo:[0,1,0] neg_hi:[0,1,0]
    v_pk_fma_f32 v[200:201], v[16:17], s[74:75], v[64:65] neg_lo:[0,1,0] neg_hi:[0,1,0]
    v_pk_fma_f32 v[202:203], v[18:19], s[74:75], v[66:67] neg_lo:[0,1,0] neg_hi:[0,1,0]
    v_pk_fma_f32 v[204:205], v[20:21], s[74:75], v[68:69] neg_lo:[0,1,0] neg_hi:[0,1,0]
    v_pk_fma_f32 v[206:207], v[22:23], s[74:75], v[70:71] neg_lo:[0,1,0] neg_hi:[0,1,0]
    v_pk_fma_f32 v[192:193], v[40:41], s[72:73], v[192:193]
    v_pk_fma_f32 v[194:195], v[42:43], s[72:73], v[194:195]
    v_pk_fma_f32 v[196:197], v[44:45], s[72:73], v[196:197]
    v_pk_fma_f32 v[198:199], v[46:47], s[72:73], v[198:199]
    v_pk_fma_f32 v[200:201], v[112:113], s[76:77], v[200:201]
    v_pk_fma_f32 v[202:203], v[114:115], s[76:77], v[202:203]
    v_pk_fma_f32 v[204:205], v[116:117], s[76:77], v[204:205]
    v_pk_fma_f32 v[206:207], v[118:119], s[76:77], v[206:207]
    s_waitcnt lgkmcnt(8)
    v_mul_u32_u24 v16, v252, v220
    v_and_b32 v17, v253, v220
    v_mul_u32_u24 v18, v252, v221
    v_and_b32 v19, v253, v221
    v_mul_u32_u24 v20, v252, v222
    v_and_b32 v21, v253, v222
    v_mul_u32_u24 v22, v252, v223
    v_and_b32 v23, v253, v223
    s_waitcnt lgkmcnt(7)
    v_mul_u32_u24 v40, v252, v224
    v_and_b32 v41, v253, v224
    v_mul_u32_u24 v42, v252, v225
    v_and_b32 v43, v253, v225
    v_mul_u32_u24 v44, v252, v226
    v_and_b32 v45, v253, v226
    v_mul_u32_u24 v46, v252, v227
    v_and_b32 v47, v253, v227
    s_waitcnt lgkmcnt(6)
    v_mul_u32_u24 v64, v252, v228
    v_and_b32 v65, v253, v228
    v_mul_u32_u24 v66, v252, v229
    v_and_b32 v67, v253, v229
    v_mul_u32_u24 v68, v252, v230
    v_and_b32 v69, v253, v230
    v_mul_u32_u24 v70, v252, v231
    v_and_b32 v71, v253, v231
    ds_read_b128 v[208:211], v6 offset:9280
    ds_read_b128 v[212:215], v5 offset:11584
    ds_read_b128 v[216:219], v6 offset:11584
    s_waitcnt vmcnt(8)
    v_mfma_f32_16x16x32_bf16 v[16:19], a[0:3], a[180:183], v[16:19]
    v_cvt_pk_bf16_f32 v192, v192, v193
    v_cvt_pk_bf16_f32 v193, v194, v195
    v_mfma_f32_16x16x32_bf16 v[20:23], a[12:15], a[180:183], v[20:23]
    s_waitcnt vmcnt(5)
    v_cvt_pk_bf16_f32 v194, v196, v197
    v_cvt_pk_bf16_f32 v195, v198, v199
    v_mfma_f32_16x16x32_bf16 v[40:43], a[0:3], a[192:195], v[40:43]
    ds_write_b128 v8, v[192:195] offset:16896
    v_mfma_f32_16x16x32_bf16 v[44:47], a[12:15], a[192:195], v[44:47]
    s_waitcnt vmcnt(2)
    v_cvt_pk_bf16_f32 v200, v200, v201
    v_cvt_pk_bf16_f32 v201, v202, v203
    v_mfma_f32_16x16x32_bf16 v[64:67], a[0:3], a[204:207], v[64:67]
    v_cvt_pk_bf16_f32 v202, v204, v205
    v_cvt_pk_bf16_f32 v203, v206, v207
    v_mfma_f32_16x16x32_bf16 v[68:71], a[12:15], a[204:207], v[68:71]
    ds_write_b128 v8, v[200:203] offset:21120
    v_mfma_f32_16x16x32_bf16 v[16:19], a[4:7], a[184:187], v[16:19]
    v_cvt_pk_bf16_f32 v160, v160, v161
    v_cvt_pk_bf16_f32 v161, v162, v163
    v_mfma_f32_16x16x32_bf16 v[20:23], a[16:19], a[184:187], v[20:23]
    v_cvt_pk_bf16_f32 v162, v164, v165
    v_cvt_pk_bf16_f32 v163, v166, v167
    v_mfma_f32_16x16x32_bf16 v[40:43], a[4:7], a[196:199], v[40:43]
    ds_write_b128 v8, v[160:163] offset:0
    v_mfma_f32_16x16x32_bf16 v[44:47], a[16:19], a[196:199], v[44:47]
    s_waitcnt vmcnt(1)
    v_cvt_pk_bf16_f32 v168, v168, v169
    v_cvt_pk_bf16_f32 v169, v170, v171
    v_mfma_f32_16x16x32_bf16 v[64:67], a[4:7], a[208:211], v[64:67]
    v_cvt_pk_bf16_f32 v170, v172, v173
    v_cvt_pk_bf16_f32 v171, v174, v175
    v_mfma_f32_16x16x32_bf16 v[68:71], a[16:19], a[208:211], v[68:71]
    ds_write_b128 v8, v[168:171] offset:4224
    v_mfma_f32_16x16x32_bf16 v[16:19], a[8:11], a[188:191], v[16:19]
    v_cvt_pk_bf16_f32 v176, v176, v177
    v_cvt_pk_bf16_f32 v177, v178, v179
    v_mfma_f32_16x16x32_bf16 v[20:23], a[20:23], a[188:191], v[20:23]
    v_cvt_pk_bf16_f32 v178, v180, v181
    v_cvt_pk_bf16_f32 v179, v182, v183
    v_mfma_f32_16x16x32_bf16 v[40:43], a[8:11], a[200:203], v[40:43]
    ds_write_b128 v8, v[176:179] offset:8448
    v_mfma_f32_16x16x32_bf16 v[44:47], a[20:23], a[200:203], v[44:47]
    s_waitcnt vmcnt(0)
    v_cvt_pk_bf16_f32 v184, v184, v185
    v_cvt_pk_bf16_f32 v185, v186, v187
    v_mfma_f32_16x16x32_bf16 v[64:67], a[8:11], a[212:215], v[64:67]
    v_cvt_pk_bf16_f32 v186, v188, v189
    v_cvt_pk_bf16_f32 v187, v190, v191
    v_mfma_f32_16x16x32_bf16 v[68:71], a[20:23], a[212:215], v[68:71]
    ds_write_b128 v8, v[184:187] offset:12672
.p2align 3
    v_pk_fma_f32 v[192:193], v[144:145], s[68:69], v[48:49] neg_lo:[0,1,0] neg_hi:[0,1,0]
    v_pk_fma_f32 v[194:195], v[146:147], s[68:69], v[50:51] neg_lo:[0,1,0] neg_hi:[0,1,0]
    v_pk_fma_f32 v[196:197], v[148:149], s[68:69], v[52:53] neg_lo:[0,1,0] neg_hi:[0,1,0]
    v_pk_fma_f32 v[198:199], v[150:151], s[68:69], v[54:55] neg_lo:[0,1,0] neg_hi:[0,1,0]
    v_pk_fma_f32 v[200:201], v[120:121], s[68:69], v[24:25] neg_lo:[0,1,0] neg_hi:[0,1,0]
    v_pk_fma_f32 v[202:203], v[122:123], s[68:69], v[26:27] neg_lo:[0,1,0] neg_hi:[0,1,0]
    v_pk_fma_f32 v[204:205], v[124:125], s[68:69], v[28:29] neg_lo:[0,1,0] neg_hi:[0,1,0]
    v_pk_fma_f32 v[206:207], v[126:127], s[68:69], v[30:31] neg_lo:[0,1,0] neg_hi:[0,1,0]
    v_pk_fma_f32 v[160:161], v[200:201], s[62:63], v[192:193]
    v_pk_fma_f32 v[162:163], v[202:203], s[62:63], v[194:195]
    v_pk_fma_f32 v[164:165], v[204:205], s[62:63], v[196:197]
    v_pk_fma_f32 v[166:167], v[206:207], s[62:63], v[198:199]
    v_pk_fma_f32 v[168:169], v[200:201], s[62:63], v[192:193] neg_lo:[0,1,0] neg_hi:[0,1,0]
    v_pk_fma_f32 v[170:171], v[202:203], s[62:63], v[194:195] neg_lo:[0,1,0] neg_hi:[0,1,0]
    v_pk_fma_f32 v[172:173], v[204:205], s[62:63], v[196:197] neg_lo:[0,1,0] neg_hi:[0,1,0]
    v_pk_fma_f32 v[174:175], v[206:207], s[62:63], v[198:199] neg_lo:[0,1,0] neg_hi:[0,1,0]
    v_pk_fma_f32 v[192:193], v[144:145], s[66:67], v[48:49] neg_lo:[0,1,0] neg_hi:[0,1,0]
    v_pk_fma_f32 v[194:195], v[146:147], s[66:67], v[50:51] neg_lo:[0,1,0] neg_hi:[0,1,0]
    v_pk_fma_f32 v[196:197], v[148:149], s[66:67], v[52:53] neg_lo:[0,1,0] neg_hi:[0,1,0]
    v_pk_fma_f32 v[198:199], v[150:151], s[66:67], v[54:55] neg_lo:[0,1,0] neg_hi:[0,1,0]
    v_pk_fma_f32 v[200:201], v[120:121], s[66:67], v[24:25] neg_lo:[0,1,0] neg_hi:[0,1,0]
    v_pk_fma_f32 v[202:203], v[122:123], s[66:67], v[26:27] neg_lo:[0,1,0] neg_hi:[0,1,0]
    v_pk_fma_f32 v[204:205], v[124:125], s[66:67], v[28:29] neg_lo:[0,1,0] neg_hi:[0,1,0]
    v_pk_fma_f32 v[206:207], v[126:127], s[66:67], v[30:31] neg_lo:[0,1,0] neg_hi:[0,1,0]
    v_pk_fma_f32 v[176:177], v[200:201], s[64:65], v[192:193]
    v_pk_fma_f32 v[178:179], v[202:203], s[64:65], v[194:195]
    v_pk_fma_f32 v[180:181], v[204:205], s[64:65], v[196:197]
    v_pk_fma_f32 v[182:183], v[206:207], s[64:65], v[198:199]
    v_pk_fma_f32 v[184:185], v[200:201], s[64:65], v[192:193] neg_lo:[0,1,0] neg_hi:[0,1,0]
    v_pk_fma_f32 v[186:187], v[202:203], s[64:65], v[194:195] neg_lo:[0,1,0] neg_hi:[0,1,0]
    v_pk_fma_f32 v[188:189], v[204:205], s[64:65], v[196:197] neg_lo:[0,1,0] neg_hi:[0,1,0]
    v_pk_fma_f32 v[190:191], v[206:207], s[64:65], v[198:199] neg_lo:[0,1,0] neg_hi:[0,1,0]
    v_pk_fma_f32 v[192:193], v[144:145], s[70:71], v[96:97] neg_lo:[0,1,0] neg_hi:[0,1,0]
    v_pk_fma_f32 v[194:195], v[146:147], s[70:71], v[98:99] neg_lo:[0,1,0] neg_hi:[0,1,0]
    v_pk_fma_f32 v[196:197], v[148:149], s[70:71], v[100:101] neg_lo:[0,1,0] neg_hi:[0,1,0]
    v_pk_fma_f32 v[198:199], v[150:151], s[70:71], v[102:103] neg_lo:[0,1,0] neg_hi:[0,1,0]
    v_pk_fma_f32 v[200:201], v[24:25], s[74:75], v[72:73] neg_lo:[0,1,0] neg_hi:[0,1,0]
    v_pk_fma_f32 v[202:203], v[26:27], s[74:75], v[74:75] neg_lo:[0,1,0] neg_hi:[0,1,0]
    v_pk_fma_f32 v[204:205], v[28:29], s[74:75], v[76:77] neg_lo:[0,1,0] neg_hi:[0,1,0]
    v_pk_fma_f32 v[206:207], v[30:31], s[74:75], v[78:79] neg_lo:[0,1,0] neg_hi:[0,1,0]
    v_pk_fma_f32 v[192:193], v[48:49], s[72:73], v[192:193]
    v_pk_fma_f32 v[194:195], v[50:51], s[72:73], v[194:195]
    v_pk_fma_f32 v[196:197], v[52:53], s[72:73], v[196:197]
    v_pk_fma_f32 v[198:199], v[54:55], s[72:73], v[198:199]
    v_pk_fma_f32 v[200:201], v[120:121], s[76:77], v[200:201]
    v_pk_fma_f32 v[202:203], v[122:123], s[76:77], v[202:203]
    v_pk_fma_f32 v[204:205], v[124:125], s[76:77], v[204:205]
    v_pk_fma_f32 v[206:207], v[126:127], s[76:77], v[206:207]
    s_waitcnt lgkmcnt(8)
    v_mul_u32_u24 v24, v252, v208
    v_and_b32 v25, v253, v208
    v_mul_u32_u24 v26, v252, v209
    v_and_b32 v27, v253, v209
    v_mul_u32_u24 v28, v252, v210
    v_and_b32 v29, v253, v210
    v_mul_u32_u24 v30, v252, v211
    v_and_b32 v31, v253, v211
    s_waitcnt lgkmcnt(7)
    v_mul_u32_u24 v48, v252, v212
    v_and_b32 v49, v253, v212
    v_mul_u32_u24 v50, v252, v213
    v_and_b32 v51, v253, v213
    v_mul_u32_u24 v52, v252, v214
    v_and_b32 v53, v253, v214
    v_mul_u32_u24 v54, v252, v215
    v_and_b32 v55, v253, v215
    s_waitcnt lgkmcnt(6)
    v_mul_u32_u24 v72, v252, v216
    v_and_b32 v73, v253, v216
    v_mul_u32_u24 v74, v252, v217
    v_and_b32 v75, v253, v217
    v_mul_u32_u24 v76, v252, v218
    v_and_b32 v77, v253, v218
    v_mul_u32_u24 v78, v252, v219
    v_and_b32 v79, v253, v219
    ds_read_b128 v[220:223], v6 offset:9344
    ds_read_b128 v[224:227], v5 offset:11648
    ds_read_b128 v[228:231], v6 offset:11648
    v_mfma_f32_16x16x32_bf16 v[24:27], a[24:27], a[180:183], v[24:27]
    v_cvt_pk_bf16_f32 v192, v192, v193
    v_cvt_pk_bf16_f32 v193, v194, v195
    v_mfma_f32_16x16x32_bf16 v[28:31], a[36:39], a[180:183], v[28:31]
    v_cvt_pk_bf16_f32 v194, v196, v197
    v_cvt_pk_bf16_f32 v195, v198, v199
    v_mfma_f32_16x16x32_bf16 v[48:51], a[24:27], a[192:195], v[48:51]
    ds_write_b128 v8, v[192:195] offset:16928
    v_mfma_f32_16x16x32_bf16 v[52:55], a[36:39], a[192:195], v[52:55]
    v_cvt_pk_bf16_f32 v200, v200, v201
    v_cvt_pk_bf16_f32 v201, v202, v203
    v_mfma_f32_16x16x32_bf16 v[72:75], a[24:27], a[204:207], v[72:75]
    v_cvt_pk_bf16_f32 v202, v204, v205
    v_cvt_pk_bf16_f32 v203, v206, v207
    v_mfma_f32_16x16x32_bf16 v[76:79], a[36:39], a[204:207], v[76:79]
    ds_write_b128 v8, v[200:203] offset:21152
    v_mfma_f32_16x16x32_bf16 v[24:27], a[28:31], a[184:187], v[24:27]
    v_cvt_pk_bf16_f32 v160, v160, v161
    v_cvt_pk_bf16_f32 v161, v162, v163
    v_mfma_f32_16x16x32_bf16 v[28:31], a[40:43], a[184:187], v[28:31]
    v_cvt_pk_bf16_f32 v162, v164, v165
    v_cvt_pk_bf16_f32 v163, v166, v167
    v_mfma_f32_16x16x32_bf16 v[48:51], a[28:31], a[196:199], v[48:51]
    ds_write_b128 v8, v[160:163] offset:32
    v_mfma_f32_16x16x32_bf16 v[52:55], a[40:43], a[196:199], v[52:55]
    v_cvt_pk_bf16_f32 v168, v168, v169
    v_cvt_pk_bf16_f32 v169, v170, v171
    v_mfma_f32_16x16x32_bf16 v[72:75], a[28:31], a[208:211], v[72:75]
    v_cvt_pk_bf16_f32 v170, v172, v173
    v_cvt_pk_bf16_f32 v171, v174, v175
    v_mfma_f32_16x16x32_bf16 v[76:79], a[40:43], a[208:211], v[76:79]
    ds_write_b128 v8, v[168:171] offset:4256
    v_mfma_f32_16x16x32_bf16 v[24:27], a[32:35], a[188:191], v[24:27]
    v_cvt_pk_bf16_f32 v176, v176, v177
    v_cvt_pk_bf16_f32 v177, v178, v179
    v_mfma_f32_16x16x32_bf16 v[28:31], a[44:47], a[188:191], v[28:31]
    v_cvt_pk_bf16_f32 v178, v180, v181
    v_cvt_pk_bf16_f32 v179, v182, v183
    v_mfma_f32_16x16x32_bf16 v[48:51], a[32:35], a[200:203], v[48:51]
    ds_write_b128 v8, v[176:179] offset:8480
    v_mfma_f32_16x16x32_bf16 v[52:55], a[44:47], a[200:203], v[52:55]
    v_cvt_pk_bf16_f32 v184, v184, v185
    v_cvt_pk_bf16_f32 v185, v186, v187
    v_mfma_f32_16x16x32_bf16 v[72:75], a[32:35], a[212:215], v[72:75]
    v_cvt_pk_bf16_f32 v186, v188, v189
    v_cvt_pk_bf16_f32 v187, v190, v191
    v_mfma_f32_16x16x32_bf16 v[76:79], a[44:47], a[212:215], v[76:79]
    s_waitcnt lgkmcnt(5)
    ds_write_b128 v8, v[184:187] offset:12704
    s_barrier
.p2align 3
    v_pk_fma_f32 v[192:193], v[152:153], s[68:69], v[56:57] neg_lo:[0,1,0] neg_hi:[0,1,0]
    v_pk_fma_f32 v[194:195], v[154:155], s[68:69], v[58:59] neg_lo:[0,1,0] neg_hi:[0,1,0]
    v_pk_fma_f32 v[196:197], v[156:157], s[68:69], v[60:61] neg_lo:[0,1,0] neg_hi:[0,1,0]
    v_pk_fma_f32 v[198:199], v[158:159], s[68:69], v[62:63] neg_lo:[0,1,0] neg_hi:[0,1,0]
    v_pk_fma_f32 v[200:201], v[128:129], s[68:69], v[32:33] neg_lo:[0,1,0] neg_hi:[0,1,0]
    v_pk_fma_f32 v[202:203], v[130:131], s[68:69], v[34:35] neg_lo:[0,1,0] neg_hi:[0,1,0]
    v_pk_fma_f32 v[204:205], v[132:133], s[68:69], v[36:37] neg_lo:[0,1,0] neg_hi:[0,1,0]
    v_pk_fma_f32 v[206:207], v[134:135], s[68:69], v[38:39] neg_lo:[0,1,0] neg_hi:[0,1,0]
    v_pk_fma_f32 v[160:161], v[200:201], s[62:63], v[192:193]
    v_pk_fma_f32 v[162:163], v[202:203], s[62:63], v[194:195]
    v_pk_fma_f32 v[164:165], v[204:205], s[62:63], v[196:197]
    v_pk_fma_f32 v[166:167], v[206:207], s[62:63], v[198:199]
    v_pk_fma_f32 v[168:169], v[200:201], s[62:63], v[192:193] neg_lo:[0,1,0] neg_hi:[0,1,0]
    v_pk_fma_f32 v[170:171], v[202:203], s[62:63], v[194:195] neg_lo:[0,1,0] neg_hi:[0,1,0]
    v_pk_fma_f32 v[172:173], v[204:205], s[62:63], v[196:197] neg_lo:[0,1,0] neg_hi:[0,1,0]
    v_pk_fma_f32 v[174:175], v[206:207], s[62:63], v[198:199] neg_lo:[0,1,0] neg_hi:[0,1,0]
    v_pk_fma_f32 v[192:193], v[152:153], s[66:67], v[56:57] neg_lo:[0,1,0] neg_hi:[0,1,0]
    v_pk_fma_f32 v[194:195], v[154:155], s[66:67], v[58:59] neg_lo:[0,1,0] neg_hi:[0,1,0]
    v_pk_fma_f32 v[196:197], v[156:157], s[66:67], v[60:61] neg_lo:[0,1,0] neg_hi:[0,1,0]
    v_pk_fma_f32 v[198:199], v[158:159], s[66:67], v[62:63] neg_lo:[0,1,0] neg_hi:[0,1,0]
    v_pk_fma_f32 v[200:201], v[128:129], s[66:67], v[32:33] neg_lo:[0,1,0] neg_hi:[0,1,0]
    v_pk_fma_f32 v[202:203], v[130:131], s[66:67], v[34:35] neg_lo:[0,1,0] neg_hi:[0,1,0]
    v_pk_fma_f32 v[204:205], v[132:133], s[66:67], v[36:37] neg_lo:[0,1,0] neg_hi:[0,1,0]
    v_pk_fma_f32 v[206:207], v[134:135], s[66:67], v[38:39] neg_lo:[0,1,0] neg_hi:[0,1,0]
    global_load_dwordx4 a[72:75], v11, s[44:45] offset:-3072 sc1
    global_load_dwordx4 a[76:79], v11, s[44:45] offset:-2048 sc1
    global_load_dwordx4 a[80:83], v11, s[44:45] offset:-1024 sc1
    v_pk_fma_f32 v[176:177], v[200:201], s[64:65], v[192:193]
    v_pk_fma_f32 v[178:179], v[202:203], s[64:65], v[194:195]
    v_pk_fma_f32 v[180:181], v[204:205], s[64:65], v[196:197]
    v_pk_fma_f32 v[182:183], v[206:207], s[64:65], v[198:199]
    v_pk_fma_f32 v[184:185], v[200:201], s[64:65], v[192:193] neg_lo:[0,1,0] neg_hi:[0,1,0]
    v_pk_fma_f32 v[186:187], v[202:203], s[64:65], v[194:195] neg_lo:[0,1,0] neg_hi:[0,1,0]
    v_pk_fma_f32 v[188:189], v[204:205], s[64:65], v[196:197] neg_lo:[0,1,0] neg_hi:[0,1,0]
    v_pk_fma_f32 v[190:191], v[206:207], s[64:65], v[198:199] neg_lo:[0,1,0] neg_hi:[0,1,0]
    v_pk_fma_f32 v[192:193], v[152:153], s[70:71], v[104:105] neg_lo:[0,1,0] neg_hi:[0,1,0]
    v_pk_fma_f32 v[194:195], v[154:155], s[70:71], v[106:107] neg_lo:[0,1,0] neg_hi:[0,1,0]
    v_pk_fma_f32 v[196:197], v[156:157], s[70:71], v[108:109] neg_lo:[0,1,0] neg_hi:[0,1,0]
    v_pk_fma_f32 v[198:199], v[158:159], s[70:71], v[110:111] neg_lo:[0,1,0] neg_hi:[0,1,0]
    v_pk_fma_f32 v[200:201], v[32:33], s[74:75], v[80:81] neg_lo:[0,1,0] neg_hi:[0,1,0]
    v_pk_fma_f32 v[202:203], v[34:35], s[74:75], v[82:83] neg_lo:[0,1,0] neg_hi:[0,1,0]
    v_pk_fma_f32 v[204:205], v[36:37], s[74:75], v[84:85] neg_lo:[0,1,0] neg_hi:[0,1,0]
    v_pk_fma_f32 v[206:207], v[38:39], s[74:75], v[86:87] neg_lo:[0,1,0] neg_hi:[0,1,0]
    v_pk_fma_f32 v[192:193], v[56:57], s[72:73], v[192:193]
    v_pk_fma_f32 v[194:195], v[58:59], s[72:73], v[194:195]
    v_pk_fma_f32 v[196:197], v[60:61], s[72:73], v[196:197]
    v_pk_fma_f32 v[198:199], v[62:63], s[72:73], v[198:199]
    v_pk_fma_f32 v[200:201], v[128:129], s[76:77], v[200:201]
    v_pk_fma_f32 v[202:203], v[130:131], s[76:77], v[202:203]
    v_pk_fma_f32 v[204:205], v[132:133], s[76:77], v[204:205]
    v_pk_fma_f32 v[206:207], v[134:135], s[76:77], v[206:207]
    global_load_dwordx4 a[84:87], v11, s[44:45] offset:0 sc1
    global_load_dwordx4 a[88:91], v11, s[44:45] offset:1024 sc1
    global_load_dwordx4 a[92:95], v11, s[44:45] offset:2048 sc1
    v_add_u32 v11, 6144, v11
    v_mul_u32_u24 v32, v252, v220
    v_and_b32 v33, v253, v220
    v_mul_u32_u24 v34, v252, v221
    v_and_b32 v35, v253, v221
    v_mul_u32_u24 v36, v252, v222
    v_and_b32 v37, v253, v222
    v_mul_u32_u24 v38, v252, v223
    v_and_b32 v39, v253, v223
    v_mul_u32_u24 v56, v252, v224
    v_and_b32 v57, v253, v224
    v_mul_u32_u24 v58, v252, v225
    v_and_b32 v59, v253, v225
    v_mul_u32_u24 v60, v252, v226
    v_and_b32 v61, v253, v226
    v_mul_u32_u24 v62, v252, v227
    v_and_b32 v63, v253, v227
    v_mul_u32_u24 v80, v252, v228
    v_and_b32 v81, v253, v228
    v_mul_u32_u24 v82, v252, v229
    v_and_b32 v83, v253, v229
    v_mul_u32_u24 v84, v252, v230
    v_and_b32 v85, v253, v230
    v_mul_u32_u24 v86, v252, v231
    v_and_b32 v87, v253, v231
    ds_read_b128 a[216:219], v9 offset:0
    ds_read_b128 a[220:223], v9 offset:25344
    ds_read_b128 a[232:235], v10 offset:25344
    v_mfma_f32_16x16x32_bf16 v[32:35], a[48:51], a[180:183], v[32:35]
    v_cvt_pk_bf16_f32 v192, v192, v193
    v_cvt_pk_bf16_f32 v193, v194, v195
    v_mfma_f32_16x16x32_bf16 v[36:39], a[60:63], a[180:183], v[36:39]
    v_cvt_pk_bf16_f32 v194, v196, v197
    v_cvt_pk_bf16_f32 v195, v198, v199
    v_mfma_f32_16x16x32_bf16 v[56:59], a[48:51], a[192:195], v[56:59]
    ds_write_b128 v8, v[192:195] offset:16960
    v_mfma_f32_16x16x32_bf16 v[60:63], a[60:63], a[192:195], v[60:63]
    v_cvt_pk_bf16_f32 v200, v200, v201
    v_cvt_pk_bf16_f32 v201, v202, v203
    v_mfma_f32_16x16x32_bf16 v[80:83], a[48:51], a[204:207], v[80:83]
    v_cvt_pk_bf16_f32 v202, v204, v205
    v_cvt_pk_bf16_f32 v203, v206, v207
    v_mfma_f32_16x16x32_bf16 v[84:87], a[60:63], a[204:207], v[84:87]
    ds_write_b128 v8, v[200:203] offset:21184
    v_mfma_f32_16x16x32_bf16 v[32:35], a[52:55], a[184:187], v[32:35]
    v_cvt_pk_bf16_f32 v160, v160, v161
    v_cvt_pk_bf16_f32 v161, v162, v163
    v_mfma_f32_16x16x32_bf16 v[36:39], a[64:67], a[184:187], v[36:39]
    v_cvt_pk_bf16_f32 v162, v164, v165
    v_cvt_pk_bf16_f32 v163, v166, v167
    v_mfma_f32_16x16x32_bf16 v[56:59], a[52:55], a[196:199], v[56:59]
    ds_write_b128 v8, v[160:163] offset:64
    v_mfma_f32_16x16x32_bf16 v[60:63], a[64:67], a[196:199], v[60:63]
    v_cvt_pk_bf16_f32 v168, v168, v169
    v_cvt_pk_bf16_f32 v169, v170, v171
    v_mfma_f32_16x16x32_bf16 v[80:83], a[52:55], a[208:211], v[80:83]
    v_cvt_pk_bf16_f32 v170, v172, v173
    v_cvt_pk_bf16_f32 v171, v174, v175
    v_mfma_f32_16x16x32_bf16 v[84:87], a[64:67], a[208:211], v[84:87]
    ds_write_b128 v8, v[168:171] offset:4288
    v_mfma_f32_16x16x32_bf16 v[32:35], a[56:59], a[188:191], v[32:35]
    v_cvt_pk_bf16_f32 v176, v176, v177
    v_cvt_pk_bf16_f32 v177, v178, v179
    v_mfma_f32_16x16x32_bf16 v[36:39], a[68:71], a[188:191], v[36:39]
    v_cvt_pk_bf16_f32 v178, v180, v181
    v_cvt_pk_bf16_f32 v179, v182, v183
    v_mfma_f32_16x16x32_bf16 v[56:59], a[56:59], a[200:203], v[56:59]
    ds_write_b128 v8, v[176:179] offset:8512
    v_mfma_f32_16x16x32_bf16 v[60:63], a[68:71], a[200:203], v[60:63]
    v_cvt_pk_bf16_f32 v184, v184, v185
    v_cvt_pk_bf16_f32 v185, v186, v187
    v_mfma_f32_16x16x32_bf16 v[80:83], a[56:59], a[212:215], v[80:83]
    v_cvt_pk_bf16_f32 v186, v188, v189
    v_cvt_pk_bf16_f32 v187, v190, v191
    v_mfma_f32_16x16x32_bf16 v[84:87], a[68:71], a[212:215], v[84:87]
    ds_write_b128 v8, v[184:187] offset:12736
    v_add_u32 v8, s6, v8
    s_branch L_T2
L_POLLEDC:
    s_barrier
    global_load_dwordx4 a[72:75], v11, s[44:45] offset:-3072 sc1
    global_load_dwordx4 a[76:79], v11, s[44:45] offset:-2048 sc1
    global_load_dwordx4 a[80:83], v11, s[44:45] offset:-1024 sc1
    global_load_dwordx4 a[84:87], v11, s[44:45] offset:0 sc1
    global_load_dwordx4 a[88:91], v11, s[44:45] offset:1024 sc1
    global_load_dwordx4 a[92:95], v11, s[44:45] offset:2048 sc1
    v_add_u32 v11, 6144, v11
    global_load_dwordx4 a[96:99], v11, s[44:45] offset:-3072 sc1
    global_load_dwordx4 a[100:103], v11, s[44:45] offset:-2048 sc1
    global_load_dwordx4 a[104:107], v11, s[44:45] offset:-1024 sc1
    global_load_dwordx4 a[108:111], v11, s[44:45] offset:0 sc1
    global_load_dwordx4 a[112:115], v11, s[44:45] offset:1024 sc1
    global_load_dwordx4 a[116:119], v11, s[44:45] offset:2048 sc1
    ds_read_b128 a[216:219], v9 offset:0
    ds_read_b128 a[220:223], v9 offset:25344
    ds_read_b128 a[232:235], v10 offset:25344
    s_mov_b64 exec, 0
    s_branch HOP2_0
HOPRET2:
    s_mov_b64 exec, -1
    s_waitcnt lgkmcnt(0)
    s_barrier
    ds_read_b128 a[224:227], v9 offset:50688
    ds_read_b128 a[228:231], v10 offset:0
    ds_read_b128 a[236:239], v10 offset:50688
    s_waitcnt vmcnt(11)
    v_mfma_f32_16x16x32_bf16 v[160:163], a[72:75], a[216:219], 0
    s_lshl_b32 s54, s19, 31
    s_waitcnt vmcnt(10)
    v_mfma_f32_16x16x32_bf16 v[164:167], a[76:79], a[216:219], 0
    s_xor_b32 s78, s62, s54
    v_add_u32 v11, 6144, v11
    s_waitcnt vmcnt(9)
    v_mfma_f32_16x16x32_bf16 v[168:171], a[80:83], a[216:219], 0
    s_xor_b32 s79, s64, s54
    global_load_dwordx4 a[120:123], v11, s[44:45] offset:-3072 sc1
    v_mfma_f32_16x16x32_bf16 v[172:175], a[72:75], a[220:223], 0
    s_mov_b32 s53, 96
    ds_read_b128 a[216:219], v9 offset:32
    v_lshlrev_b32 v14, 3, v1
    v_mfma_f32_16x16x32_bf16 v[176:179], a[76:79], a[220:223], 0
    s_mul_i32 s55, s48, 50688
    v_mfma_f32_16x16x32_bf16 v[180:183], a[80:83], a[220:223], 0
    s_add_u32 s56, s55, s11
    v_add_u32 v12, s56, v14
    s_waitcnt vmcnt(9)
    v_mfma_f32_16x16x32_bf16 v[160:163], a[84:87], a[220:223], v[160:163]
    s_xor_b32 s54, s11, 4224
    global_load_dwordx4 a[124:127], v11, s[44:45] offset:-2048 sc1
    s_waitcnt vmcnt(9)
    v_mfma_f32_16x16x32_bf16 v[164:167], a[88:91], a[220:223], v[164:167]
    s_add_u32 s56, s55, s54
    v_add_u32 v13, s56, v14
    s_waitcnt vmcnt(8)
    v_mfma_f32_16x16x32_bf16 v[168:171], a[92:95], a[220:223], v[168:171]
    s_mul_i32 s54, s48, 4224
    s_waitcnt lgkmcnt(3)
    v_mfma_f32_16x16x32_bf16 v[184:187], a[72:75], a[224:227], 0
    s_add_u32 s54, s54, 101376
    ds_read_b128 a[220:223], v9 offset:25376
    v_add_u32 v14, s54, v14
    v_mfma_f32_16x16x32_bf16 v[188:191], a[76:79], a[224:227], 0
    s_mul_i32 s54, s49, 224
    v_mfma_f32_16x16x32_bf16 v[192:195], a[80:83], a[224:227], 0
    s_add_u32 s54, s54, s50
    v_mfma_f32_16x16x32_bf16 v[172:175], a[84:87], a[224:227], v[172:175]
    s_lshl2_add_u32 s54, s18, s54
    global_load_dwordx4 a[128:131], v11, s[44:45] offset:-1024 sc1
    v_mfma_f32_16x16x32_bf16 v[176:179], a[88:91], a[224:227], v[176:179]
    s_mul_i32 s54, s54, 192
    v_add_u32 v6, 16, v1
    v_lshrrev_b32 v6, 6, v6
    v_mfma_f32_16x16x32_bf16 v[180:183], a[92:95], a[224:227], v[180:183]
    s_waitcnt lgkmcnt(3)
    v_lshlrev_b32 v6, 31, v6
    v_lshl_add_u32 v15, v1, 4, v6
    v_mfma_f32_16x16x32_bf16 v[196:199], a[72:75], a[228:231], 0
    ds_read_b128 a[224:227], v9 offset:50720
    v_add_u32 v15, s54, v15
    v_mfma_f32_16x16x32_bf16 v[200:203], a[76:79], a[228:231], 0
    v_mfma_f32_16x16x32_bf16 v[204:207], a[80:83], a[228:231], 0
    v_mfma_f32_16x16x32_bf16 v[184:187], a[84:87], a[228:231], v[184:187]
    global_load_dwordx4 a[132:135], v11, s[44:45] offset:0 sc1
    v_mfma_f32_16x16x32_bf16 v[188:191], a[88:91], a[228:231], v[188:191]
    v_mfma_f32_16x16x32_bf16 v[192:195], a[92:95], a[228:231], v[192:195]
    s_waitcnt lgkmcnt(3)
    v_mfma_f32_16x16x32_bf16 v[208:211], a[72:75], a[232:235], 0
    ds_read_b128 a[228:231], v10 offset:32
    v_mfma_f32_16x16x32_bf16 v[212:215], a[76:79], a[232:235], 0
    v_mfma_f32_16x16x32_bf16 v[216:219], a[80:83], a[232:235], 0
    v_mfma_f32_16x16x32_bf16 v[196:199], a[84:87], a[232:235], v[196:199]
    global_load_dwordx4 a[136:139], v11, s[44:45] offset:1024 sc1
    v_mfma_f32_16x16x32_bf16 v[200:203], a[88:91], a[232:235], v[200:203]
    v_mfma_f32_16x16x32_bf16 v[204:207], a[92:95], a[232:235], v[204:207]
    v_mfma_f32_16x16x32_bf16 v[208:211], a[84:87], a[236:239], v[208:211]
    ds_read_b128 a[232:235], v10 offset:25376
    v_mfma_f32_16x16x32_bf16 v[212:215], a[88:91], a[236:239], v[212:215]
    global_load_dwordx4 a[140:143], v11, s[44:45] offset:2048 sc1
    v_mfma_f32_16x16x32_bf16 v[216:219], a[92:95], a[236:239], v[216:219]
    s_waitcnt vmcnt(6) lgkmcnt(1)
    v_mfma_f32_16x16x32_bf16 v[160:163], a[96:99], a[216:219], v[160:163]
    ds_read_b128 a[236:239], v10 offset:50720
    v_mfma_f32_16x16x32_bf16 v[164:167], a[100:103], a[216:219], v[164:167]
    v_add_u32 v11, 6144, v11
    v_mfma_f32_16x16x32_bf16 v[168:171], a[104:107], a[216:219], v[168:171]
    global_load_dwordx4 a[72:75], v11, s[44:45] offset:-3072 sc1
    v_mfma_f32_16x16x32_bf16 v[172:175], a[96:99], a[220:223], v[172:175]
    ds_read_b128 a[216:219], v9 offset:64
    v_mfma_f32_16x16x32_bf16 v[176:179], a[100:103], a[220:223], v[176:179]
    v_mfma_f32_16x16x32_bf16 v[180:183], a[104:107], a[220:223], v[180:183]
    v_mfma_f32_16x16x32_bf16 v[160:163], a[108:111], a[220:223], v[160:163]
    global_load_dwordx4 a[76:79], v11, s[44:45] offset:-2048 sc1
    v_mfma_f32_16x16x32_bf16 v[164:167], a[112:115], a[220:223], v[164:167]
    v_mfma_f32_16x16x32_bf16 v[168:171], a[116:119], a[220:223], v[168:171]
    v_mfma_f32_16x16x32_bf16 v[184:187], a[96:99], a[224:227], v[184:187]
    ds_read_b128 a[220:223], v9 offset:25408
    v_mfma_f32_16x16x32_bf16 v[188:191], a[100:103], a[224:227], v[188:191]
    v_mfma_f32_16x16x32_bf16 v[192:195], a[104:107], a[224:227], v[192:195]
    v_mfma_f32_16x16x32_bf16 v[172:175], a[108:111], a[224:227], v[172:175]
    global_load_dwordx4 a[80:83], v11, s[44:45] offset:-1024 sc1
    v_mfma_f32_16x16x32_bf16 v[176:179], a[112:115], a[224:227], v[176:179]
    v_mfma_f32_16x16x32_bf16 v[180:183], a[116:119], a[224:227], v[180:183]
    v_mfma_f32_16x16x32_bf16 v[196:199], a[96:99], a[228:231], v[196:199]
    ds_read_b128 a[224:227], v9 offset:50752
    v_mfma_f32_16x16x32_bf16 v[200:203], a[100:103], a[228:231], v[200:203]
    v_mfma_f32_16x16x32_bf16 v[204:207], a[104:107], a[228:231], v[204:207]
    v_mfma_f32_16x16x32_bf16 v[184:187], a[108:111], a[228:231], v[184:187]
    global_load_dwordx4 a[84:87], v11, s[44:45] offset:0 sc1
    v_mfma_f32_16x16x32_bf16 v[188:191], a[112:115], a[228:231], v[188:191]
    v_mfma_f32_16x16x32_bf16 v[192:195], a[116:119], a[228:231], v[192:195]
    s_waitcnt lgkmcnt(3)
    v_mfma_f32_16x16x32_bf16 v[208:211], a[96:99], a[232:235], v[208:211]
    ds_read_b128 a[228:231], v10 offset:64
    v_mfma_f32_16x16x32_bf16 v[212:215], a[100:103], a[232:235], v[212:215]
    v_mfma_f32_16x16x32_bf16 v[216:219], a[104:107], a[232:235], v[216:219]
    v_mfma_f32_16x16x32_bf16 v[196:199], a[108:111], a[232:235], v[196:199]
    global_load_dwordx4 a[88:91], v11, s[44:45] offset:1024 sc1
    v_mfma_f32_16x16x32_bf16 v[200:203], a[112:115], a[232:235], v[200:203]
    v_mfma_f32_16x16x32_bf16 v[204:207], a[116:119], a[232:235], v[204:207]
    v_mfma_f32_16x16x32_bf16 v[208:211], a[108:111], a[236:239], v[208:211]
    ds_read_b128 a[232:235], v10 offset:25408
    v_mfma_f32_16x16x32_bf16 v[212:215], a[112:115], a[236:239], v[212:215]
    global_load_dwordx4 a[92:95], v11, s[44:45] offset:2048 sc1
    v_mfma_f32_16x16x32_bf16 v[216:219], a[116:119], a[236:239], v[216:219]
    s_waitcnt vmcnt(6) lgkmcnt(1)
    v_mfma_f32_16x16x32_bf16 v[160:163], a[120:123], a[216:219], v[160:163]
    ds_read_b128 a[236:239], v10 offset:50752
    v_mfma_f32_16x16x32_bf16 v[164:167], a[124:127], a[216:219], v[164:167]
    v_mfma_f32_16x16x32_bf16 v[168:171], a[128:131], a[216:219], v[168:171]
    v_add_u32 v9, 96, v9
    v_mfma_f32_16x16x32_bf16 v[172:175], a[120:123], a[220:223], v[172:175]
    ds_read_b128 a[216:219], v9 offset:0
    v_add_u32 v11, 6144, v11
    v_mfma_f32_16x16x32_bf16 v[176:179], a[124:127], a[220:223], v[176:179]
    global_load_dwordx4 a[96:99], v11, s[44:45] offset:-3072 sc1
    v_mfma_f32_16x16x32_bf16 v[180:183], a[128:131], a[220:223], v[180:183]
    v_mfma_f32_16x16x32_bf16 v[160:163], a[132:135], a[220:223], v[160:163]
    global_load_dwordx4 a[100:103], v11, s[44:45] offset:-2048 sc1
    v_mfma_f32_16x16x32_bf16 v[164:167], a[136:139], a[220:223], v[164:167]
    v_mfma_f32_16x16x32_bf16 v[168:171], a[140:143], a[220:223], v[168:171]
    v_mfma_f32_16x16x32_bf16 v[184:187], a[120:123], a[224:227], v[184:187]
    ds_read_b128 a[220:223], v9 offset:25344
    v_mfma_f32_16x16x32_bf16 v[188:191], a[124:127], a[224:227], v[188:191]
    v_mfma_f32_16x16x32_bf16 v[192:195], a[128:131], a[224:227], v[192:195]
    v_mfma_f32_16x16x32_bf16 v[172:175], a[132:135], a[224:227], v[172:175]
    global_load_dwordx4 a[104:107], v11, s[44:45] offset:-1024 sc1
    v_mfma_f32_16x16x32_bf16 v[176:179], a[136:139], a[224:227], v[176:179]
    v_mfma_f32_16x16x32_bf16 v[180:183], a[140:143], a[224:227], v[180:183]
    v_mfma_f32_16x16x32_bf16 v[196:199], a[120:123], a[228:231], v[196:199]
    ds_read_b128 a[224:227], v9 offset:50688
    v_mfma_f32_16x16x32_bf16 v[200:203], a[124:127], a[228:231], v[200:203]
    v_mfma_f32_16x16x32_bf16 v[204:207], a[128:131], a[228:231], v[204:207]
    v_mfma_f32_16x16x32_bf16 v[184:187], a[132:135], a[228:231], v[184:187]
    global_load_dwordx4 a[108:111], v11, s[44:45] offset:0 sc1
    v_mfma_f32_16x16x32_bf16 v[188:191], a[136:139], a[228:231], v[188:191]
    v_mfma_f32_16x16x32_bf16 v[192:195], a[140:143], a[228:231], v[192:195]
    s_waitcnt lgkmcnt(3)
    v_add_u32 v10, 96, v10
    v_mfma_f32_16x16x32_bf16 v[208:211], a[120:123], a[232:235], v[208:211]
    ds_read_b128 a[228:231], v10 offset:0
    v_mfma_f32_16x16x32_bf16 v[212:215], a[124:127], a[232:235], v[212:215]
    v_mfma_f32_16x16x32_bf16 v[216:219], a[128:131], a[232:235], v[216:219]
    v_mfma_f32_16x16x32_bf16 v[196:199], a[132:135], a[232:235], v[196:199]
    global_load_dwordx4 a[112:115], v11, s[44:45] offset:1024 sc1
    v_mfma_f32_16x16x32_bf16 v[200:203], a[136:139], a[232:235], v[200:203]
    v_mfma_f32_16x16x32_bf16 v[204:207], a[140:143], a[232:235], v[204:207]
    v_mfma_f32_16x16x32_bf16 v[208:211], a[132:135], a[236:239], v[208:211]
    ds_read_b128 a[232:235], v10 offset:25344
    v_mfma_f32_16x16x32_bf16 v[212:215], a[136:139], a[236:239], v[212:215]
    global_load_dwordx4 a[116:119], v11, s[44:45] offset:2048 sc1
    v_mfma_f32_16x16x32_bf16 v[216:219], a[140:143], a[236:239], v[216:219]
    s_waitcnt vmcnt(6) lgkmcnt(1)
    v_mfma_f32_16x16x32_bf16 v[160:163], a[72:75], a[216:219], v[160:163]
    ds_read_b128 a[236:239], v10 offset:50688
    v_mfma_f32_16x16x32_bf16 v[164:167], a[76:79], a[216:219], v[164:167]
    v_add_u32 v11, 6144, v11
    v_mfma_f32_16x16x32_bf16 v[168:171], a[80:83], a[216:219], v[168:171]
    global_load_dwordx4 a[120:123], v11, s[44:45] offset:-3072 sc1
    v_mfma_f32_16x16x32_bf16 v[172:175], a[72:75], a[220:223], v[172:175]
    s_mov_b32 s53, 96
    ds_read_b128 a[216:219], v9 offset:32
    v_mfma_f32_16x16x32_bf16 v[176:179], a[76:79], a[220:223], v[176:179]
    v_mfma_f32_16x16x32_bf16 v[180:183], a[80:83], a[220:223], v[180:183]
    v_mfma_f32_16x16x32_bf16 v[160:163], a[84:87], a[220:223], v[160:163]
    global_load_dwordx4 a[124:127], v11, s[44:45] offset:-2048 sc1
    v_mfma_f32_16x16x32_bf16 v[164:167], a[88:91], a[220:223], v[164:167]
    v_mfma_f32_16x16x32_bf16 v[168:171], a[92:95], a[220:223], v[168:171]
    v_mfma_f32_16x16x32_bf16 v[184:187], a[72:75], a[224:227], v[184:187]
    ds_read_b128 a[220:223], v9 offset:25376
    v_mfma_f32_16x16x32_bf16 v[188:191], a[76:79], a[224:227], v[188:191]
    v_mfma_f32_16x16x32_bf16 v[192:195], a[80:83], a[224:227], v[192:195]
    v_mfma_f32_16x16x32_bf16 v[172:175], a[84:87], a[224:227], v[172:175]
    global_load_dwordx4 a[128:131], v11, s[44:45] offset:-1024 sc1
    v_mfma_f32_16x16x32_bf16 v[176:179], a[88:91], a[224:227], v[176:179]
    v_mfma_f32_16x16x32_bf16 v[180:183], a[92:95], a[224:227], v[180:183]
    v_mfma_f32_16x16x32_bf16 v[196:199], a[72:75], a[228:231], v[196:199]
    ds_read_b128 a[224:227], v9 offset:50720
    v_mfma_f32_16x16x32_bf16 v[200:203], a[76:79], a[228:231], v[200:203]
    v_mfma_f32_16x16x32_bf16 v[204:207], a[80:83], a[228:231], v[204:207]
    v_mfma_f32_16x16x32_bf16 v[184:187], a[84:87], a[228:231], v[184:187]
    global_load_dwordx4 a[132:135], v11, s[44:45] offset:0 sc1
    v_mfma_f32_16x16x32_bf16 v[188:191], a[88:91], a[228:231], v[188:191]
    v_mfma_f32_16x16x32_bf16 v[192:195], a[92:95], a[228:231], v[192:195]
    s_waitcnt lgkmcnt(3)
    v_mfma_f32_16x16x32_bf16 v[208:211], a[72:75], a[232:235], v[208:211]
    ds_read_b128 a[228:231], v10 offset:32
    v_mfma_f32_16x16x32_bf16 v[212:215], a[76:79], a[232:235], v[212:215]
    v_mfma_f32_16x16x32_bf16 v[216:219], a[80:83], a[232:235], v[216:219]
    v_mfma_f32_16x16x32_bf16 v[196:199], a[84:87], a[232:235], v[196:199]
    global_load_dwordx4 a[136:139], v11, s[44:45] offset:1024 sc1
    v_mfma_f32_16x16x32_bf16 v[200:203], a[88:91], a[232:235], v[200:203]
    v_mfma_f32_16x16x32_bf16 v[204:207], a[92:95], a[232:235], v[204:207]
    v_mfma_f32_16x16x32_bf16 v[208:211], a[84:87], a[236:239], v[208:211]
    ds_read_b128 a[232:235], v10 offset:25376
    v_mfma_f32_16x16x32_bf16 v[212:215], a[88:91], a[236:239], v[212:215]
    global_load_dwordx4 a[140:143], v11, s[44:45] offset:2048 sc1
    v_mfma_f32_16x16x32_bf16 v[216:219], a[92:95], a[236:239], v[216:219]
    s_waitcnt vmcnt(6) lgkmcnt(1)
    v_mfma_f32_16x16x32_bf16 v[160:163], a[96:99], a[216:219], v[160:163]
    ds_read_b128 a[236:239], v10 offset:50720
    v_mfma_f32_16x16x32_bf16 v[164:167], a[100:103], a[216:219], v[164:167]
    v_add_u32 v11, 6144, v11
    v_mfma_f32_16x16x32_bf16 v[168:171], a[104:107], a[216:219], v[168:171]
    global_load_dwordx4 a[72:75], v11, s[44:45] offset:-3072 sc1
    v_mfma_f32_16x16x32_bf16 v[172:175], a[96:99], a[220:223], v[172:175]
    ds_read_b128 a[216:219], v9 offset:64
    v_mfma_f32_16x16x32_bf16 v[176:179], a[100:103], a[220:223], v[176:179]
    v_mfma_f32_16x16x32_bf16 v[180:183], a[104:107], a[220:223], v[180:183]
    v_mfma_f32_16x16x32_bf16 v[160:163], a[108:111], a[220:223], v[160:163]
    global_load_dwordx4 a[76:79], v11, s[44:45] offset:-2048 sc1
    v_mfma_f32_16x16x32_bf16 v[164:167], a[112:115], a[220:223], v[164:167]
    v_mfma_f32_16x16x32_bf16 v[168:171], a[116:119], a[220:223], v[168:171]
    v_mfma_f32_16x16x32_bf16 v[184:187], a[96:99], a[224:227], v[184:187]
    ds_read_b128 a[220:223], v9 offset:25408
    v_mfma_f32_16x16x32_bf16 v[188:191], a[100:103], a[224:227], v[188:191]
    v_mfma_f32_16x16x32_bf16 v[192:195], a[104:107], a[224:227], v[192:195]
    v_mfma_f32_16x16x32_bf16 v[172:175], a[108:111], a[224:227], v[172:175]
    global_load_dwordx4 a[80:83], v11, s[44:45] offset:-1024 sc1
    v_mfma_f32_16x16x32_bf16 v[176:179], a[112:115], a[224:227], v[176:179]
    v_mfma_f32_16x16x32_bf16 v[180:183], a[116:119], a[224:227], v[180:183]
    v_mfma_f32_16x16x32_bf16 v[196:199], a[96:99], a[228:231], v[196:199]
    ds_read_b128 a[224:227], v9 offset:50752
    v_mfma_f32_16x16x32_bf16 v[200:203], a[100:103], a[228:231], v[200:203]
    v_mfma_f32_16x16x32_bf16 v[204:207], a[104:107], a[228:231], v[204:207]
    v_mfma_f32_16x16x32_bf16 v[184:187], a[108:111], a[228:231], v[184:187]
    global_load_dwordx4 a[84:87], v11, s[44:45] offset:0 sc1
    v_mfma_f32_16x16x32_bf16 v[188:191], a[112:115], a[228:231], v[188:191]
    v_mfma_f32_16x16x32_bf16 v[192:195], a[116:119], a[228:231], v[192:195]
    s_waitcnt lgkmcnt(3)
    v_mfma_f32_16x16x32_bf16 v[208:211], a[96:99], a[232:235], v[208:211]
    ds_read_b128 a[228:231], v10 offset:64
    v_mfma_f32_16x16x32_bf16 v[212:215], a[100:103], a[232:235], v[212:215]
    v_mfma_f32_16x16x32_bf16 v[216:219], a[104:107], a[232:235], v[216:219]
    v_mfma_f32_16x16x32_bf16 v[196:199], a[108:111], a[232:235], v[196:199]
    global_load_dwordx4 a[88:91], v11, s[44:45] offset:1024 sc1
    v_mfma_f32_16x16x32_bf16 v[200:203], a[112:115], a[232:235], v[200:203]
    v_mfma_f32_16x16x32_bf16 v[204:207], a[116:119], a[232:235], v[204:207]
    v_mfma_f32_16x16x32_bf16 v[208:211], a[108:111], a[236:239], v[208:211]
    ds_read_b128 a[232:235], v10 offset:25408
    v_mfma_f32_16x16x32_bf16 v[212:215], a[112:115], a[236:239], v[212:215]
    global_load_dwordx4 a[92:95], v11, s[44:45] offset:2048 sc1
    v_mfma_f32_16x16x32_bf16 v[216:219], a[116:119], a[236:239], v[216:219]
    s_waitcnt vmcnt(6) lgkmcnt(1)
    v_mfma_f32_16x16x32_bf16 v[160:163], a[120:123], a[216:219], v[160:163]
    ds_read_b128 a[236:239], v10 offset:50752
    v_mfma_f32_16x16x32_bf16 v[164:167], a[124:127], a[216:219], v[164:167]
    v_mfma_f32_16x16x32_bf16 v[168:171], a[128:131], a[216:219], v[168:171]
    v_add_u32 v9, 96, v9
    v_mfma_f32_16x16x32_bf16 v[172:175], a[120:123], a[220:223], v[172:175]
    ds_read_b128 a[216:219], v9 offset:0
    v_add_u32 v11, 6144, v11
    v_mfma_f32_16x16x32_bf16 v[176:179], a[124:127], a[220:223], v[176:179]
    global_load_dwordx4 a[96:99], v11, s[44:45] offset:-3072 sc1
    v_mfma_f32_16x16x32_bf16 v[180:183], a[128:131], a[220:223], v[180:183]
    v_mfma_f32_16x16x32_bf16 v[160:163], a[132:135], a[220:223], v[160:163]
    global_load_dwordx4 a[100:103], v11, s[44:45] offset:-2048 sc1
    v_mfma_f32_16x16x32_bf16 v[164:167], a[136:139], a[220:223], v[164:167]
    v_mfma_f32_16x16x32_bf16 v[168:171], a[140:143], a[220:223], v[168:171]
    v_mfma_f32_16x16x32_bf16 v[184:187], a[120:123], a[224:227], v[184:187]
    ds_read_b128 a[220:223], v9 offset:25344
    v_mfma_f32_16x16x32_bf16 v[188:191], a[124:127], a[224:227], v[188:191]
    v_mfma_f32_16x16x32_bf16 v[192:195], a[128:131], a[224:227], v[192:195]
    v_mfma_f32_16x16x32_bf16 v[172:175], a[132:135], a[224:227], v[172:175]
    global_load_dwordx4 a[104:107], v11, s[44:45] offset:-1024 sc1
    v_mfma_f32_16x16x32_bf16 v[176:179], a[136:139], a[224:227], v[176:179]
    v_mfma_f32_16x16x32_bf16 v[180:183], a[140:143], a[224:227], v[180:183]
    v_mfma_f32_16x16x32_bf16 v[196:199], a[120:123], a[228:231], v[196:199]
    ds_read_b128 a[224:227], v9 offset:50688
    v_mfma_f32_16x16x32_bf16 v[200:203], a[124:127], a[228:231], v[200:203]
    v_mfma_f32_16x16x32_bf16 v[204:207], a[128:131], a[228:231], v[204:207]
    v_mfma_f32_16x16x32_bf16 v[184:187], a[132:135], a[228:231], v[184:187]
    global_load_dwordx4 a[108:111], v11, s[44:45] offset:0 sc1
    v_mfma_f32_16x16x32_bf16 v[188:191], a[136:139], a[228:231], v[188:191]
    v_mfma_f32_16x16x32_bf16 v[192:195], a[140:143], a[228:231], v[192:195]
    s_waitcnt lgkmcnt(3)
    v_add_u32 v10, 96, v10
    v_mfma_f32_16x16x32_bf16 v[208:211], a[120:123], a[232:235], v[208:211]
    ds_read_b128 a[228:231], v10 offset:0
    v_mfma_f32_16x16x32_bf16 v[212:215], a[124:127], a[232:235], v[212:215]
    v_mfma_f32_16x16x32_bf16 v[216:219], a[128:131], a[232:235], v[216:219]
    v_mfma_f32_16x16x32_bf16 v[196:199], a[132:135], a[232:235], v[196:199]
    global_load_dwordx4 a[112:115], v11, s[44:45] offset:1024 sc1
    v_mfma_f32_16x16x32_bf16 v[200:203], a[136:139], a[232:235], v[200:203]
    v_mfma_f32_16x16x32_bf16 v[204:207], a[140:143], a[232:235], v[204:207]
    v_mfma_f32_16x16x32_bf16 v[208:211], a[132:135], a[236:239], v[208:211]
    ds_read_b128 a[232:235], v10 offset:25344
    v_mfma_f32_16x16x32_bf16 v[212:215], a[136:139], a[236:239], v[212:215]
    global_load_dwordx4 a[116:119], v11, s[44:45] offset:2048 sc1
    v_mfma_f32_16x16x32_bf16 v[216:219], a[140:143], a[236:239], v[216:219]
    s_waitcnt vmcnt(6) lgkmcnt(1)
    v_mfma_f32_16x16x32_bf16 v[160:163], a[72:75], a[216:219], v[160:163]
    ds_read_b128 a[236:239], v10 offset:50688
    v_mfma_f32_16x16x32_bf16 v[164:167], a[76:79], a[216:219], v[164:167]
    v_add_u32 v11, 6144, v11
    v_mfma_f32_16x16x32_bf16 v[168:171], a[80:83], a[216:219], v[168:171]
    global_load_dwordx4 a[120:123], v11, s[44:45] offset:-3072 sc1
    v_mfma_f32_16x16x32_bf16 v[172:175], a[72:75], a[220:223], v[172:175]
    s_mov_b32 s53, 96
    ds_read_b128 a[216:219], v9 offset:32
    v_mfma_f32_16x16x32_bf16 v[176:179], a[76:79], a[220:223], v[176:179]
    s_mov_b32 s52, 4
    v_mfma_f32_16x16x32_bf16 v[180:183], a[80:83], a[220:223], v[180:183]
    v_mfma_f32_16x16x32_bf16 v[160:163], a[84:87], a[220:223], v[160:163]
    global_load_dwordx4 a[124:127], v11, s[44:45] offset:-2048 sc1
    v_mfma_f32_16x16x32_bf16 v[164:167], a[88:91], a[220:223], v[164:167]
    v_mfma_f32_16x16x32_bf16 v[168:171], a[92:95], a[220:223], v[168:171]
    v_mfma_f32_16x16x32_bf16 v[184:187], a[72:75], a[224:227], v[184:187]
    ds_read_b128 a[220:223], v9 offset:25376
    v_mfma_f32_16x16x32_bf16 v[188:191], a[76:79], a[224:227], v[188:191]
    v_mfma_f32_16x16x32_bf16 v[192:195], a[80:83], a[224:227], v[192:195]
    v_mfma_f32_16x16x32_bf16 v[172:175], a[84:87], a[224:227], v[172:175]
    global_load_dwordx4 a[128:131], v11, s[44:45] offset:-1024 sc1
    v_mfma_f32_16x16x32_bf16 v[176:179], a[88:91], a[224:227], v[176:179]
    v_mfma_f32_16x16x32_bf16 v[180:183], a[92:95], a[224:227], v[180:183]
    v_mfma_f32_16x16x32_bf16 v[196:199], a[72:75], a[228:231], v[196:199]
    ds_read_b128 a[224:227], v9 offset:50720
    v_mfma_f32_16x16x32_bf16 v[200:203], a[76:79], a[228:231], v[200:203]
    v_mfma_f32_16x16x32_bf16 v[204:207], a[80:83], a[228:231], v[204:207]
    v_mfma_f32_16x16x32_bf16 v[184:187], a[84:87], a[228:231], v[184:187]
    global_load_dwordx4 a[132:135], v11, s[44:45] offset:0 sc1
    v_mfma_f32_16x16x32_bf16 v[188:191], a[88:91], a[228:231], v[188:191]
    v_mfma_f32_16x16x32_bf16 v[192:195], a[92:95], a[228:231], v[192:195]
    s_waitcnt lgkmcnt(3)
    v_mfma_f32_16x16x32_bf16 v[208:211], a[72:75], a[232:235], v[208:211]
    ds_read_b128 a[228:231], v10 offset:32
    v_mfma_f32_16x16x32_bf16 v[212:215], a[76:79], a[232:235], v[212:215]
    v_mfma_f32_16x16x32_bf16 v[216:219], a[80:83], a[232:235], v[216:219]
    v_mfma_f32_16x16x32_bf16 v[196:199], a[84:87], a[232:235], v[196:199]
    global_load_dwordx4 a[136:139], v11, s[44:45] offset:1024 sc1
    v_mfma_f32_16x16x32_bf16 v[200:203], a[88:91], a[232:235], v[200:203]
    v_mfma_f32_16x16x32_bf16 v[204:207], a[92:95], a[232:235], v[204:207]
    v_mfma_f32_16x16x32_bf16 v[208:211], a[84:87], a[236:239], v[208:211]
    ds_read_b128 a[232:235], v10 offset:25376
    v_mfma_f32_16x16x32_bf16 v[212:215], a[88:91], a[236:239], v[212:215]
    global_load_dwordx4 a[140:143], v11, s[44:45] offset:2048 sc1
    v_mfma_f32_16x16x32_bf16 v[216:219], a[92:95], a[236:239], v[216:219]
    s_waitcnt vmcnt(6) lgkmcnt(1)
    v_mfma_f32_16x16x32_bf16 v[160:163], a[96:99], a[216:219], v[160:163]
    ds_read_b128 a[236:239], v10 offset:50720
    v_mfma_f32_16x16x32_bf16 v[164:167], a[100:103], a[216:219], v[164:167]
    v_add_u32 v11, 6144, v11
    v_mfma_f32_16x16x32_bf16 v[168:171], a[104:107], a[216:219], v[168:171]
    global_load_dwordx4 a[72:75], v11, s[44:45] offset:-3072 sc1
    v_mfma_f32_16x16x32_bf16 v[172:175], a[96:99], a[220:223], v[172:175]
    ds_read_b128 a[216:219], v9 offset:64
    v_mfma_f32_16x16x32_bf16 v[176:179], a[100:103], a[220:223], v[176:179]
    v_mfma_f32_16x16x32_bf16 v[180:183], a[104:107], a[220:223], v[180:183]
    v_mfma_f32_16x16x32_bf16 v[160:163], a[108:111], a[220:223], v[160:163]
    global_load_dwordx4 a[76:79], v11, s[44:45] offset:-2048 sc1
    v_mfma_f32_16x16x32_bf16 v[164:167], a[112:115], a[220:223], v[164:167]
    v_mfma_f32_16x16x32_bf16 v[168:171], a[116:119], a[220:223], v[168:171]
    v_mfma_f32_16x16x32_bf16 v[184:187], a[96:99], a[224:227], v[184:187]
    ds_read_b128 a[220:223], v9 offset:25408
    v_mfma_f32_16x16x32_bf16 v[188:191], a[100:103], a[224:227], v[188:191]
    v_mfma_f32_16x16x32_bf16 v[192:195], a[104:107], a[224:227], v[192:195]
    v_mfma_f32_16x16x32_bf16 v[172:175], a[108:111], a[224:227], v[172:175]
    global_load_dwordx4 a[80:83], v11, s[44:45] offset:-1024 sc1
    v_mfma_f32_16x16x32_bf16 v[176:179], a[112:115], a[224:227], v[176:179]
    v_mfma_f32_16x16x32_bf16 v[180:183], a[116:119], a[224:227], v[180:183]
    v_mfma_f32_16x16x32_bf16 v[196:199], a[96:99], a[228:231], v[196:199]
    ds_read_b128 a[224:227], v9 offset:50752
    v_mfma_f32_16x16x32_bf16 v[200:203], a[100:103], a[228:231], v[200:203]
    v_mfma_f32_16x16x32_bf16 v[204:207], a[104:107], a[228:231], v[204:207]
    v_mfma_f32_16x16x32_bf16 v[184:187], a[108:111], a[228:231], v[184:187]
    global_load_dwordx4 a[84:87], v11, s[44:45] offset:0 sc1
    v_mfma_f32_16x16x32_bf16 v[188:191], a[112:115], a[228:231], v[188:191]
    v_mfma_f32_16x16x32_bf16 v[192:195], a[116:119], a[228:231], v[192:195]
    s_waitcnt lgkmcnt(3)
    v_mfma_f32_16x16x32_bf16 v[208:211], a[96:99], a[232:235], v[208:211]
    ds_read_b128 a[228:231], v10 offset:64
    v_mfma_f32_16x16x32_bf16 v[212:215], a[100:103], a[232:235], v[212:215]
    v_mfma_f32_16x16x32_bf16 v[216:219], a[104:107], a[232:235], v[216:219]
    v_mfma_f32_16x16x32_bf16 v[196:199], a[108:111], a[232:235], v[196:199]
    global_load_dwordx4 a[88:91], v11, s[44:45] offset:1024 sc1
    v_mfma_f32_16x16x32_bf16 v[200:203], a[112:115], a[232:235], v[200:203]
    v_mfma_f32_16x16x32_bf16 v[204:207], a[116:119], a[232:235], v[204:207]
    v_mfma_f32_16x16x32_bf16 v[208:211], a[108:111], a[236:239], v[208:211]
    ds_read_b128 a[232:235], v10 offset:25408
    v_mfma_f32_16x16x32_bf16 v[212:215], a[112:115], a[236:239], v[212:215]
    global_load_dwordx4 a[92:95], v11, s[44:45] offset:2048 sc1
    v_mfma_f32_16x16x32_bf16 v[216:219], a[116:119], a[236:239], v[216:219]
    s_waitcnt vmcnt(6) lgkmcnt(1)
    v_mfma_f32_16x16x32_bf16 v[160:163], a[120:123], a[216:219], v[160:163]
    ds_read_b128 a[236:239], v10 offset:50752
    v_mfma_f32_16x16x32_bf16 v[164:167], a[124:127], a[216:219], v[164:167]
    v_mfma_f32_16x16x32_bf16 v[168:171], a[128:131], a[216:219], v[168:171]
    v_add_u32 v9, 96, v9
    v_mfma_f32_16x16x32_bf16 v[172:175], a[120:123], a[220:223], v[172:175]
    ds_read_b128 a[216:219], v9 offset:0
    v_add_u32 v11, 6144, v11
    v_mfma_f32_16x16x32_bf16 v[176:179], a[124:127], a[220:223], v[176:179]
    global_load_dwordx4 a[96:99], v11, s[44:45] offset:-3072 sc1
    v_mfma_f32_16x16x32_bf16 v[180:183], a[128:131], a[220:223], v[180:183]
    v_mfma_f32_16x16x32_bf16 v[160:163], a[132:135], a[220:223], v[160:163]
    global_load_dwordx4 a[100:103], v11, s[44:45] offset:-2048 sc1
    v_mfma_f32_16x16x32_bf16 v[164:167], a[136:139], a[220:223], v[164:167]
    v_mfma_f32_16x16x32_bf16 v[168:171], a[140:143], a[220:223], v[168:171]
    v_mfma_f32_16x16x32_bf16 v[184:187], a[120:123], a[224:227], v[184:187]
    ds_read_b128 a[220:223], v9 offset:25344
    v_mfma_f32_16x16x32_bf16 v[188:191], a[124:127], a[224:227], v[188:191]
    v_mfma_f32_16x16x32_bf16 v[192:195], a[128:131], a[224:227], v[192:195]
    v_mfma_f32_16x16x32_bf16 v[172:175], a[132:135], a[224:227], v[172:175]
    global_load_dwordx4 a[104:107], v11, s[44:45] offset:-1024 sc1
    v_mfma_f32_16x16x32_bf16 v[176:179], a[136:139], a[224:227], v[176:179]
    v_mfma_f32_16x16x32_bf16 v[180:183], a[140:143], a[224:227], v[180:183]
    v_mfma_f32_16x16x32_bf16 v[196:199], a[120:123], a[228:231], v[196:199]
    ds_read_b128 a[224:227], v9 offset:50688
    v_mfma_f32_16x16x32_bf16 v[200:203], a[124:127], a[228:231], v[200:203]
    v_mfma_f32_16x16x32_bf16 v[204:207], a[128:131], a[228:231], v[204:207]
    v_mfma_f32_16x16x32_bf16 v[184:187], a[132:135], a[228:231], v[184:187]
    global_load_dwordx4 a[108:111], v11, s[44:45] offset:0 sc1
    v_mfma_f32_16x16x32_bf16 v[188:191], a[136:139], a[228:231], v[188:191]
    v_mfma_f32_16x16x32_bf16 v[192:195], a[140:143], a[228:231], v[192:195]
    s_waitcnt lgkmcnt(3)
    v_add_u32 v10, 96, v10
    v_mfma_f32_16x16x32_bf16 v[208:211], a[120:123], a[232:235], v[208:211]
    ds_read_b128 a[228:231], v10 offset:0
    v_mfma_f32_16x16x32_bf16 v[212:215], a[124:127], a[232:235], v[212:215]
    v_mfma_f32_16x16x32_bf16 v[216:219], a[128:131], a[232:235], v[216:219]
    v_mfma_f32_16x16x32_bf16 v[196:199], a[132:135], a[232:235], v[196:199]
    global_load_dwordx4 a[112:115], v11, s[44:45] offset:1024 sc1
    v_mfma_f32_16x16x32_bf16 v[200:203], a[136:139], a[232:235], v[200:203]
    v_mfma_f32_16x16x32_bf16 v[204:207], a[140:143], a[232:235], v[204:207]
    v_mfma_f32_16x16x32_bf16 v[208:211], a[132:135], a[236:239], v[208:211]
    s_barrier
    ds_read_b128 a[232:235], v10 offset:25344
    v_mfma_f32_16x16x32_bf16 v[212:215], a[136:139], a[236:239], v[212:215]
    global_load_dwordx4 a[116:119], v11, s[44:45] offset:2048 sc1
    v_mfma_f32_16x16x32_bf16 v[216:219], a[140:143], a[236:239], v[216:219]
    s_branch L_IT3
L_PROD:
    s_load_dwordx2 s[32:33], s[0:1], 24
    s_cmp_lt_u32 s2, 40
    s_cselect_b32 s10, s2, 63
    s_cmp_eq_u32 s2, 41
    s_cselect_b32 s10, 40, s10
    s_cmp_eq_u32 s2, 42
    s_cselect_b32 s10, 41, s10
    s_cmp_ge_u32 s10, 42
    s_cbranch_scc1 L_END
    s_lshr_b32 s56, s10, 1
    s_mul_i32 s54, s56, 6144
    s_and_b32 s48, s10, 1
    s_mul_i32 s55, s48, 96
    s_add_u32 s54, s54, s55
    v_mul_u32_u24 v5, 10923, v0
    v_lshrrev_b32 v5, 16, v5
    v_mul_u32_u24 v6, 96, v5
    v_lshl_add_u32 v4, v0, 4, v6
    s_lshl_b32 s55, s18, 10
    s_mov_b32 s34, 903168
    s_mov_b32 s35, 0x20000
    s_cmp_eq_u32 s18, 3
    s_cbranch_scc1 L_PROD_W3
    s_waitcnt lgkmcnt(0)
    s_add_u32 m0, s55, 0
    s_nop 0
    buffer_load_dwordx4 v4, s[32:35], s54 offen lds
    s_add_u32 m0, s55, 3072
    s_add_u32 s54, s54, 129024
    buffer_load_dwordx4 v4, s[32:35], s54 offen lds
    s_add_u32 m0, s55, 6144
    s_add_u32 s54, s54, 129024
    buffer_load_dwordx4 v4, s[32:35], s54 offen lds
    s_add_u32 m0, s55, 9216
    s_add_u32 s54, s54, 129024
    buffer_load_dwordx4 v4, s[32:35], s54 offen lds
    s_add_u32 m0, s55, 12288
    s_add_u32 s54, s54, 129024
    buffer_load_dwordx4 v4, s[32:35], s54 offen lds
    s_add_u32 m0, s55, 15360
    s_add_u32 s54, s54, 129024
    buffer_load_dwordx4 v4, s[32:35], s54 offen lds
    s_add_u32 m0, s55, 18432
    s_add_u32 s54, s54, 129024
    buffer_load_dwordx4 v4, s[32:35], s54 offen lds
    s_load_dwordx2 s[36:37], s[0:1], 32
    s_load_dwordx2 s[40:41], s[0:1], 40
    s_load_dwordx2 s[44:45], s[0:1], 48
    s_mov_b32 s38, 9633792
    s_mov_b32 s39, 0x20000
    s_mov_b32 s42, 256
    s_mov_b32 s43, 0x20000
    s_mov_b32 s46, 268435456
    s_mov_b32 s47, 0x20000
    v_lshrrev_b32 v7, 2, v2
    v_lshl_add_u32 v7, v3, 3, v7
    v_mul_u32_u24 v7, 96, v7
    v_bfe_u32 v8, v2, 1, 1
    v_mul_u32_u24 v8, 48, v8
    v_and_b32 v9, 1, v2
    v_lshl_add_u32 v8, v9, 3, v8
    s_lshl_b32 s55, s18, 4
    v_add3_u32 v7, v7, v8, s55
    v_bfe_u32 v8, v2, 1, 2
    v_lshlrev_b32 v8, 2, v8
    v_bfe_u32 v9, v2, 3, 1
    v_lshl_add_u32 v8, v9, 1, v8
    v_and_b32 v9, 1, v2
    v_add_u32 v8, v8, v9
    v_lshl_add_u32 v8, v3, 4, v8
    v_lshlrev_b32 v8, 4, v8
    v_xor_b32 v9, 32, v8
    s_mul_i32 s55, s48, 356352
    s_lshl_b32 s57, s18, 10
    s_add_u32 s55, s55, s57
    s_mul_i32 s57, s56, 6144
    s_add_u32 s4, s55, s57
    s_add_u32 s5, s4, 712704
    s_mul_i32 s57, s56, 3072
    s_add_u32 s6, s55, s57
    s_add_u32 s6, s6, 258048
    s_add_u32 s7, s5, 258048
    s_add_u32 s57, s4, 224256
    s_cmp_ge_u32 s56, 16
    s_cselect_b32 s7, s57, s7
    s_cselect_b32 s57, 0, 32
    v_xor_b32 v10, s57, v8
    s_mov_b32 s8, s4
    s_mov_b32 s9, s5
    s_mov_b32 s62, 0x3df4c401
    s_mov_b32 s63, 0x3df4c401
    s_mov_b32 s64, 0x3e379301
    s_mov_b32 s65, 0x3e379301
    s_mov_b32 s66, 0x3e89ae41
    s_mov_b32 s67, 0x3e89ae41
    s_mov_b32 s68, 0x3ece8561
    s_mov_b32 s69, 0x3ece8561
    s_mov_b32 s70, 0xbf303b34
    s_mov_b32 s71, 0xbf303b34
    s_mov_b32 s72, 0xbedc4a01
    s_mov_b32 s73, 0xbedc4a01
    s_mov_b32 s74, 0xbe89ae41
    s_mov_b32 s75, 0xbe89ae41
    s_mov_b32 s76, 0xbe2c19d1
    s_mov_b32 s77, 0xbe2c19d1
    s_mov_b32 s58, 0xffff0000
    s_waitcnt vmcnt(0) lgkmcnt(0)
    s_barrier
    ds_read_b64_tr_b16 v[128:129], v7 offset:0
    ds_read_b64_tr_b16 v[130:131], v7 offset:384
    ds_read_b64_tr_b16 v[136:137], v7 offset:6144
    ds_read_b64_tr_b16 v[138:139], v7 offset:6528
    ds_read_b64_tr_b16 v[132:133], v7 offset:3072
    ds_read_b64_tr_b16 v[134:135], v7 offset:3456
    ds_read_b64_tr_b16 v[140:141], v7 offset:9216
    ds_read_b64_tr_b16 v[142:143], v7 offset:9600
    ds_read_b64_tr_b16 v[148:149], v7 offset:15360
    ds_read_b64_tr_b16 v[150:151], v7 offset:15744
    ds_read_b64_tr_b16 v[144:145], v7 offset:12288
    ds_read_b64_tr_b16 v[146:147], v7 offset:12672
    ds_read_b64_tr_b16 v[152:153], v7 offset:18432
    ds_read_b64_tr_b16 v[154:155], v7 offset:18816
    s_waitcnt lgkmcnt(13)
    v_lshlrev_b32 v16, 16, v128
    v_and_b32 v17, s58, v128
    v_lshlrev_b32 v18, 16, v129
    v_and_b32 v19, s58, v129
    s_waitcnt lgkmcnt(12)
    v_lshlrev_b32 v20, 16, v130
    v_and_b32 v21, s58, v130
    v_lshlrev_b32 v22, 16, v131
    v_and_b32 v23, s58, v131
    s_waitcnt lgkmcnt(11)
    v_lshlrev_b32 v32, 16, v136
    v_and_b32 v33, s58, v136
    v_lshlrev_b32 v34, 16, v137
    v_and_b32 v35, s58, v137
    s_waitcnt lgkmcnt(10)
    v_lshlrev_b32 v36, 16, v138
    v_and_b32 v37, s58, v138
    v_lshlrev_b32 v38, 16, v139
    v_and_b32 v39, s58, v139
    s_waitcnt lgkmcnt(9)
    v_lshlrev_b32 v24, 16, v132
    v_and_b32 v25, s58, v132
    v_lshlrev_b32 v26, 16, v133
    v_and_b32 v27, s58, v133
    s_waitcnt lgkmcnt(8)
    v_lshlrev_b32 v28, 16, v134
    v_and_b32 v29, s58, v134
    v_lshlrev_b32 v30, 16, v135
    v_and_b32 v31, s58, v135
    s_waitcnt lgkmcnt(7)
    v_lshlrev_b32 v40, 16, v140
    v_and_b32 v41, s58, v140
    v_lshlrev_b32 v42, 16, v141
    v_and_b32 v43, s58, v141
    s_waitcnt lgkmcnt(6)
    v_lshlrev_b32 v44, 16, v142
    v_and_b32 v45, s58, v142
    v_lshlrev_b32 v46, 16, v143
    v_and_b32 v47, s58, v143
    v_pk_mul_f32 v[80:81], v[32:33], s[66:67]
    v_pk_mul_f32 v[88:89], v[24:25], s[64:65]
    v_pk_fma_f32 v[80:81], v[16:17], s[62:63], v[80:81]
    v_pk_fma_f32 v[88:89], v[40:41], s[68:69], v[88:89]
    v_pk_add_f32 v[96:97], v[80:81], v[88:89]
    v_pk_add_f32 v[104:105], v[80:81], v[88:89] neg_lo:[0,1] neg_hi:[0,1]
    v_pk_mul_f32 v[82:83], v[34:35], s[66:67]
    v_pk_mul_f32 v[90:91], v[26:27], s[64:65]
    v_pk_fma_f32 v[82:83], v[18:19], s[62:63], v[82:83]
    v_pk_fma_f32 v[90:91], v[42:43], s[68:69], v[90:91]
    v_pk_add_f32 v[98:99], v[82:83], v[90:91]
    v_pk_add_f32 v[106:107], v[82:83], v[90:91] neg_lo:[0,1] neg_hi:[0,1]
    v_pk_mul_f32 v[84:85], v[36:37], s[66:67]
    v_pk_mul_f32 v[92:93], v[28:29], s[64:65]
    v_pk_fma_f32 v[84:85], v[20:21], s[62:63], v[84:85]
    v_pk_fma_f32 v[92:93], v[44:45], s[68:69], v[92:93]
    v_pk_add_f32 v[100:101], v[84:85], v[92:93]
    v_pk_add_f32 v[108:109], v[84:85], v[92:93] neg_lo:[0,1] neg_hi:[0,1]
    v_pk_mul_f32 v[86:87], v[38:39], s[66:67]
    v_pk_mul_f32 v[94:95], v[30:31], s[64:65]
    v_pk_fma_f32 v[86:87], v[22:23], s[62:63], v[86:87]
    v_pk_fma_f32 v[94:95], v[46:47], s[68:69], v[94:95]
    v_pk_add_f32 v[102:103], v[86:87], v[94:95]
    v_pk_add_f32 v[110:111], v[86:87], v[94:95] neg_lo:[0,1] neg_hi:[0,1]
    v_cvt_pk_bf16_f32 v112, v96, v97
    v_cvt_pk_bf16_f32 v113, v98, v99
    v_cvt_pk_bf16_f32 v114, v100, v101
    v_cvt_pk_bf16_f32 v115, v102, v103
    buffer_store_dwordx4 v[112:115], v8, s[44:47], s8 offen offset:0 sc1
    v_cvt_pk_bf16_f32 v116, v104, v105
    v_cvt_pk_bf16_f32 v117, v106, v107
    v_cvt_pk_bf16_f32 v118, v108, v109
    v_cvt_pk_bf16_f32 v119, v110, v111
    buffer_store_dwordx4 v[116:119], v9, s[44:47], s9 offen offset:0 sc1
    v_pk_mul_f32 v[80:81], v[32:33], s[74:75]
    v_pk_mul_f32 v[88:89], v[24:25], s[72:73]
    v_pk_fma_f32 v[80:81], v[16:17], s[70:71], v[80:81]
    v_pk_fma_f32 v[88:89], v[40:41], s[76:77], v[88:89]
    v_pk_add_f32 v[96:97], v[80:81], v[88:89]
    v_pk_add_f32 v[104:105], v[80:81], v[88:89] neg_lo:[0,1] neg_hi:[0,1]
    v_pk_mul_f32 v[82:83], v[34:35], s[74:75]
    v_pk_mul_f32 v[90:91], v[26:27], s[72:73]
    v_pk_fma_f32 v[82:83], v[18:19], s[70:71], v[82:83]
    v_pk_fma_f32 v[90:91], v[42:43], s[76:77], v[90:91]
    v_pk_add_f32 v[98:99], v[82:83], v[90:91]
    v_pk_add_f32 v[106:107], v[82:83], v[90:91] neg_lo:[0,1] neg_hi:[0,1]
    v_pk_mul_f32 v[84:85], v[36:37], s[74:75]
    v_pk_mul_f32 v[92:93], v[28:29], s[72:73]
    v_pk_fma_f32 v[84:85], v[20:21], s[70:71], v[84:85]
    v_pk_fma_f32 v[92:93], v[44:45], s[76:77], v[92:93]
    v_pk_add_f32 v[100:101], v[84:85], v[92:93]
    v_pk_add_f32 v[108:109], v[84:85], v[92:93] neg_lo:[0,1] neg_hi:[0,1]
    v_pk_mul_f32 v[86:87], v[38:39], s[74:75]
    v_pk_mul_f32 v[94:95], v[30:31], s[72:73]
    v_pk_fma_f32 v[86:87], v[22:23], s[70:71], v[86:87]
    v_pk_fma_f32 v[94:95], v[46:47], s[76:77], v[94:95]
    v_pk_add_f32 v[102:103], v[86:87], v[94:95]
    v_pk_add_f32 v[110:111], v[86:87], v[94:95] neg_lo:[0,1] neg_hi:[0,1]
    v_cvt_pk_bf16_f32 v120, v96, v97
    v_cvt_pk_bf16_f32 v121, v98, v99
    v_cvt_pk_bf16_f32 v122, v100, v101
    v_cvt_pk_bf16_f32 v123, v102, v103
    s_add_u32 s57, s4, 129024
    buffer_store_dwordx4 v[120:123], v8, s[44:47], s57 offen sc1
    v_cvt_pk_bf16_f32 v124, v104, v105
    v_cvt_pk_bf16_f32 v125, v106, v107
    v_cvt_pk_bf16_f32 v126, v108, v109
    v_cvt_pk_bf16_f32 v127, v110, v111
    s_add_u32 s57, s5, 129024
    buffer_store_dwordx4 v[124:127], v9, s[44:47], s57 offen sc1
    buffer_store_dwordx4 v[128:131], v8, s[44:47], s6 offen offset:0 sc1
    buffer_store_dwordx4 v[140:143], v10, s[44:47], s7 offen offset:0 sc1
    s_waitcnt lgkmcnt(5)
    v_lshlrev_b32 v56, 16, v148
    v_and_b32 v57, s58, v148
    v_lshlrev_b32 v58, 16, v149
    v_and_b32 v59, s58, v149
    s_waitcnt lgkmcnt(4)
    v_lshlrev_b32 v60, 16, v150
    v_and_b32 v61, s58, v150
    v_lshlrev_b32 v62, 16, v151
    v_and_b32 v63, s58, v151
    s_waitcnt lgkmcnt(3)
    v_lshlrev_b32 v48, 16, v144
    v_and_b32 v49, s58, v144
    v_lshlrev_b32 v50, 16, v145
    v_and_b32 v51, s58, v145
    s_waitcnt lgkmcnt(2)
    v_lshlrev_b32 v52, 16, v146
    v_and_b32 v53, s58, v146
    v_lshlrev_b32 v54, 16, v147
    v_and_b32 v55, s58, v147
    s_waitcnt lgkmcnt(1)
    v_lshlrev_b32 v64, 16, v152
    v_and_b32 v65, s58, v152
    v_lshlrev_b32 v66, 16, v153
    v_and_b32 v67, s58, v153
    s_waitcnt lgkmcnt(0)
    v_lshlrev_b32 v68, 16, v154
    v_and_b32 v69, s58, v154
    v_lshlrev_b32 v70, 16, v155
    v_and_b32 v71, s58, v155
    v_pk_mul_f32 v[80:81], v[56:57], s[66:67]
    v_pk_mul_f32 v[88:89], v[48:49], s[64:65]
    v_pk_fma_f32 v[88:89], v[64:65], s[68:69], v[88:89]
    v_pk_add_f32 v[96:97], v[80:81], v[88:89]
    v_pk_add_f32 v[104:105], v[80:81], v[88:89] neg_lo:[0,1] neg_hi:[0,1]
    v_pk_mul_f32 v[82:83], v[58:59], s[66:67]
    v_pk_mul_f32 v[90:91], v[50:51], s[64:65]
    v_pk_fma_f32 v[90:91], v[66:67], s[68:69], v[90:91]
    v_pk_add_f32 v[98:99], v[82:83], v[90:91]
    v_pk_add_f32 v[106:107], v[82:83], v[90:91] neg_lo:[0,1] neg_hi:[0,1]
    v_pk_mul_f32 v[84:85], v[60:61], s[66:67]
    v_pk_mul_f32 v[92:93], v[52:53], s[64:65]
    v_pk_fma_f32 v[92:93], v[68:69], s[68:69], v[92:93]
    v_pk_add_f32 v[100:101], v[84:85], v[92:93]
    v_pk_add_f32 v[108:109], v[84:85], v[92:93] neg_lo:[0,1] neg_hi:[0,1]
    v_pk_mul_f32 v[86:87], v[62:63], s[66:67]
    v_pk_mul_f32 v[94:95], v[54:55], s[64:65]
    v_pk_fma_f32 v[94:95], v[70:71], s[68:69], v[94:95]
    v_pk_add_f32 v[102:103], v[86:87], v[94:95]
    v_pk_add_f32 v[110:111], v[86:87], v[94:95] neg_lo:[0,1] neg_hi:[0,1]
    v_cvt_pk_bf16_f32 v112, v96, v97
    v_cvt_pk_bf16_f32 v113, v98, v99
    v_cvt_pk_bf16_f32 v114, v100, v101
    v_cvt_pk_bf16_f32 v115, v102, v103
    buffer_store_dwordx4 v[112:115], v8, s[44:47], s8 offen offset:3072 sc1
    v_cvt_pk_bf16_f32 v116, v104, v105
    v_cvt_pk_bf16_f32 v117, v106, v107
    v_cvt_pk_bf16_f32 v118, v108, v109
    v_cvt_pk_bf16_f32 v119, v110, v111
    buffer_store_dwordx4 v[116:119], v9, s[44:47], s9 offen offset:3072 sc1
    v_pk_mul_f32 v[80:81], v[56:57], s[74:75]
    v_pk_mul_f32 v[88:89], v[48:49], s[72:73]
    v_pk_fma_f32 v[88:89], v[64:65], s[76:77], v[88:89]
    v_pk_add_f32 v[96:97], v[80:81], v[88:89]
    v_pk_add_f32 v[104:105], v[80:81], v[88:89] neg_lo:[0,1] neg_hi:[0,1]
    v_pk_mul_f32 v[82:83], v[58:59], s[74:75]
    v_pk_mul_f32 v[90:91], v[50:51], s[72:73]
    v_pk_fma_f32 v[90:91], v[66:67], s[76:77], v[90:91]
    v_pk_add_f32 v[98:99], v[82:83], v[90:91]
    v_pk_add_f32 v[106:107], v[82:83], v[90:91] neg_lo:[0,1] neg_hi:[0,1]
    v_pk_mul_f32 v[84:85], v[60:61], s[74:75]
    v_pk_mul_f32 v[92:93], v[52:53], s[72:73]
    v_pk_fma_f32 v[92:93], v[68:69], s[76:77], v[92:93]
    v_pk_add_f32 v[100:101], v[84:85], v[92:93]
    v_pk_add_f32 v[108:109], v[84:85], v[92:93] neg_lo:[0,1] neg_hi:[0,1]
    v_pk_mul_f32 v[86:87], v[62:63], s[74:75]
    v_pk_mul_f32 v[94:95], v[54:55], s[72:73]
    v_pk_fma_f32 v[94:95], v[70:71], s[76:77], v[94:95]
    v_pk_add_f32 v[102:103], v[86:87], v[94:95]
    v_pk_add_f32 v[110:111], v[86:87], v[94:95] neg_lo:[0,1] neg_hi:[0,1]
    v_cvt_pk_bf16_f32 v120, v96, v97
    v_cvt_pk_bf16_f32 v121, v98, v99
    v_cvt_pk_bf16_f32 v122, v100, v101
    v_cvt_pk_bf16_f32 v123, v102, v103
    s_add_u32 s57, s4, 132096
    buffer_store_dwordx4 v[120:123], v8, s[44:47], s57 offen sc1
    v_cvt_pk_bf16_f32 v124, v104, v105
    v_cvt_pk_bf16_f32 v125, v106, v107
    v_cvt_pk_bf16_f32 v126, v108, v109
    v_cvt_pk_bf16_f32 v127, v110, v111
    s_add_u32 s57, s5, 132096
    buffer_store_dwordx4 v[124:127], v9, s[44:47], s57 offen sc1
    buffer_store_dwordx4 v[152:155], v10, s[44:47], s7 offen offset:3072 sc1
    s_waitcnt vmcnt(0)
    s_barrier
    s_cmp_lg_u32 s18, 0
    s_cbranch_scc1 L_PROD_PF
    v_mov_b32 v4, 128
    v_mov_b32 v5, 1
    s_mov_b64 exec, 1
    buffer_atomic_add v5, v4, s[40:43], 0 offen sc0 sc1
    s_waitcnt vmcnt(0)
    v_readfirstlane_b32 s54, v5
    s_nop 0
    s_cmp_lg_u32 s54, 41
    s_cbranch_scc1 L_NOTLAST
    v_mov_b32 v4, 0
    v_mov_b32 v5, 42
    buffer_store_dword v5, v4, s[40:43], 0 offen sc1
L_NOTLAST:
    s_mov_b64 exec, -1
L_PROD_PF:
    s_cmp_ge_u32 s2, 40
    s_cbranch_scc1 L_PROD_END
    v_mov_b32 v4, 0
    s_mov_b32 s54, -1
    s_mov_b32 s55, -1
    s_mov_b32 s52, 0x400000
L_POLLP:
    buffer_load_dword v5, v4, s[40:43], 0 offen sc1
    s_waitcnt vmcnt(0)
    v_cmp_eq_u32 vcc, 42, v5
    s_nop 0
    s_cmp_eq_u64 vcc, s[54:55]
    s_cbranch_scc1 L_POLLEDP
    s_sleep 2
    s_sub_u32 s52, s52, 1
    s_cmp_lg_u32 s52, 0
    s_cbranch_scc1 L_POLLP
L_POLLEDP:
    s_lshr_b32 s54, s2, 3
    s_lshl_b32 s54, s54, 13
    s_mul_i32 s55, s18, 356352
    s_add_u32 s54, s54, s55
    v_lshlrev_b32 v4, 7, v1
    buffer_load_dword v16, v4, s[44:47], s54 offen sc1
    s_add_u32 s54, s54, 40960
    s_waitcnt vmcnt(0)
    buffer_load_dword v17, v4, s[44:47], s54 offen sc1
    s_add_u32 s54, s54, 40960
    s_waitcnt vmcnt(0)
    buffer_load_dword v18, v4, s[44:47], s54 offen sc1
    s_add_u32 s54, s54, 40960
    s_waitcnt vmcnt(0)
    buffer_load_dword v19, v4, s[44:47], s54 offen sc1
    s_add_u32 s54, s54, 40960
    s_waitcnt vmcnt(0)
    buffer_load_dword v20, v4, s[44:47], s54 offen sc1
    s_add_u32 s54, s54, 40960
    s_waitcnt vmcnt(0)
    buffer_load_dword v21, v4, s[44:47], s54 offen sc1
    s_add_u32 s54, s54, 40960
    s_waitcnt vmcnt(0)
    buffer_load_dword v22, v4, s[44:47], s54 offen sc1
    s_add_u32 s54, s54, 40960
    s_waitcnt vmcnt(0)
    buffer_load_dword v23, v4, s[44:47], s54 offen sc1
    s_add_u32 s54, s54, 40960
    s_waitcnt vmcnt(0)
    buffer_load_dword v24, v4, s[44:47], s54 offen sc1
    s_waitcnt vmcnt(0)
    s_waitcnt vmcnt(0)
L_PROD_END:
    s_endpgm
L_PROD_W3:
    s_load_dwordx2 s[36:37], s[0:1], 32
    s_load_dwordx2 s[40:41], s[0:1], 40
    s_load_dwordx2 s[44:45], s[0:1], 48
    s_mov_b32 s38, 9633792
    s_mov_b32 s39, 0x20000
    s_mov_b32 s42, 256
    s_mov_b32 s43, 0x20000
    s_mov_b32 s46, 268435456
    s_mov_b32 s47, 0x20000
    s_waitcnt lgkmcnt(0)
    s_barrier
    s_barrier
    s_branch L_PROD_PF
.section .rodata,"a"
.p2align 6
.amdhsa_kernel standalone__detection_seg_fpn_lateral__vision_kernel
  .amdhsa_next_free_vgpr 496
  .amdhsa_next_free_sgpr 102
  .amdhsa_accum_offset 256
  .amdhsa_group_segment_fixed_size 0
  .amdhsa_kernarg_size 56
  .amdhsa_user_sgpr_count 2
  .amdhsa_user_sgpr_kernarg_segment_ptr 1
  .amdhsa_system_sgpr_workgroup_id_x 1
.end_amdhsa_kernel
```
